```python
import torch

def _softmax(x, axis=-1):
    return torch.softmax(x, dim=axis)

def _gelu(x):
    return torch.nn.functional.gelu(x, approximate='tanh')

def _silu(x):
    return torch.nn.functional.silu(x)

def _sigmoid(x):
    return torch.sigmoid(x)

def _layernorm(x, axis=-1, eps=1e-05):
    m = x.mean(dim=axis, keepdim=True)
    v = x.var(dim=axis, keepdim=True, unbiased=False)
    return (x - m) / torch.sqrt(v + eps)

def _scatter_add(tgt, idx, src, axis=0):
    return tgt.clone().index_add_(axis, idx, src)

def _segment_sum(src, seg, n):
    out = torch.zeros((n,) + src.shape[1:], dtype=src.dtype)
    return out.index_add_(0, seg, src)

def _pad(x, pw):
    flat = tuple((v for pair in reversed(pw) for v in pair))
    return torch.nn.functional.pad(x, flat)
kernel_name = 'interleave_layers__memory_aug_recurrent_mem_tr__mixer_channel_mlp__prompt'

def setup_inputs():

    _w = lambda a: (lambda t: t.to(torch.bfloat16) if t.is_floating_point() else t)(torch.as_tensor(a))

    def _A_setup():
        B, S, Dm = (1, 2048, 1024)
        H, Dh = (32, 128)
        M, seg = (8, 32)
        seg = min(seg, S)
        S = S // seg * seg
        return {'x': _w((lambda *s: torch.randn(*s, dtype=torch.bfloat16) * 0.05)(B, S, Dm)), 'mem0': _w((lambda *s: torch.randn(*s, dtype=torch.bfloat16) * 0.8)(B, M, Dm)), 'Wq': _w((lambda *s: torch.randn(*s, dtype=torch.bfloat16) * 1.6)(Dm, H, Dh) * Dm ** (-0.5)), 'Wk': _w((lambda *s: torch.randn(*s, dtype=torch.bfloat16) * 1.6)(Dm, H, Dh) * Dm ** (-0.5)), 'Wv': _w((lambda *s: torch.randn(*s, dtype=torch.bfloat16) * 0.8)(Dm, H, Dh) * Dm ** (-0.5)), 'Wo': _w((lambda *s: torch.randn(*s, dtype=torch.bfloat16) * 0.8)(H, Dh, Dm) * (H * Dh) ** (-0.5)), 'seg_len': seg}
    _A_in = _A_setup()

    def _B_setup():
        B, S, D, F = (1, 2048, 1024, 3584)
        return {'x': _w((lambda *s: torch.randn(*s, dtype=torch.bfloat16) * 0.05)(B, S, D)), 'w1': _w((lambda *s: torch.randn(*s, dtype=torch.bfloat16) * 3.2)(D, F) * D ** (-0.5)), 'b1': _w((lambda *s: torch.randn(*s, dtype=torch.bfloat16) * 0.8)(F)), 'w2': _w((lambda *s: torch.randn(*s, dtype=torch.bfloat16) * 0.1)(F, D) * F ** (-0.5)), 'b2': _w((lambda *s: torch.randn(*s, dtype=torch.bfloat16) * 0.1)(D))}
    _B_in = _B_setup()
    return {'A_x': _A_in['x'], 'A_mem0': _A_in['mem0'], 'A_Wq': _A_in['Wq'], 'A_Wk': _A_in['Wk'], 'A_Wv': _A_in['Wv'], 'A_Wo': _A_in['Wo'], 'A_seg_len': _A_in['seg_len'], 'B_x': _B_in['x'], 'B_w1': _B_in['w1'], 'B_b1': _B_in['b1'], 'B_w2': _B_in['w2'], 'B_b2': _B_in['b2']}

def reference(A_x, A_mem0, A_Wq, A_Wk, A_Wv, A_Wo, A_seg_len, B_x, B_w1, B_b1, B_w2, B_b2):

    def _A_ref(x, mem0, Wq, Wk, Wv, Wo, seg_len):
        B, S, Dm = x.shape
        H, Dh = (Wq.shape[1], Wq.shape[2])
        M = mem0.shape[1]
        scale = Dh ** (-0.5)
        n_seg = S // seg_len
        L = M + seg_len
        idx = torch.arange(L)
        mask = (idx[:, None] < M) | (idx[:, None] >= idx[None, :])
        mem = mem0
        outs = []
        for s in range(n_seg):
            xs = x[:, s * seg_len:(s + 1) * seg_len, :].clone()
            h = torch.concatenate([mem, xs], axis=1)
            q = torch.einsum('btd,dhe->bhte', h, Wq)
            k = torch.einsum('btd,dhe->bhte', h, Wk)
            v = torch.einsum('btd,dhe->bhte', h, Wv)
            scores = torch.einsum('bhqe,bhke->bhqk', q, k) * scale
            scores = torch.where(mask[None, None], scores, -1000000000.0)
            p = _softmax(scores, axis=-1)
            o = torch.einsum('bhqk,bhke->bhqe', p, v)
            o = torch.einsum('bhte,hed->btd', o, Wo)
            mem = o[:, :M, :].clone()
            outs.append(o[:, M:, :])
        return torch.concatenate(outs, axis=1)

    def _B_ref(x, w1, b1, w2, b2):
        y = _layernorm(x, axis=-1)
        h = _gelu(torch.einsum('bsd,df->bsf', y, w1) + b1)
        return torch.einsum('bsf,fd->bsd', h, w2) + b2
    x = A_x
    x = x + _A_ref(_layernorm(x, axis=-1), A_mem0, A_Wq, A_Wk, A_Wv, A_Wo, A_seg_len)
    x = x + _B_ref(_layernorm(x, axis=-1), B_w1, B_b1, B_w2, B_b2)
    x = x + _A_ref(_layernorm(x, axis=-1), A_mem0, A_Wq, A_Wk, A_Wv, A_Wo, A_seg_len)
    x = x + _B_ref(_layernorm(x, axis=-1), B_w1, B_b1, B_w2, B_b2)
    return x
```

```asm
; @launch kernel=ln_a_kernel grid=(1088,1,1) block=(256,1,1) lds=0
; @launch kernel=gemm_qkv_kernel grid=(768,1,1) block=(256,1,1) lds=147456
; @launch kernel=chain0_kernel grid=(256,1,1) block=(256,1,1) lds=135424
; @launch kernel=attn_kernel grid=(512,1,1) block=(256,1,1) lds=104448
; @launch kernel=gemm_wo0_kernel grid=(256,1,1) block=(256,1,1) lds=73728
; @launch kernel=ln_b_kernel grid=(512,1,1) block=(256,1,1) lds=0
; @launch kernel=gemm_w1_kernel grid=(224,1,1) block=(256,1,1) lds=147456
; @launch kernel=gemm_w2a_kernel grid=(256,1,1) block=(256,1,1) lds=73728
; @launch kernel=ln_c_kernel grid=(512,1,1) block=(256,1,1) lds=0
; @launch kernel=gemm_qkv_kernel grid=(768,1,1) block=(256,1,1) lds=147456
; @launch kernel=chain1_kernel grid=(256,1,1) block=(256,1,1) lds=135424
; @launch kernel=attn_kernel grid=(512,1,1) block=(256,1,1) lds=104448
; @launch kernel=gemm_wo1_kernel grid=(256,1,1) block=(256,1,1) lds=73728
; @launch kernel=ln_b_kernel grid=(512,1,1) block=(256,1,1) lds=0
; @launch kernel=gemm_w1_kernel grid=(224,1,1) block=(256,1,1) lds=147456
; @launch kernel=gemm_w2b_kernel grid=(256,1,1) block=(256,1,1) lds=73728
.amdgcn_target "amdgcn-amd-amdhsa--gfx950"
.text
.globl ln_a_kernel
.p2align 8
.type ln_a_kernel,@function
ln_a_kernel:
    s_cmp_lt_u32 s2, 512
    s_cbranch_scc1 .z_1
    s_cmp_ge_u32 s2, 1088
    s_cbranch_scc1 .ln_a_kernel_done
    s_load_dwordx2 s[4:5], s[0:1], 112
    s_waitcnt lgkmcnt(0)
    s_add_u32 s4, s4, 0x7000000
    s_addc_u32 s5, s5, 0
    s_mov_b32 s8, s4
    s_and_b32 s9, s5, 0xffff
    s_mov_b32 s10, 0x240000
    s_mov_b32 s11, 0x00020000
    s_sub_u32 s3, s2, 512
    s_lshl_b32 s3, s3, 12
    v_lshlrev_b32 v1, 4, v0
    v_add_u32 v1, s3, v1
    v_mov_b32 v4, 0
    v_mov_b32 v5, 0
    v_mov_b32 v6, 0
    v_mov_b32 v7, 0
    buffer_store_dwordx4 v[4:7], v1, s[8:11], 0 offen
    s_endpgm
.z_1:
    s_load_dwordx2 s[4:5], s[0:1], 0
    s_load_dwordx2 s[6:7], s[0:1], 112
    s_waitcnt lgkmcnt(0)
    s_add_u32 s6, s6, 0x0
    s_addc_u32 s7, s7, 0
    s_mov_b32 s8, s4
    s_and_b32 s9, s5, 0xffff
    s_mov_b32 s10, 0x400000
    s_mov_b32 s11, 0x00020000
    s_mov_b32 s12, s6
    s_and_b32 s13, s7, 0xffff
    s_mov_b32 s14, 0x400000
    s_mov_b32 s15, 0x00020000
    v_lshrrev_b32 v1, 6, v0
    v_and_b32 v2, 63, v0
    s_lshl_b32 s3, s2, 2
    v_add_u32 v1, s3, v1
    v_lshlrev_b32 v1, 11, v1
    v_lshlrev_b32 v2, 4, v2
    v_add_u32 v1, v1, v2
    buffer_load_dwordx4 v[4:7], v1, s[8:11], 0 offen
    buffer_load_dwordx4 v[8:11], v1, s[8:11], 0 offen offset:1024
    s_waitcnt vmcnt(0)
    v_lshlrev_b32 v16, 16, v4
    v_and_b32 v17, 0xffff0000, v4
    v_lshlrev_b32 v18, 16, v5
    v_and_b32 v19, 0xffff0000, v5
    v_lshlrev_b32 v20, 16, v6
    v_and_b32 v21, 0xffff0000, v6
    v_lshlrev_b32 v22, 16, v7
    v_and_b32 v23, 0xffff0000, v7
    v_lshlrev_b32 v24, 16, v8
    v_and_b32 v25, 0xffff0000, v8
    v_lshlrev_b32 v26, 16, v9
    v_and_b32 v27, 0xffff0000, v9
    v_lshlrev_b32 v28, 16, v10
    v_and_b32 v29, 0xffff0000, v10
    v_lshlrev_b32 v30, 16, v11
    v_and_b32 v31, 0xffff0000, v11
    v_add_f32 v32, v16, v17
    v_add_f32 v32, v32, v18
    v_add_f32 v32, v32, v19
    v_add_f32 v32, v32, v20
    v_add_f32 v32, v32, v21
    v_add_f32 v32, v32, v22
    v_add_f32 v32, v32, v23
    v_add_f32 v32, v32, v24
    v_add_f32 v32, v32, v25
    v_add_f32 v32, v32, v26
    v_add_f32 v32, v32, v27
    v_add_f32 v32, v32, v28
    v_add_f32 v32, v32, v29
    v_add_f32 v32, v32, v30
    v_add_f32 v32, v32, v31
    ds_swizzle_b32 v33, v32 offset:0x41f
    s_waitcnt lgkmcnt(0)
    v_add_f32 v32, v32, v33
    ds_swizzle_b32 v33, v32 offset:0x81f
    s_waitcnt lgkmcnt(0)
    v_add_f32 v32, v32, v33
    ds_swizzle_b32 v33, v32 offset:0x101f
    s_waitcnt lgkmcnt(0)
    v_add_f32 v32, v32, v33
    ds_swizzle_b32 v33, v32 offset:0x201f
    s_waitcnt lgkmcnt(0)
    v_add_f32 v32, v32, v33
    ds_swizzle_b32 v33, v32 offset:0x401f
    s_waitcnt lgkmcnt(0)
    v_add_f32 v32, v32, v33
    v_mov_b32 v33, v32
    s_nop 1
    v_permlane32_swap_b32 v32, v33
    s_nop 1
    v_add_f32 v32, v32, v33
    v_mul_f32 v32, 0x3a800000, v32
    v_sub_f32 v16, v16, v32
    v_sub_f32 v17, v17, v32
    v_sub_f32 v18, v18, v32
    v_sub_f32 v19, v19, v32
    v_sub_f32 v20, v20, v32
    v_sub_f32 v21, v21, v32
    v_sub_f32 v22, v22, v32
    v_sub_f32 v23, v23, v32
    v_sub_f32 v24, v24, v32
    v_sub_f32 v25, v25, v32
    v_sub_f32 v26, v26, v32
    v_sub_f32 v27, v27, v32
    v_sub_f32 v28, v28, v32
    v_sub_f32 v29, v29, v32
    v_sub_f32 v30, v30, v32
    v_sub_f32 v31, v31, v32
    v_mul_f32 v34, v16, v16
    v_fmac_f32 v34, v17, v17
    v_fmac_f32 v34, v18, v18
    v_fmac_f32 v34, v19, v19
    v_fmac_f32 v34, v20, v20
    v_fmac_f32 v34, v21, v21
    v_fmac_f32 v34, v22, v22
    v_fmac_f32 v34, v23, v23
    v_fmac_f32 v34, v24, v24
    v_fmac_f32 v34, v25, v25
    v_fmac_f32 v34, v26, v26
    v_fmac_f32 v34, v27, v27
    v_fmac_f32 v34, v28, v28
    v_fmac_f32 v34, v29, v29
    v_fmac_f32 v34, v30, v30
    v_fmac_f32 v34, v31, v31
    ds_swizzle_b32 v33, v34 offset:0x41f
    s_waitcnt lgkmcnt(0)
    v_add_f32 v34, v34, v33
    ds_swizzle_b32 v33, v34 offset:0x81f
    s_waitcnt lgkmcnt(0)
    v_add_f32 v34, v34, v33
    ds_swizzle_b32 v33, v34 offset:0x101f
    s_waitcnt lgkmcnt(0)
    v_add_f32 v34, v34, v33
    ds_swizzle_b32 v33, v34 offset:0x201f
    s_waitcnt lgkmcnt(0)
    v_add_f32 v34, v34, v33
    ds_swizzle_b32 v33, v34 offset:0x401f
    s_waitcnt lgkmcnt(0)
    v_add_f32 v34, v34, v33
    v_mov_b32 v33, v34
    s_nop 1
    v_permlane32_swap_b32 v34, v33
    s_nop 1
    v_add_f32 v34, v34, v33
    v_mov_b32 v35, 0x3727c5ac
    v_fmac_f32 v35, 0x3a800000, v34
    v_rsq_f32 v35, v35
    s_nop 0
    v_mul_f32 v16, v16, v35
    v_mul_f32 v17, v17, v35
    v_mul_f32 v18, v18, v35
    v_mul_f32 v19, v19, v35
    v_mul_f32 v20, v20, v35
    v_mul_f32 v21, v21, v35
    v_mul_f32 v22, v22, v35
    v_mul_f32 v23, v23, v35
    v_mul_f32 v24, v24, v35
    v_mul_f32 v25, v25, v35
    v_mul_f32 v26, v26, v35
    v_mul_f32 v27, v27, v35
    v_mul_f32 v28, v28, v35
    v_mul_f32 v29, v29, v35
    v_mul_f32 v30, v30, v35
    v_mul_f32 v31, v31, v35
    v_cvt_pk_bf16_f32 v4, v16, v17
    v_cvt_pk_bf16_f32 v5, v18, v19
    v_cvt_pk_bf16_f32 v6, v20, v21
    v_cvt_pk_bf16_f32 v7, v22, v23
    v_cvt_pk_bf16_f32 v8, v24, v25
    v_cvt_pk_bf16_f32 v9, v26, v27
    v_cvt_pk_bf16_f32 v10, v28, v29
    v_cvt_pk_bf16_f32 v11, v30, v31
    buffer_store_dwordx4 v[4:7], v1, s[12:15], 0 offen
    buffer_store_dwordx4 v[8:11], v1, s[12:15], 0 offen offset:1024
.ln_a_kernel_done:
    s_endpgm
.section .rodata,"a"
.p2align 6
.amdhsa_kernel ln_a_kernel
  .amdhsa_next_free_vgpr 40
  .amdhsa_next_free_sgpr 24
  .amdhsa_accum_offset 40
  .amdhsa_group_segment_fixed_size 0
  .amdhsa_kernarg_size 120
  .amdhsa_user_sgpr_count 2
  .amdhsa_user_sgpr_kernarg_segment_ptr 1
  .amdhsa_system_sgpr_workgroup_id_x 1
.end_amdhsa_kernel
.text
.globl ln_b_kernel
.p2align 8
.type ln_b_kernel,@function
ln_b_kernel:
    s_cmp_ge_u32 s2, 512
    s_cbranch_scc1 .ln_b_kernel_done
    s_load_dwordx2 s[4:5], s[0:1], 112
    s_load_dwordx2 s[6:7], s[0:1], 112
    s_waitcnt lgkmcnt(0)
    s_add_u32 s4, s4, 0x400000
    s_addc_u32 s5, s5, 0
    s_add_u32 s6, s6, 0x0
    s_addc_u32 s7, s7, 0
    s_mov_b32 s8, s4
    s_and_b32 s9, s5, 0xffff
    s_mov_b32 s10, 0x400000
    s_mov_b32 s11, 0x00020000
    s_mov_b32 s12, s6
    s_and_b32 s13, s7, 0xffff
    s_mov_b32 s14, 0x400000
    s_mov_b32 s15, 0x00020000
    v_lshrrev_b32 v1, 6, v0
    v_and_b32 v2, 63, v0
    s_lshl_b32 s3, s2, 2
    v_add_u32 v1, s3, v1
    v_lshlrev_b32 v1, 11, v1
    v_lshlrev_b32 v2, 4, v2
    v_add_u32 v1, v1, v2
    buffer_load_dwordx4 v[4:7], v1, s[8:11], 0 offen
    buffer_load_dwordx4 v[8:11], v1, s[8:11], 0 offen offset:1024
    s_waitcnt vmcnt(0)
    v_lshlrev_b32 v16, 16, v4
    v_and_b32 v17, 0xffff0000, v4
    v_lshlrev_b32 v18, 16, v5
    v_and_b32 v19, 0xffff0000, v5
    v_lshlrev_b32 v20, 16, v6
    v_and_b32 v21, 0xffff0000, v6
    v_lshlrev_b32 v22, 16, v7
    v_and_b32 v23, 0xffff0000, v7
    v_lshlrev_b32 v24, 16, v8
    v_and_b32 v25, 0xffff0000, v8
    v_lshlrev_b32 v26, 16, v9
    v_and_b32 v27, 0xffff0000, v9
    v_lshlrev_b32 v28, 16, v10
    v_and_b32 v29, 0xffff0000, v10
    v_lshlrev_b32 v30, 16, v11
    v_and_b32 v31, 0xffff0000, v11
    v_add_f32 v32, v16, v17
    v_add_f32 v32, v32, v18
    v_add_f32 v32, v32, v19
    v_add_f32 v32, v32, v20
    v_add_f32 v32, v32, v21
    v_add_f32 v32, v32, v22
    v_add_f32 v32, v32, v23
    v_add_f32 v32, v32, v24
    v_add_f32 v32, v32, v25
    v_add_f32 v32, v32, v26
    v_add_f32 v32, v32, v27
    v_add_f32 v32, v32, v28
    v_add_f32 v32, v32, v29
    v_add_f32 v32, v32, v30
    v_add_f32 v32, v32, v31
    ds_swizzle_b32 v33, v32 offset:0x41f
    s_waitcnt lgkmcnt(0)
    v_add_f32 v32, v32, v33
    ds_swizzle_b32 v33, v32 offset:0x81f
    s_waitcnt lgkmcnt(0)
    v_add_f32 v32, v32, v33
    ds_swizzle_b32 v33, v32 offset:0x101f
    s_waitcnt lgkmcnt(0)
    v_add_f32 v32, v32, v33
    ds_swizzle_b32 v33, v32 offset:0x201f
    s_waitcnt lgkmcnt(0)
    v_add_f32 v32, v32, v33
    ds_swizzle_b32 v33, v32 offset:0x401f
    s_waitcnt lgkmcnt(0)
    v_add_f32 v32, v32, v33
    v_mov_b32 v33, v32
    s_nop 1
    v_permlane32_swap_b32 v32, v33
    s_nop 1
    v_add_f32 v32, v32, v33
    v_mul_f32 v32, 0x3a800000, v32
    v_sub_f32 v16, v16, v32
    v_sub_f32 v17, v17, v32
    v_sub_f32 v18, v18, v32
    v_sub_f32 v19, v19, v32
    v_sub_f32 v20, v20, v32
    v_sub_f32 v21, v21, v32
    v_sub_f32 v22, v22, v32
    v_sub_f32 v23, v23, v32
    v_sub_f32 v24, v24, v32
    v_sub_f32 v25, v25, v32
    v_sub_f32 v26, v26, v32
    v_sub_f32 v27, v27, v32
    v_sub_f32 v28, v28, v32
    v_sub_f32 v29, v29, v32
    v_sub_f32 v30, v30, v32
    v_sub_f32 v31, v31, v32
    v_mul_f32 v34, v16, v16
    v_fmac_f32 v34, v17, v17
    v_fmac_f32 v34, v18, v18
    v_fmac_f32 v34, v19, v19
    v_fmac_f32 v34, v20, v20
    v_fmac_f32 v34, v21, v21
    v_fmac_f32 v34, v22, v22
    v_fmac_f32 v34, v23, v23
    v_fmac_f32 v34, v24, v24
    v_fmac_f32 v34, v25, v25
    v_fmac_f32 v34, v26, v26
    v_fmac_f32 v34, v27, v27
    v_fmac_f32 v34, v28, v28
    v_fmac_f32 v34, v29, v29
    v_fmac_f32 v34, v30, v30
    v_fmac_f32 v34, v31, v31
    ds_swizzle_b32 v33, v34 offset:0x41f
    s_waitcnt lgkmcnt(0)
    v_add_f32 v34, v34, v33
    ds_swizzle_b32 v33, v34 offset:0x81f
    s_waitcnt lgkmcnt(0)
    v_add_f32 v34, v34, v33
    ds_swizzle_b32 v33, v34 offset:0x101f
    s_waitcnt lgkmcnt(0)
    v_add_f32 v34, v34, v33
    ds_swizzle_b32 v33, v34 offset:0x201f
    s_waitcnt lgkmcnt(0)
    v_add_f32 v34, v34, v33
    ds_swizzle_b32 v33, v34 offset:0x401f
    s_waitcnt lgkmcnt(0)
    v_add_f32 v34, v34, v33
    v_mov_b32 v33, v34
    s_nop 1
    v_permlane32_swap_b32 v34, v33
    s_nop 1
    v_add_f32 v34, v34, v33
    v_mov_b32 v35, 0x3727c5ac
    v_fmac_f32 v35, 0x3a800000, v34
    v_rsq_f32 v35, v35
    s_nop 0
    v_mul_f32 v16, v16, v35
    v_mul_f32 v17, v17, v35
    v_mul_f32 v18, v18, v35
    v_mul_f32 v19, v19, v35
    v_mul_f32 v20, v20, v35
    v_mul_f32 v21, v21, v35
    v_mul_f32 v22, v22, v35
    v_mul_f32 v23, v23, v35
    v_mul_f32 v24, v24, v35
    v_mul_f32 v25, v25, v35
    v_mul_f32 v26, v26, v35
    v_mul_f32 v27, v27, v35
    v_mul_f32 v28, v28, v35
    v_mul_f32 v29, v29, v35
    v_mul_f32 v30, v30, v35
    v_mul_f32 v31, v31, v35
    v_cvt_pk_bf16_f32 v4, v16, v17
    v_cvt_pk_bf16_f32 v5, v18, v19
    v_cvt_pk_bf16_f32 v6, v20, v21
    v_cvt_pk_bf16_f32 v7, v22, v23
    v_cvt_pk_bf16_f32 v8, v24, v25
    v_cvt_pk_bf16_f32 v9, v26, v27
    v_cvt_pk_bf16_f32 v10, v28, v29
    v_cvt_pk_bf16_f32 v11, v30, v31
    v_lshlrev_b32 v16, 16, v4
    v_and_b32 v17, 0xffff0000, v4
    v_lshlrev_b32 v18, 16, v5
    v_and_b32 v19, 0xffff0000, v5
    v_lshlrev_b32 v20, 16, v6
    v_and_b32 v21, 0xffff0000, v6
    v_lshlrev_b32 v22, 16, v7
    v_and_b32 v23, 0xffff0000, v7
    v_lshlrev_b32 v24, 16, v8
    v_and_b32 v25, 0xffff0000, v8
    v_lshlrev_b32 v26, 16, v9
    v_and_b32 v27, 0xffff0000, v9
    v_lshlrev_b32 v28, 16, v10
    v_and_b32 v29, 0xffff0000, v10
    v_lshlrev_b32 v30, 16, v11
    v_and_b32 v31, 0xffff0000, v11
    v_add_f32 v32, v16, v17
    v_add_f32 v32, v32, v18
    v_add_f32 v32, v32, v19
    v_add_f32 v32, v32, v20
    v_add_f32 v32, v32, v21
    v_add_f32 v32, v32, v22
    v_add_f32 v32, v32, v23
    v_add_f32 v32, v32, v24
    v_add_f32 v32, v32, v25
    v_add_f32 v32, v32, v26
    v_add_f32 v32, v32, v27
    v_add_f32 v32, v32, v28
    v_add_f32 v32, v32, v29
    v_add_f32 v32, v32, v30
    v_add_f32 v32, v32, v31
    ds_swizzle_b32 v33, v32 offset:0x41f
    s_waitcnt lgkmcnt(0)
    v_add_f32 v32, v32, v33
    ds_swizzle_b32 v33, v32 offset:0x81f
    s_waitcnt lgkmcnt(0)
    v_add_f32 v32, v32, v33
    ds_swizzle_b32 v33, v32 offset:0x101f
    s_waitcnt lgkmcnt(0)
    v_add_f32 v32, v32, v33
    ds_swizzle_b32 v33, v32 offset:0x201f
    s_waitcnt lgkmcnt(0)
    v_add_f32 v32, v32, v33
    ds_swizzle_b32 v33, v32 offset:0x401f
    s_waitcnt lgkmcnt(0)
    v_add_f32 v32, v32, v33
    v_mov_b32 v33, v32
    s_nop 1
    v_permlane32_swap_b32 v32, v33
    s_nop 1
    v_add_f32 v32, v32, v33
    v_mul_f32 v32, 0x3a800000, v32
    v_sub_f32 v16, v16, v32
    v_sub_f32 v17, v17, v32
    v_sub_f32 v18, v18, v32
    v_sub_f32 v19, v19, v32
    v_sub_f32 v20, v20, v32
    v_sub_f32 v21, v21, v32
    v_sub_f32 v22, v22, v32
    v_sub_f32 v23, v23, v32
    v_sub_f32 v24, v24, v32
    v_sub_f32 v25, v25, v32
    v_sub_f32 v26, v26, v32
    v_sub_f32 v27, v27, v32
    v_sub_f32 v28, v28, v32
    v_sub_f32 v29, v29, v32
    v_sub_f32 v30, v30, v32
    v_sub_f32 v31, v31, v32
    v_mul_f32 v34, v16, v16
    v_fmac_f32 v34, v17, v17
    v_fmac_f32 v34, v18, v18
    v_fmac_f32 v34, v19, v19
    v_fmac_f32 v34, v20, v20
    v_fmac_f32 v34, v21, v21
    v_fmac_f32 v34, v22, v22
    v_fmac_f32 v34, v23, v23
    v_fmac_f32 v34, v24, v24
    v_fmac_f32 v34, v25, v25
    v_fmac_f32 v34, v26, v26
    v_fmac_f32 v34, v27, v27
    v_fmac_f32 v34, v28, v28
    v_fmac_f32 v34, v29, v29
    v_fmac_f32 v34, v30, v30
    v_fmac_f32 v34, v31, v31
    ds_swizzle_b32 v33, v34 offset:0x41f
    s_waitcnt lgkmcnt(0)
    v_add_f32 v34, v34, v33
    ds_swizzle_b32 v33, v34 offset:0x81f
    s_waitcnt lgkmcnt(0)
    v_add_f32 v34, v34, v33
    ds_swizzle_b32 v33, v34 offset:0x101f
    s_waitcnt lgkmcnt(0)
    v_add_f32 v34, v34, v33
    ds_swizzle_b32 v33, v34 offset:0x201f
    s_waitcnt lgkmcnt(0)
    v_add_f32 v34, v34, v33
    ds_swizzle_b32 v33, v34 offset:0x401f
    s_waitcnt lgkmcnt(0)
    v_add_f32 v34, v34, v33
    v_mov_b32 v33, v34
    s_nop 1
    v_permlane32_swap_b32 v34, v33
    s_nop 1
    v_add_f32 v34, v34, v33
    v_mov_b32 v35, 0x3727c5ac
    v_fmac_f32 v35, 0x3a800000, v34
    v_rsq_f32 v35, v35
    s_nop 0
    v_mul_f32 v16, v16, v35
    v_mul_f32 v17, v17, v35
    v_mul_f32 v18, v18, v35
    v_mul_f32 v19, v19, v35
    v_mul_f32 v20, v20, v35
    v_mul_f32 v21, v21, v35
    v_mul_f32 v22, v22, v35
    v_mul_f32 v23, v23, v35
    v_mul_f32 v24, v24, v35
    v_mul_f32 v25, v25, v35
    v_mul_f32 v26, v26, v35
    v_mul_f32 v27, v27, v35
    v_mul_f32 v28, v28, v35
    v_mul_f32 v29, v29, v35
    v_mul_f32 v30, v30, v35
    v_mul_f32 v31, v31, v35
    v_cvt_pk_bf16_f32 v4, v16, v17
    v_cvt_pk_bf16_f32 v5, v18, v19
    v_cvt_pk_bf16_f32 v6, v20, v21
    v_cvt_pk_bf16_f32 v7, v22, v23
    v_cvt_pk_bf16_f32 v8, v24, v25
    v_cvt_pk_bf16_f32 v9, v26, v27
    v_cvt_pk_bf16_f32 v10, v28, v29
    v_cvt_pk_bf16_f32 v11, v30, v31
    buffer_store_dwordx4 v[4:7], v1, s[12:15], 0 offen
    buffer_store_dwordx4 v[8:11], v1, s[12:15], 0 offen offset:1024
.ln_b_kernel_done:
    s_endpgm
.section .rodata,"a"
.p2align 6
.amdhsa_kernel ln_b_kernel
  .amdhsa_next_free_vgpr 40
  .amdhsa_next_free_sgpr 24
  .amdhsa_accum_offset 40
  .amdhsa_group_segment_fixed_size 0
  .amdhsa_kernarg_size 120
  .amdhsa_user_sgpr_count 2
  .amdhsa_user_sgpr_kernarg_segment_ptr 1
  .amdhsa_system_sgpr_workgroup_id_x 1
.end_amdhsa_kernel
.text
.globl ln_c_kernel
.p2align 8
.type ln_c_kernel,@function
ln_c_kernel:
    s_cmp_ge_u32 s2, 512
    s_cbranch_scc1 .ln_c_kernel_done
    s_load_dwordx2 s[4:5], s[0:1], 112
    s_load_dwordx2 s[6:7], s[0:1], 112
    s_waitcnt lgkmcnt(0)
    s_add_u32 s4, s4, 0x800000
    s_addc_u32 s5, s5, 0
    s_add_u32 s6, s6, 0x0
    s_addc_u32 s7, s7, 0
    s_mov_b32 s8, s4
    s_and_b32 s9, s5, 0xffff
    s_mov_b32 s10, 0x400000
    s_mov_b32 s11, 0x00020000
    s_mov_b32 s12, s6
    s_and_b32 s13, s7, 0xffff
    s_mov_b32 s14, 0x400000
    s_mov_b32 s15, 0x00020000
    v_lshrrev_b32 v1, 6, v0
    v_and_b32 v2, 63, v0
    s_lshl_b32 s3, s2, 2
    v_add_u32 v1, s3, v1
    v_lshlrev_b32 v1, 11, v1
    v_lshlrev_b32 v2, 4, v2
    v_add_u32 v1, v1, v2
    buffer_load_dwordx4 v[4:7], v1, s[8:11], 0 offen
    buffer_load_dwordx4 v[8:11], v1, s[8:11], 0 offen offset:1024
    s_waitcnt vmcnt(0)
    v_lshlrev_b32 v16, 16, v4
    v_and_b32 v17, 0xffff0000, v4
    v_lshlrev_b32 v18, 16, v5
    v_and_b32 v19, 0xffff0000, v5
    v_lshlrev_b32 v20, 16, v6
    v_and_b32 v21, 0xffff0000, v6
    v_lshlrev_b32 v22, 16, v7
    v_and_b32 v23, 0xffff0000, v7
    v_lshlrev_b32 v24, 16, v8
    v_and_b32 v25, 0xffff0000, v8
    v_lshlrev_b32 v26, 16, v9
    v_and_b32 v27, 0xffff0000, v9
    v_lshlrev_b32 v28, 16, v10
    v_and_b32 v29, 0xffff0000, v10
    v_lshlrev_b32 v30, 16, v11
    v_and_b32 v31, 0xffff0000, v11
    v_add_f32 v32, v16, v17
    v_add_f32 v32, v32, v18
    v_add_f32 v32, v32, v19
    v_add_f32 v32, v32, v20
    v_add_f32 v32, v32, v21
    v_add_f32 v32, v32, v22
    v_add_f32 v32, v32, v23
    v_add_f32 v32, v32, v24
    v_add_f32 v32, v32, v25
    v_add_f32 v32, v32, v26
    v_add_f32 v32, v32, v27
    v_add_f32 v32, v32, v28
    v_add_f32 v32, v32, v29
    v_add_f32 v32, v32, v30
    v_add_f32 v32, v32, v31
    ds_swizzle_b32 v33, v32 offset:0x41f
    s_waitcnt lgkmcnt(0)
    v_add_f32 v32, v32, v33
    ds_swizzle_b32 v33, v32 offset:0x81f
    s_waitcnt lgkmcnt(0)
    v_add_f32 v32, v32, v33
    ds_swizzle_b32 v33, v32 offset:0x101f
    s_waitcnt lgkmcnt(0)
    v_add_f32 v32, v32, v33
    ds_swizzle_b32 v33, v32 offset:0x201f
    s_waitcnt lgkmcnt(0)
    v_add_f32 v32, v32, v33
    ds_swizzle_b32 v33, v32 offset:0x401f
    s_waitcnt lgkmcnt(0)
    v_add_f32 v32, v32, v33
    v_mov_b32 v33, v32
    s_nop 1
    v_permlane32_swap_b32 v32, v33
    s_nop 1
    v_add_f32 v32, v32, v33
    v_mul_f32 v32, 0x3a800000, v32
    v_sub_f32 v16, v16, v32
    v_sub_f32 v17, v17, v32
    v_sub_f32 v18, v18, v32
    v_sub_f32 v19, v19, v32
    v_sub_f32 v20, v20, v32
    v_sub_f32 v21, v21, v32
    v_sub_f32 v22, v22, v32
    v_sub_f32 v23, v23, v32
    v_sub_f32 v24, v24, v32
    v_sub_f32 v25, v25, v32
    v_sub_f32 v26, v26, v32
    v_sub_f32 v27, v27, v32
    v_sub_f32 v28, v28, v32
    v_sub_f32 v29, v29, v32
    v_sub_f32 v30, v30, v32
    v_sub_f32 v31, v31, v32
    v_mul_f32 v34, v16, v16
    v_fmac_f32 v34, v17, v17
    v_fmac_f32 v34, v18, v18
    v_fmac_f32 v34, v19, v19
    v_fmac_f32 v34, v20, v20
    v_fmac_f32 v34, v21, v21
    v_fmac_f32 v34, v22, v22
    v_fmac_f32 v34, v23, v23
    v_fmac_f32 v34, v24, v24
    v_fmac_f32 v34, v25, v25
    v_fmac_f32 v34, v26, v26
    v_fmac_f32 v34, v27, v27
    v_fmac_f32 v34, v28, v28
    v_fmac_f32 v34, v29, v29
    v_fmac_f32 v34, v30, v30
    v_fmac_f32 v34, v31, v31
    ds_swizzle_b32 v33, v34 offset:0x41f
    s_waitcnt lgkmcnt(0)
    v_add_f32 v34, v34, v33
    ds_swizzle_b32 v33, v34 offset:0x81f
    s_waitcnt lgkmcnt(0)
    v_add_f32 v34, v34, v33
    ds_swizzle_b32 v33, v34 offset:0x101f
    s_waitcnt lgkmcnt(0)
    v_add_f32 v34, v34, v33
    ds_swizzle_b32 v33, v34 offset:0x201f
    s_waitcnt lgkmcnt(0)
    v_add_f32 v34, v34, v33
    ds_swizzle_b32 v33, v34 offset:0x401f
    s_waitcnt lgkmcnt(0)
    v_add_f32 v34, v34, v33
    v_mov_b32 v33, v34
    s_nop 1
    v_permlane32_swap_b32 v34, v33
    s_nop 1
    v_add_f32 v34, v34, v33
    v_mov_b32 v35, 0x3727c5ac
    v_fmac_f32 v35, 0x3a800000, v34
    v_rsq_f32 v35, v35
    s_nop 0
    v_mul_f32 v16, v16, v35
    v_mul_f32 v17, v17, v35
    v_mul_f32 v18, v18, v35
    v_mul_f32 v19, v19, v35
    v_mul_f32 v20, v20, v35
    v_mul_f32 v21, v21, v35
    v_mul_f32 v22, v22, v35
    v_mul_f32 v23, v23, v35
    v_mul_f32 v24, v24, v35
    v_mul_f32 v25, v25, v35
    v_mul_f32 v26, v26, v35
    v_mul_f32 v27, v27, v35
    v_mul_f32 v28, v28, v35
    v_mul_f32 v29, v29, v35
    v_mul_f32 v30, v30, v35
    v_mul_f32 v31, v31, v35
    v_cvt_pk_bf16_f32 v4, v16, v17
    v_cvt_pk_bf16_f32 v5, v18, v19
    v_cvt_pk_bf16_f32 v6, v20, v21
    v_cvt_pk_bf16_f32 v7, v22, v23
    v_cvt_pk_bf16_f32 v8, v24, v25
    v_cvt_pk_bf16_f32 v9, v26, v27
    v_cvt_pk_bf16_f32 v10, v28, v29
    v_cvt_pk_bf16_f32 v11, v30, v31
    buffer_store_dwordx4 v[4:7], v1, s[12:15], 0 offen
    buffer_store_dwordx4 v[8:11], v1, s[12:15], 0 offen offset:1024
.ln_c_kernel_done:
    s_endpgm
.section .rodata,"a"
.p2align 6
.amdhsa_kernel ln_c_kernel
  .amdhsa_next_free_vgpr 40
  .amdhsa_next_free_sgpr 24
  .amdhsa_accum_offset 40
  .amdhsa_group_segment_fixed_size 0
  .amdhsa_kernarg_size 120
  .amdhsa_user_sgpr_count 2
  .amdhsa_user_sgpr_kernarg_segment_ptr 1
  .amdhsa_system_sgpr_workgroup_id_x 1
.end_amdhsa_kernel
.text
.globl gemm_qkv_kernel
.p2align 8
.type gemm_qkv_kernel,@function
gemm_qkv_kernel:
    s_cmp_ge_u32 s2, 768
    s_cbranch_scc1 .gemm_qkv_kernel_done
    s_load_dwordx2 s[6:7], s[0:1], 112
    s_load_dwordx2 s[28:29], s[0:1], 16
    s_load_dwordx2 s[30:31], s[0:1], 24
    s_load_dwordx2 s[32:33], s[0:1], 32
    s_and_b32 s40, s2, 7
    s_lshr_b32 s41, s2, 3
    s_waitcnt lgkmcnt(0)
    s_add_u32 s4, s6, 0x0
    s_addc_u32 s5, s7, 0
    s_mov_b32 s8, s4
    s_and_b32 s9, s5, 0xffff
    s_mov_b32 s10, 0x400000
    s_mov_b32 s11, 0x00020000
    s_mul_i32 s42, s41, 128
    s_mov_b32 s4, s28
    s_mov_b32 s5, s29
    s_cmp_ge_u32 s42, 4096
    s_cselect_b32 s4, s30, s4
    s_cselect_b32 s5, s31, s5
    s_cmp_ge_u32 s42, 8192
    s_cselect_b32 s4, s32, s4
    s_cselect_b32 s5, s33, s5
    s_and_b32 s43, s42, 4095
    s_mov_b32 s12, s4
    s_and_b32 s13, s5, 0xffff
    s_mov_b32 s14, 0x800000
    s_mov_b32 s15, 0x00020000
    s_mul_i32 s44, s40, 524288
    s_lshl_b32 s45, s43, 1
    v_and_b32 v1, 63, v0
    v_lshrrev_b32 v2, 6, v0
    s_nop 0
    v_readfirstlane_b32 s46, v2
    v_lshrrev_b32 v3, 3, v1
    v_and_b32 v4, 7, v1
    v_xor_b32 v4, v4, v3
    v_lshlrev_b32 v4, 4, v4
    s_mov_b32 s47, 2048
    v_mul_lo_u32 v3, v3, s47
    v_add_u32 v10, v3, v4
    v_lshrrev_b32 v3, 4, v1
    v_and_b32 v4, 15, v1
    v_lshlrev_b32 v5, 2, v3
    v_xor_b32 v4, v4, v5
    v_lshlrev_b32 v4, 4, v4
    s_mov_b32 s47, 8192
    v_mul_lo_u32 v3, v3, s47
    v_add_u32 v11, v3, v4
    s_mul_i32 s48, s46, 131072
    s_add_u32 s44, s44, s48
    s_mul_i32 s48, s46, 131072
    s_add_u32 s45, s45, s48
    s_mul_i32 s49, s46, 8192
    s_mul_i32 s50, s46, 4096
    s_add_u32 s50, s50, 32768
    v_lshrrev_b32 v3, 1, v2
    v_and_b32 v4, 1, v2
    v_and_b32 v5, 31, v1
    v_lshrrev_b32 v6, 5, v1
    v_mul_u32_u24 v7, 128, v3
    v_add_u32 v7, v7, v5
    v_lshlrev_b32 v7, 7, v7
    v_and_b32 v8, 7, v1
    v_xor_b32 v8, v8, v6
    v_lshlrev_b32 v8, 4, v8
    v_add_u32 v12, v7, v8
    v_xor_b32 v13, 32, v12
    v_xor_b32 v14, 64, v12
    v_xor_b32 v15, 96, v12
    v_lshrrev_b32 v7, 4, v1
    v_and_b32 v7, 1, v7
    v_lshrrev_b32 v8, 2, v1
    v_and_b32 v8, 3, v8
    v_and_b32 v9, 3, v1
    v_mul_u32_u24 v16, 8, v4
    v_lshl_add_u32 v16, v7, 1, v16
    v_lshrrev_b32 v17, 1, v9
    v_add_u32 v16, v16, v17
    v_lshlrev_b32 v17, 2, v8
    v_lshl_add_u32 v18, v6, 3, v8
    v_mul_u32_u24 v18, 256, v18
    v_and_b32 v19, 1, v9
    v_lshl_add_u32 v18, v19, 3, v18
    v_add_u32 v18, 32768, v18
    v_add_u32 v19, 0, v16
    v_xor_b32 v19, v19, v17
    v_lshl_add_u32 v20, v19, 4, v18
    v_add_u32 v19, 4, v16
    v_xor_b32 v19, v19, v17
    v_lshl_add_u32 v21, v19, 4, v18
    v_mov_b32 v128, 0
    v_mov_b32 v129, 0
    v_mov_b32 v130, 0
    v_mov_b32 v131, 0
    v_mov_b32 v132, 0
    v_mov_b32 v133, 0
    v_mov_b32 v134, 0
    v_mov_b32 v135, 0
    v_mov_b32 v136, 0
    v_mov_b32 v137, 0
    v_mov_b32 v138, 0
    v_mov_b32 v139, 0
    v_mov_b32 v140, 0
    v_mov_b32 v141, 0
    v_mov_b32 v142, 0
    v_mov_b32 v143, 0
    v_mov_b32 v144, 0
    v_mov_b32 v145, 0
    v_mov_b32 v146, 0
    v_mov_b32 v147, 0
    v_mov_b32 v148, 0
    v_mov_b32 v149, 0
    v_mov_b32 v150, 0
    v_mov_b32 v151, 0
    v_mov_b32 v152, 0
    v_mov_b32 v153, 0
    v_mov_b32 v154, 0
    v_mov_b32 v155, 0
    v_mov_b32 v156, 0
    v_mov_b32 v157, 0
    v_mov_b32 v158, 0
    v_mov_b32 v159, 0
    v_mov_b32 v160, 0
    v_mov_b32 v161, 0
    v_mov_b32 v162, 0
    v_mov_b32 v163, 0
    v_mov_b32 v164, 0
    v_mov_b32 v165, 0
    v_mov_b32 v166, 0
    v_mov_b32 v167, 0
    v_mov_b32 v168, 0
    v_mov_b32 v169, 0
    v_mov_b32 v170, 0
    v_mov_b32 v171, 0
    v_mov_b32 v172, 0
    v_mov_b32 v173, 0
    v_mov_b32 v174, 0
    v_mov_b32 v175, 0
    v_mov_b32 v176, 0
    v_mov_b32 v177, 0
    v_mov_b32 v178, 0
    v_mov_b32 v179, 0
    v_mov_b32 v180, 0
    v_mov_b32 v181, 0
    v_mov_b32 v182, 0
    v_mov_b32 v183, 0
    v_mov_b32 v184, 0
    v_mov_b32 v185, 0
    v_mov_b32 v186, 0
    v_mov_b32 v187, 0
    v_mov_b32 v188, 0
    v_mov_b32 v189, 0
    v_mov_b32 v190, 0
    v_mov_b32 v191, 0
    v_mov_b32 v192, 0
    v_mov_b32 v193, 0
    v_mov_b32 v194, 0
    v_mov_b32 v195, 0
    v_mov_b32 v196, 0
    v_mov_b32 v197, 0
    v_mov_b32 v198, 0
    v_mov_b32 v199, 0
    v_mov_b32 v200, 0
    v_mov_b32 v201, 0
    v_mov_b32 v202, 0
    v_mov_b32 v203, 0
    v_mov_b32 v204, 0
    v_mov_b32 v205, 0
    v_mov_b32 v206, 0
    v_mov_b32 v207, 0
    v_mov_b32 v208, 0
    v_mov_b32 v209, 0
    v_mov_b32 v210, 0
    v_mov_b32 v211, 0
    v_mov_b32 v212, 0
    v_mov_b32 v213, 0
    v_mov_b32 v214, 0
    v_mov_b32 v215, 0
    v_mov_b32 v216, 0
    v_mov_b32 v217, 0
    v_mov_b32 v218, 0
    v_mov_b32 v219, 0
    v_mov_b32 v220, 0
    v_mov_b32 v221, 0
    v_mov_b32 v222, 0
    v_mov_b32 v223, 0
    v_mov_b32 v224, 0
    v_mov_b32 v225, 0
    v_mov_b32 v226, 0
    v_mov_b32 v227, 0
    v_mov_b32 v228, 0
    v_mov_b32 v229, 0
    v_mov_b32 v230, 0
    v_mov_b32 v231, 0
    v_mov_b32 v232, 0
    v_mov_b32 v233, 0
    v_mov_b32 v234, 0
    v_mov_b32 v235, 0
    v_mov_b32 v236, 0
    v_mov_b32 v237, 0
    v_mov_b32 v238, 0
    v_mov_b32 v239, 0
    v_mov_b32 v240, 0
    v_mov_b32 v241, 0
    v_mov_b32 v242, 0
    v_mov_b32 v243, 0
    v_mov_b32 v244, 0
    v_mov_b32 v245, 0
    v_mov_b32 v246, 0
    v_mov_b32 v247, 0
    v_mov_b32 v248, 0
    v_mov_b32 v249, 0
    v_mov_b32 v250, 0
    v_mov_b32 v251, 0
    v_mov_b32 v252, 0
    v_mov_b32 v253, 0
    v_mov_b32 v254, 0
    v_mov_b32 v255, 0
    s_mov_b32 s51, 0
    s_add_u32 s52, s51, s49
    s_mov_b32 m0, s52
    s_add_u32 s53, s44, 0
    buffer_load_dwordx4 v10, s[8:11], s53 offen lds
    s_add_u32 s52, s51, s49
    s_add_u32 s52, s52, 1024
    s_mov_b32 m0, s52
    s_add_u32 s53, s44, 16384
    buffer_load_dwordx4 v10, s[8:11], s53 offen lds
    s_add_u32 s52, s51, s49
    s_add_u32 s52, s52, 2048
    s_mov_b32 m0, s52
    s_add_u32 s53, s44, 32768
    buffer_load_dwordx4 v10, s[8:11], s53 offen lds
    s_add_u32 s52, s51, s49
    s_add_u32 s52, s52, 3072
    s_mov_b32 m0, s52
    s_add_u32 s53, s44, 49152
    buffer_load_dwordx4 v10, s[8:11], s53 offen lds
    s_add_u32 s52, s51, s49
    s_add_u32 s52, s52, 4096
    s_mov_b32 m0, s52
    s_add_u32 s53, s44, 65536
    buffer_load_dwordx4 v10, s[8:11], s53 offen lds
    s_add_u32 s52, s51, s49
    s_add_u32 s52, s52, 5120
    s_mov_b32 m0, s52
    s_add_u32 s53, s44, 81920
    buffer_load_dwordx4 v10, s[8:11], s53 offen lds
    s_add_u32 s52, s51, s49
    s_add_u32 s52, s52, 6144
    s_mov_b32 m0, s52
    s_add_u32 s53, s44, 98304
    buffer_load_dwordx4 v10, s[8:11], s53 offen lds
    s_add_u32 s52, s51, s49
    s_add_u32 s52, s52, 7168
    s_mov_b32 m0, s52
    s_add_u32 s53, s44, 114688
    buffer_load_dwordx4 v10, s[8:11], s53 offen lds
    s_add_u32 s52, s51, s50
    s_mov_b32 m0, s52
    s_add_u32 s53, s45, 0
    buffer_load_dwordx4 v11, s[12:15], s53 offen lds
    s_add_u32 s52, s51, s50
    s_add_u32 s52, s52, 1024
    s_mov_b32 m0, s52
    s_add_u32 s53, s45, 32768
    buffer_load_dwordx4 v11, s[12:15], s53 offen lds
    s_add_u32 s52, s51, s50
    s_add_u32 s52, s52, 2048
    s_mov_b32 m0, s52
    s_add_u32 s53, s45, 65536
    buffer_load_dwordx4 v11, s[12:15], s53 offen lds
    s_add_u32 s52, s51, s50
    s_add_u32 s52, s52, 3072
    s_mov_b32 m0, s52
    s_add_u32 s53, s45, 98304
    buffer_load_dwordx4 v11, s[12:15], s53 offen lds
    s_add_u32 s44, s44, 128
    s_add_u32 s45, s45, 524288
    s_add_u32 s51, s51, 49152
    s_cmp_eq_u32 s51, 147456
    s_cselect_b32 s51, 0, s51
    s_add_u32 s52, s51, s49
    s_mov_b32 m0, s52
    s_add_u32 s53, s44, 0
    buffer_load_dwordx4 v10, s[8:11], s53 offen lds
    s_add_u32 s52, s51, s49
    s_add_u32 s52, s52, 1024
    s_mov_b32 m0, s52
    s_add_u32 s53, s44, 16384
    buffer_load_dwordx4 v10, s[8:11], s53 offen lds
    s_add_u32 s52, s51, s49
    s_add_u32 s52, s52, 2048
    s_mov_b32 m0, s52
    s_add_u32 s53, s44, 32768
    buffer_load_dwordx4 v10, s[8:11], s53 offen lds
    s_add_u32 s52, s51, s49
    s_add_u32 s52, s52, 3072
    s_mov_b32 m0, s52
    s_add_u32 s53, s44, 49152
    buffer_load_dwordx4 v10, s[8:11], s53 offen lds
    s_add_u32 s52, s51, s49
    s_add_u32 s52, s52, 4096
    s_mov_b32 m0, s52
    s_add_u32 s53, s44, 65536
    buffer_load_dwordx4 v10, s[8:11], s53 offen lds
    s_add_u32 s52, s51, s49
    s_add_u32 s52, s52, 5120
    s_mov_b32 m0, s52
    s_add_u32 s53, s44, 81920
    buffer_load_dwordx4 v10, s[8:11], s53 offen lds
    s_add_u32 s52, s51, s49
    s_add_u32 s52, s52, 6144
    s_mov_b32 m0, s52
    s_add_u32 s53, s44, 98304
    buffer_load_dwordx4 v10, s[8:11], s53 offen lds
    s_add_u32 s52, s51, s49
    s_add_u32 s52, s52, 7168
    s_mov_b32 m0, s52
    s_add_u32 s53, s44, 114688
    buffer_load_dwordx4 v10, s[8:11], s53 offen lds
    s_add_u32 s52, s51, s50
    s_mov_b32 m0, s52
    s_add_u32 s53, s45, 0
    buffer_load_dwordx4 v11, s[12:15], s53 offen lds
    s_add_u32 s52, s51, s50
    s_add_u32 s52, s52, 1024
    s_mov_b32 m0, s52
    s_add_u32 s53, s45, 32768
    buffer_load_dwordx4 v11, s[12:15], s53 offen lds
    s_add_u32 s52, s51, s50
    s_add_u32 s52, s52, 2048
    s_mov_b32 m0, s52
    s_add_u32 s53, s45, 65536
    buffer_load_dwordx4 v11, s[12:15], s53 offen lds
    s_add_u32 s52, s51, s50
    s_add_u32 s52, s52, 3072
    s_mov_b32 m0, s52
    s_add_u32 s53, s45, 98304
    buffer_load_dwordx4 v11, s[12:15], s53 offen lds
    s_add_u32 s44, s44, 128
    s_add_u32 s45, s45, 524288
    s_add_u32 s51, s51, 49152
    s_cmp_eq_u32 s51, 147456
    s_cselect_b32 s51, 0, s51
    s_mov_b32 s54, 0
    s_mov_b32 s55, 0
.gemm_qkv_kernel_loop:
    s_waitcnt vmcnt(12)
    s_barrier
    v_add_u32 v24, s54, v12
    v_add_u32 v25, s54, v13
    v_add_u32 v26, s54, v14
    v_add_u32 v27, s54, v15
    v_add_u32 v28, s54, v20
    v_add_u32 v29, s54, v21
    ds_read_b128 v[32:35], v24 offset:0
    ds_read_b128 v[36:39], v24 offset:4096
    ds_read_b128 v[40:43], v24 offset:8192
    ds_read_b128 v[44:47], v24 offset:12288
    ds_read_b64_tr_b16 v[48:49], v28 offset:0
    ds_read_b64_tr_b16 v[50:51], v28 offset:1024
    ds_read_b64_tr_b16 v[52:53], v29 offset:0
    ds_read_b64_tr_b16 v[54:55], v29 offset:1024
    ds_read_b128 v[56:59], v25 offset:0
    ds_read_b128 v[60:63], v25 offset:4096
    ds_read_b128 v[64:67], v25 offset:8192
    ds_read_b128 v[68:71], v25 offset:12288
    ds_read_b64_tr_b16 v[72:73], v28 offset:4096
    ds_read_b64_tr_b16 v[74:75], v28 offset:5120
    ds_read_b64_tr_b16 v[76:77], v29 offset:4096
    ds_read_b64_tr_b16 v[78:79], v29 offset:5120
    s_waitcnt lgkmcnt(8)
    v_mfma_f32_32x32x16_bf16 v[128:143], v[48:51], v[32:35], v[128:143]
    s_add_u32 s52, s51, s49
    s_mov_b32 m0, s52
    s_add_u32 s53, s44, 0
    buffer_load_dwordx4 v10, s[8:11], s53 offen lds
    v_mfma_f32_32x32x16_bf16 v[144:159], v[52:55], v[32:35], v[144:159]
    v_mfma_f32_32x32x16_bf16 v[160:175], v[48:51], v[36:39], v[160:175]
    s_add_u32 s52, s51, s49
    s_add_u32 s52, s52, 1024
    s_mov_b32 m0, s52
    s_add_u32 s53, s44, 16384
    buffer_load_dwordx4 v10, s[8:11], s53 offen lds
    v_mfma_f32_32x32x16_bf16 v[176:191], v[52:55], v[36:39], v[176:191]
    v_mfma_f32_32x32x16_bf16 v[192:207], v[48:51], v[40:43], v[192:207]
    v_mfma_f32_32x32x16_bf16 v[208:223], v[52:55], v[40:43], v[208:223]
    s_add_u32 s52, s51, s49
    s_add_u32 s52, s52, 2048
    s_mov_b32 m0, s52
    s_add_u32 s53, s44, 32768
    buffer_load_dwordx4 v10, s[8:11], s53 offen lds
    v_mfma_f32_32x32x16_bf16 v[224:239], v[48:51], v[44:47], v[224:239]
    v_mfma_f32_32x32x16_bf16 v[240:255], v[52:55], v[44:47], v[240:255]
    ds_read_b128 v[32:35], v26 offset:0
    ds_read_b128 v[36:39], v26 offset:4096
    ds_read_b128 v[40:43], v26 offset:8192
    ds_read_b128 v[44:47], v26 offset:12288
    ds_read_b64_tr_b16 v[48:49], v28 offset:8192
    ds_read_b64_tr_b16 v[50:51], v28 offset:9216
    ds_read_b64_tr_b16 v[52:53], v29 offset:8192
    ds_read_b64_tr_b16 v[54:55], v29 offset:9216
    s_waitcnt lgkmcnt(8)
    v_mfma_f32_32x32x16_bf16 v[128:143], v[72:75], v[56:59], v[128:143]
    s_add_u32 s52, s51, s49
    s_add_u32 s52, s52, 3072
    s_mov_b32 m0, s52
    s_add_u32 s53, s44, 49152
    buffer_load_dwordx4 v10, s[8:11], s53 offen lds
    v_mfma_f32_32x32x16_bf16 v[144:159], v[76:79], v[56:59], v[144:159]
    v_mfma_f32_32x32x16_bf16 v[160:175], v[72:75], v[60:63], v[160:175]
    s_add_u32 s52, s51, s49
    s_add_u32 s52, s52, 4096
    s_mov_b32 m0, s52
    s_add_u32 s53, s44, 65536
    buffer_load_dwordx4 v10, s[8:11], s53 offen lds
    v_mfma_f32_32x32x16_bf16 v[176:191], v[76:79], v[60:63], v[176:191]
    v_mfma_f32_32x32x16_bf16 v[192:207], v[72:75], v[64:67], v[192:207]
    v_mfma_f32_32x32x16_bf16 v[208:223], v[76:79], v[64:67], v[208:223]
    s_add_u32 s52, s51, s49
    s_add_u32 s52, s52, 5120
    s_mov_b32 m0, s52
    s_add_u32 s53, s44, 81920
    buffer_load_dwordx4 v10, s[8:11], s53 offen lds
    v_mfma_f32_32x32x16_bf16 v[224:239], v[72:75], v[68:71], v[224:239]
    v_mfma_f32_32x32x16_bf16 v[240:255], v[76:79], v[68:71], v[240:255]
    ds_read_b128 v[56:59], v27 offset:0
    ds_read_b128 v[60:63], v27 offset:4096
    ds_read_b128 v[64:67], v27 offset:8192
    ds_read_b128 v[68:71], v27 offset:12288
    ds_read_b64_tr_b16 v[72:73], v28 offset:12288
    ds_read_b64_tr_b16 v[74:75], v28 offset:13312
    ds_read_b64_tr_b16 v[76:77], v29 offset:12288
    ds_read_b64_tr_b16 v[78:79], v29 offset:13312
    s_waitcnt lgkmcnt(8)
    v_mfma_f32_32x32x16_bf16 v[128:143], v[48:51], v[32:35], v[128:143]
    s_add_u32 s52, s51, s49
    s_add_u32 s52, s52, 6144
    s_mov_b32 m0, s52
    s_add_u32 s53, s44, 98304
    buffer_load_dwordx4 v10, s[8:11], s53 offen lds
    v_mfma_f32_32x32x16_bf16 v[144:159], v[52:55], v[32:35], v[144:159]
    v_mfma_f32_32x32x16_bf16 v[160:175], v[48:51], v[36:39], v[160:175]
    s_add_u32 s52, s51, s49
    s_add_u32 s52, s52, 7168
    s_mov_b32 m0, s52
    s_add_u32 s53, s44, 114688
    buffer_load_dwordx4 v10, s[8:11], s53 offen lds
    v_mfma_f32_32x32x16_bf16 v[176:191], v[52:55], v[36:39], v[176:191]
    v_mfma_f32_32x32x16_bf16 v[192:207], v[48:51], v[40:43], v[192:207]
    v_mfma_f32_32x32x16_bf16 v[208:223], v[52:55], v[40:43], v[208:223]
    s_add_u32 s52, s51, s50
    s_mov_b32 m0, s52
    s_add_u32 s53, s45, 0
    buffer_load_dwordx4 v11, s[12:15], s53 offen lds
    v_mfma_f32_32x32x16_bf16 v[224:239], v[48:51], v[44:47], v[224:239]
    v_mfma_f32_32x32x16_bf16 v[240:255], v[52:55], v[44:47], v[240:255]
    s_waitcnt lgkmcnt(0)
    v_mfma_f32_32x32x16_bf16 v[128:143], v[72:75], v[56:59], v[128:143]
    s_add_u32 s52, s51, s50
    s_add_u32 s52, s52, 1024
    s_mov_b32 m0, s52
    s_add_u32 s53, s45, 32768
    buffer_load_dwordx4 v11, s[12:15], s53 offen lds
    v_mfma_f32_32x32x16_bf16 v[144:159], v[76:79], v[56:59], v[144:159]
    v_mfma_f32_32x32x16_bf16 v[160:175], v[72:75], v[60:63], v[160:175]
    s_add_u32 s52, s51, s50
    s_add_u32 s52, s52, 2048
    s_mov_b32 m0, s52
    s_add_u32 s53, s45, 65536
    buffer_load_dwordx4 v11, s[12:15], s53 offen lds
    v_mfma_f32_32x32x16_bf16 v[176:191], v[76:79], v[60:63], v[176:191]
    v_mfma_f32_32x32x16_bf16 v[192:207], v[72:75], v[64:67], v[192:207]
    v_mfma_f32_32x32x16_bf16 v[208:223], v[76:79], v[64:67], v[208:223]
    s_add_u32 s52, s51, s50
    s_add_u32 s52, s52, 3072
    s_mov_b32 m0, s52
    s_add_u32 s53, s45, 98304
    buffer_load_dwordx4 v11, s[12:15], s53 offen lds
    v_mfma_f32_32x32x16_bf16 v[224:239], v[72:75], v[68:71], v[224:239]
    v_mfma_f32_32x32x16_bf16 v[240:255], v[76:79], v[68:71], v[240:255]
    s_add_u32 s44, s44, 128
    s_add_u32 s45, s45, 524288
    s_add_u32 s51, s51, 49152
    s_cmp_eq_u32 s51, 147456
    s_cselect_b32 s51, 0, s51
    s_add_u32 s54, s54, 49152
    s_cmp_eq_u32 s54, 147456
    s_cselect_b32 s54, 0, s54
    s_add_u32 s55, s55, 1
    s_cmp_lt_u32 s55, 16
    s_cbranch_scc1 .gemm_qkv_kernel_loop
    s_waitcnt vmcnt(0)
    s_nop 15
    s_nop 15
    s_add_u32 s4, s6, 0x1000000
    s_addc_u32 s5, s7, 0
    s_mov_b32 s16, s4
    s_and_b32 s17, s5, 0xffff
    s_mov_b32 s18, 0x3000000
    s_mov_b32 s19, 0x00020000
    s_mul_i32 s4, s40, 256
    v_mul_u32_u24 v7, 128, v3
    v_add_u32 v7, v7, v5
    v_add_u32 v7, s4, v7
    s_mov_b32 s47, 24576
    v_mul_lo_u32 v7, v7, s47
    v_mul_u32_u24 v8, 64, v4
    v_lshl_add_u32 v8, v6, 2, v8
    v_add_u32 v8, s42, v8
    v_lshlrev_b32 v8, 1, v8
    v_add_u32 v7, v7, v8
    s_mov_b32 s4, 0
    s_waitcnt vmcnt(0)
    v_cvt_pk_bf16_f32 v32, v128, v129
    v_cvt_pk_bf16_f32 v33, v130, v131
    buffer_store_dwordx2 v[32:33], v7, s[16:19], s4 offen offset:0
    s_nop 1
    v_cvt_pk_bf16_f32 v32, v132, v133
    v_cvt_pk_bf16_f32 v33, v134, v135
    buffer_store_dwordx2 v[32:33], v7, s[16:19], s4 offen offset:16
    s_nop 1
    v_cvt_pk_bf16_f32 v32, v136, v137
    v_cvt_pk_bf16_f32 v33, v138, v139
    buffer_store_dwordx2 v[32:33], v7, s[16:19], s4 offen offset:32
    s_nop 1
    v_cvt_pk_bf16_f32 v32, v140, v141
    v_cvt_pk_bf16_f32 v33, v142, v143
    buffer_store_dwordx2 v[32:33], v7, s[16:19], s4 offen offset:48
    s_nop 1
    s_mov_b32 s4, 786432
    s_waitcnt vmcnt(0)
    v_cvt_pk_bf16_f32 v32, v160, v161
    v_cvt_pk_bf16_f32 v33, v162, v163
    buffer_store_dwordx2 v[32:33], v7, s[16:19], s4 offen offset:0
    s_nop 1
    v_cvt_pk_bf16_f32 v32, v164, v165
    v_cvt_pk_bf16_f32 v33, v166, v167
    buffer_store_dwordx2 v[32:33], v7, s[16:19], s4 offen offset:16
    s_nop 1
    v_cvt_pk_bf16_f32 v32, v168, v169
    v_cvt_pk_bf16_f32 v33, v170, v171
    buffer_store_dwordx2 v[32:33], v7, s[16:19], s4 offen offset:32
    s_nop 1
    v_cvt_pk_bf16_f32 v32, v172, v173
    v_cvt_pk_bf16_f32 v33, v174, v175
    buffer_store_dwordx2 v[32:33], v7, s[16:19], s4 offen offset:48
    s_nop 1
    s_mov_b32 s4, 1572864
    s_waitcnt vmcnt(0)
    v_cvt_pk_bf16_f32 v32, v192, v193
    v_cvt_pk_bf16_f32 v33, v194, v195
    buffer_store_dwordx2 v[32:33], v7, s[16:19], s4 offen offset:0
    s_nop 1
    v_cvt_pk_bf16_f32 v32, v196, v197
    v_cvt_pk_bf16_f32 v33, v198, v199
    buffer_store_dwordx2 v[32:33], v7, s[16:19], s4 offen offset:16
    s_nop 1
    v_cvt_pk_bf16_f32 v32, v200, v201
    v_cvt_pk_bf16_f32 v33, v202, v203
    buffer_store_dwordx2 v[32:33], v7, s[16:19], s4 offen offset:32
    s_nop 1
    v_cvt_pk_bf16_f32 v32, v204, v205
    v_cvt_pk_bf16_f32 v33, v206, v207
    buffer_store_dwordx2 v[32:33], v7, s[16:19], s4 offen offset:48
    s_nop 1
    s_mov_b32 s4, 2359296
    s_waitcnt vmcnt(0)
    v_cvt_pk_bf16_f32 v32, v224, v225
    v_cvt_pk_bf16_f32 v33, v226, v227
    buffer_store_dwordx2 v[32:33], v7, s[16:19], s4 offen offset:0
    s_nop 1
    v_cvt_pk_bf16_f32 v32, v228, v229
    v_cvt_pk_bf16_f32 v33, v230, v231
    buffer_store_dwordx2 v[32:33], v7, s[16:19], s4 offen offset:16
    s_nop 1
    v_cvt_pk_bf16_f32 v32, v232, v233
    v_cvt_pk_bf16_f32 v33, v234, v235
    buffer_store_dwordx2 v[32:33], v7, s[16:19], s4 offen offset:32
    s_nop 1
    v_cvt_pk_bf16_f32 v32, v236, v237
    v_cvt_pk_bf16_f32 v33, v238, v239
    buffer_store_dwordx2 v[32:33], v7, s[16:19], s4 offen offset:48
    s_nop 1
    s_mov_b32 s4, 0
    s_waitcnt vmcnt(0)
    v_cvt_pk_bf16_f32 v32, v144, v145
    v_cvt_pk_bf16_f32 v33, v146, v147
    buffer_store_dwordx2 v[32:33], v7, s[16:19], s4 offen offset:64
    s_nop 1
    v_cvt_pk_bf16_f32 v32, v148, v149
    v_cvt_pk_bf16_f32 v33, v150, v151
    buffer_store_dwordx2 v[32:33], v7, s[16:19], s4 offen offset:80
    s_nop 1
    v_cvt_pk_bf16_f32 v32, v152, v153
    v_cvt_pk_bf16_f32 v33, v154, v155
    buffer_store_dwordx2 v[32:33], v7, s[16:19], s4 offen offset:96
    s_nop 1
    v_cvt_pk_bf16_f32 v32, v156, v157
    v_cvt_pk_bf16_f32 v33, v158, v159
    buffer_store_dwordx2 v[32:33], v7, s[16:19], s4 offen offset:112
    s_nop 1
    s_mov_b32 s4, 786432
    s_waitcnt vmcnt(0)
    v_cvt_pk_bf16_f32 v32, v176, v177
    v_cvt_pk_bf16_f32 v33, v178, v179
    buffer_store_dwordx2 v[32:33], v7, s[16:19], s4 offen offset:64
    s_nop 1
    v_cvt_pk_bf16_f32 v32, v180, v181
    v_cvt_pk_bf16_f32 v33, v182, v183
    buffer_store_dwordx2 v[32:33], v7, s[16:19], s4 offen offset:80
    s_nop 1
    v_cvt_pk_bf16_f32 v32, v184, v185
    v_cvt_pk_bf16_f32 v33, v186, v187
    buffer_store_dwordx2 v[32:33], v7, s[16:19], s4 offen offset:96
    s_nop 1
    v_cvt_pk_bf16_f32 v32, v188, v189
    v_cvt_pk_bf16_f32 v33, v190, v191
    buffer_store_dwordx2 v[32:33], v7, s[16:19], s4 offen offset:112
    s_nop 1
    s_mov_b32 s4, 1572864
    s_waitcnt vmcnt(0)
    v_cvt_pk_bf16_f32 v32, v208, v209
    v_cvt_pk_bf16_f32 v33, v210, v211
    buffer_store_dwordx2 v[32:33], v7, s[16:19], s4 offen offset:64
    s_nop 1
    v_cvt_pk_bf16_f32 v32, v212, v213
    v_cvt_pk_bf16_f32 v33, v214, v215
    buffer_store_dwordx2 v[32:33], v7, s[16:19], s4 offen offset:80
    s_nop 1
    v_cvt_pk_bf16_f32 v32, v216, v217
    v_cvt_pk_bf16_f32 v33, v218, v219
    buffer_store_dwordx2 v[32:33], v7, s[16:19], s4 offen offset:96
    s_nop 1
    v_cvt_pk_bf16_f32 v32, v220, v221
    v_cvt_pk_bf16_f32 v33, v222, v223
    buffer_store_dwordx2 v[32:33], v7, s[16:19], s4 offen offset:112
    s_nop 1
    s_mov_b32 s4, 2359296
    s_waitcnt vmcnt(0)
    v_cvt_pk_bf16_f32 v32, v240, v241
    v_cvt_pk_bf16_f32 v33, v242, v243
    buffer_store_dwordx2 v[32:33], v7, s[16:19], s4 offen offset:64
    s_nop 1
    v_cvt_pk_bf16_f32 v32, v244, v245
    v_cvt_pk_bf16_f32 v33, v246, v247
    buffer_store_dwordx2 v[32:33], v7, s[16:19], s4 offen offset:80
    s_nop 1
    v_cvt_pk_bf16_f32 v32, v248, v249
    v_cvt_pk_bf16_f32 v33, v250, v251
    buffer_store_dwordx2 v[32:33], v7, s[16:19], s4 offen offset:96
    s_nop 1
    v_cvt_pk_bf16_f32 v32, v252, v253
    v_cvt_pk_bf16_f32 v33, v254, v255
    buffer_store_dwordx2 v[32:33], v7, s[16:19], s4 offen offset:112
    s_nop 1
.gemm_qkv_kernel_done:
    s_endpgm
.section .rodata,"a"
.p2align 6
.amdhsa_kernel gemm_qkv_kernel
  .amdhsa_next_free_vgpr 256
  .amdhsa_next_free_sgpr 64
  .amdhsa_accum_offset 256
  .amdhsa_group_segment_fixed_size 0
  .amdhsa_kernarg_size 120
  .amdhsa_user_sgpr_count 2
  .amdhsa_user_sgpr_kernarg_segment_ptr 1
  .amdhsa_system_sgpr_workgroup_id_x 1
.end_amdhsa_kernel
.text
.globl gemm_wo0_kernel
.p2align 8
.type gemm_wo0_kernel,@function
gemm_wo0_kernel:
    s_cmp_ge_u32 s2, 256
    s_cbranch_scc1 .gemm_wo0_kernel_done
    s_load_dwordx2 s[6:7], s[0:1], 112
    s_load_dwordx2 s[28:29], s[0:1], 40
    s_load_dwordx2 s[36:37], s[0:1], 0
    s_and_b32 s40, s2, 15
    s_lshr_b32 s41, s2, 4
    s_waitcnt lgkmcnt(0)
    s_add_u32 s4, s6, 0x4000000
    s_addc_u32 s5, s7, 0
    s_mov_b32 s8, s4
    s_and_b32 s9, s5, 0xffff
    s_mov_b32 s10, 0x1000000
    s_mov_b32 s11, 0x00020000
    s_mul_i32 s42, s41, 64
    s_mov_b32 s4, s28
    s_mov_b32 s5, s29
    s_mov_b32 s43, s42
    s_mov_b32 s12, s4
    s_and_b32 s13, s5, 0xffff
    s_mov_b32 s14, 0x800000
    s_mov_b32 s15, 0x00020000
    s_mul_i32 s44, s40, 1048576
    s_lshl_b32 s45, s43, 1
    v_and_b32 v1, 63, v0
    v_lshrrev_b32 v2, 6, v0
    s_nop 0
    v_readfirstlane_b32 s46, v2
    v_lshrrev_b32 v3, 3, v1
    v_and_b32 v4, 7, v1
    v_xor_b32 v4, v4, v3
    v_lshlrev_b32 v4, 4, v4
    s_mov_b32 s47, 8192
    v_mul_lo_u32 v3, v3, s47
    v_add_u32 v10, v3, v4
    v_lshrrev_b32 v3, 3, v1
    v_and_b32 v4, 7, v1
    v_lshrrev_b32 v5, 1, v3
    v_and_b32 v5, 1, v5
    v_lshlrev_b32 v5, 2, v5
    v_xor_b32 v4, v4, v5
    v_lshlrev_b32 v4, 4, v4
    s_mov_b32 s47, 2048
    v_mul_lo_u32 v3, v3, s47
    v_add_u32 v11, v3, v4
    s_mul_i32 s48, s46, 262144
    s_add_u32 s44, s44, s48
    s_mul_i32 s48, s46, 32768
    s_add_u32 s45, s45, s48
    s_mul_i32 s49, s46, 4096
    s_mul_i32 s50, s46, 2048
    s_add_u32 s50, s50, 16384
    v_lshrrev_b32 v3, 1, v2
    v_and_b32 v4, 1, v2
    v_and_b32 v5, 31, v1
    v_lshrrev_b32 v6, 5, v1
    v_mul_u32_u24 v7, 64, v3
    v_add_u32 v7, v7, v5
    v_lshlrev_b32 v7, 7, v7
    v_and_b32 v8, 7, v1
    v_xor_b32 v8, v8, v6
    v_lshlrev_b32 v8, 4, v8
    v_add_u32 v12, v7, v8
    v_xor_b32 v13, 32, v12
    v_xor_b32 v14, 64, v12
    v_xor_b32 v15, 96, v12
    v_lshrrev_b32 v7, 4, v1
    v_and_b32 v7, 1, v7
    v_lshrrev_b32 v8, 2, v1
    v_and_b32 v8, 3, v8
    v_and_b32 v9, 3, v1
    v_mul_u32_u24 v16, 4, v4
    v_lshl_add_u32 v16, v7, 1, v16
    v_lshrrev_b32 v17, 1, v9
    v_add_u32 v16, v16, v17
    v_lshrrev_b32 v17, 1, v8
    v_lshlrev_b32 v17, 2, v17
    v_lshl_add_u32 v18, v6, 3, v8
    v_mul_u32_u24 v18, 128, v18
    v_and_b32 v19, 1, v9
    v_lshl_add_u32 v18, v19, 3, v18
    v_add_u32 v18, 16384, v18
    v_add_u32 v19, 0, v16
    v_xor_b32 v19, v19, v17
    v_lshl_add_u32 v20, v19, 4, v18
    v_mov_b32 v128, 0
    v_mov_b32 v129, 0
    v_mov_b32 v130, 0
    v_mov_b32 v131, 0
    v_mov_b32 v132, 0
    v_mov_b32 v133, 0
    v_mov_b32 v134, 0
    v_mov_b32 v135, 0
    v_mov_b32 v136, 0
    v_mov_b32 v137, 0
    v_mov_b32 v138, 0
    v_mov_b32 v139, 0
    v_mov_b32 v140, 0
    v_mov_b32 v141, 0
    v_mov_b32 v142, 0
    v_mov_b32 v143, 0
    v_mov_b32 v144, 0
    v_mov_b32 v145, 0
    v_mov_b32 v146, 0
    v_mov_b32 v147, 0
    v_mov_b32 v148, 0
    v_mov_b32 v149, 0
    v_mov_b32 v150, 0
    v_mov_b32 v151, 0
    v_mov_b32 v152, 0
    v_mov_b32 v153, 0
    v_mov_b32 v154, 0
    v_mov_b32 v155, 0
    v_mov_b32 v156, 0
    v_mov_b32 v157, 0
    v_mov_b32 v158, 0
    v_mov_b32 v159, 0
    s_mov_b32 s51, 0
    s_add_u32 s52, s51, s49
    s_mov_b32 m0, s52
    s_add_u32 s53, s44, 0
    buffer_load_dwordx4 v10, s[8:11], s53 offen lds
    s_add_u32 s52, s51, s49
    s_add_u32 s52, s52, 1024
    s_mov_b32 m0, s52
    s_add_u32 s53, s44, 65536
    buffer_load_dwordx4 v10, s[8:11], s53 offen lds
    s_add_u32 s52, s51, s49
    s_add_u32 s52, s52, 2048
    s_mov_b32 m0, s52
    s_add_u32 s53, s44, 131072
    buffer_load_dwordx4 v10, s[8:11], s53 offen lds
    s_add_u32 s52, s51, s49
    s_add_u32 s52, s52, 3072
    s_mov_b32 m0, s52
    s_add_u32 s53, s44, 196608
    buffer_load_dwordx4 v10, s[8:11], s53 offen lds
    s_add_u32 s52, s51, s50
    s_mov_b32 m0, s52
    s_add_u32 s53, s45, 0
    buffer_load_dwordx4 v11, s[12:15], s53 offen lds
    s_add_u32 s52, s51, s50
    s_add_u32 s52, s52, 1024
    s_mov_b32 m0, s52
    s_add_u32 s53, s45, 16384
    buffer_load_dwordx4 v11, s[12:15], s53 offen lds
    s_add_u32 s44, s44, 128
    s_add_u32 s45, s45, 131072
    s_add_u32 s51, s51, 24576
    s_cmp_eq_u32 s51, 73728
    s_cselect_b32 s51, 0, s51
    s_add_u32 s52, s51, s49
    s_mov_b32 m0, s52
    s_add_u32 s53, s44, 0
    buffer_load_dwordx4 v10, s[8:11], s53 offen lds
    s_add_u32 s52, s51, s49
    s_add_u32 s52, s52, 1024
    s_mov_b32 m0, s52
    s_add_u32 s53, s44, 65536
    buffer_load_dwordx4 v10, s[8:11], s53 offen lds
    s_add_u32 s52, s51, s49
    s_add_u32 s52, s52, 2048
    s_mov_b32 m0, s52
    s_add_u32 s53, s44, 131072
    buffer_load_dwordx4 v10, s[8:11], s53 offen lds
    s_add_u32 s52, s51, s49
    s_add_u32 s52, s52, 3072
    s_mov_b32 m0, s52
    s_add_u32 s53, s44, 196608
    buffer_load_dwordx4 v10, s[8:11], s53 offen lds
    s_add_u32 s52, s51, s50
    s_mov_b32 m0, s52
    s_add_u32 s53, s45, 0
    buffer_load_dwordx4 v11, s[12:15], s53 offen lds
    s_add_u32 s52, s51, s50
    s_add_u32 s52, s52, 1024
    s_mov_b32 m0, s52
    s_add_u32 s53, s45, 16384
    buffer_load_dwordx4 v11, s[12:15], s53 offen lds
    s_add_u32 s44, s44, 128
    s_add_u32 s45, s45, 131072
    s_add_u32 s51, s51, 24576
    s_cmp_eq_u32 s51, 73728
    s_cselect_b32 s51, 0, s51
    s_mov_b32 s54, 0
    s_mov_b32 s55, 0
.gemm_wo0_kernel_loop:
    s_waitcnt vmcnt(6)
    s_barrier
    v_add_u32 v24, s54, v12
    v_add_u32 v25, s54, v13
    v_add_u32 v26, s54, v14
    v_add_u32 v27, s54, v15
    v_add_u32 v28, s54, v20
    ds_read_b128 v[32:35], v24 offset:0
    ds_read_b128 v[36:39], v24 offset:4096
    ds_read_b64_tr_b16 v[48:49], v28 offset:0
    ds_read_b64_tr_b16 v[50:51], v28 offset:512
    ds_read_b128 v[56:59], v25 offset:0
    ds_read_b128 v[60:63], v25 offset:4096
    ds_read_b64_tr_b16 v[72:73], v28 offset:2048
    ds_read_b64_tr_b16 v[74:75], v28 offset:2560
    s_waitcnt lgkmcnt(4)
    v_mfma_f32_32x32x16_bf16 v[128:143], v[48:51], v[32:35], v[128:143]
    s_add_u32 s52, s51, s49
    s_mov_b32 m0, s52
    s_add_u32 s53, s44, 0
    buffer_load_dwordx4 v10, s[8:11], s53 offen lds
    v_mfma_f32_32x32x16_bf16 v[144:159], v[48:51], v[36:39], v[144:159]
    s_add_u32 s52, s51, s49
    s_add_u32 s52, s52, 1024
    s_mov_b32 m0, s52
    s_add_u32 s53, s44, 65536
    buffer_load_dwordx4 v10, s[8:11], s53 offen lds
    ds_read_b128 v[32:35], v26 offset:0
    ds_read_b128 v[36:39], v26 offset:4096
    ds_read_b64_tr_b16 v[48:49], v28 offset:4096
    ds_read_b64_tr_b16 v[50:51], v28 offset:4608
    s_waitcnt lgkmcnt(4)
    v_mfma_f32_32x32x16_bf16 v[128:143], v[72:75], v[56:59], v[128:143]
    s_add_u32 s52, s51, s49
    s_add_u32 s52, s52, 2048
    s_mov_b32 m0, s52
    s_add_u32 s53, s44, 131072
    buffer_load_dwordx4 v10, s[8:11], s53 offen lds
    v_mfma_f32_32x32x16_bf16 v[144:159], v[72:75], v[60:63], v[144:159]
    ds_read_b128 v[56:59], v27 offset:0
    ds_read_b128 v[60:63], v27 offset:4096
    ds_read_b64_tr_b16 v[72:73], v28 offset:6144
    ds_read_b64_tr_b16 v[74:75], v28 offset:6656
    s_waitcnt lgkmcnt(4)
    v_mfma_f32_32x32x16_bf16 v[128:143], v[48:51], v[32:35], v[128:143]
    s_add_u32 s52, s51, s49
    s_add_u32 s52, s52, 3072
    s_mov_b32 m0, s52
    s_add_u32 s53, s44, 196608
    buffer_load_dwordx4 v10, s[8:11], s53 offen lds
    v_mfma_f32_32x32x16_bf16 v[144:159], v[48:51], v[36:39], v[144:159]
    s_add_u32 s52, s51, s50
    s_mov_b32 m0, s52
    s_add_u32 s53, s45, 0
    buffer_load_dwordx4 v11, s[12:15], s53 offen lds
    s_waitcnt lgkmcnt(0)
    v_mfma_f32_32x32x16_bf16 v[128:143], v[72:75], v[56:59], v[128:143]
    s_add_u32 s52, s51, s50
    s_add_u32 s52, s52, 1024
    s_mov_b32 m0, s52
    s_add_u32 s53, s45, 16384
    buffer_load_dwordx4 v11, s[12:15], s53 offen lds
    v_mfma_f32_32x32x16_bf16 v[144:159], v[72:75], v[60:63], v[144:159]
    s_add_u32 s44, s44, 128
    s_add_u32 s45, s45, 131072
    s_add_u32 s51, s51, 24576
    s_cmp_eq_u32 s51, 73728
    s_cselect_b32 s51, 0, s51
    s_add_u32 s54, s54, 24576
    s_cmp_eq_u32 s54, 73728
    s_cselect_b32 s54, 0, s54
    s_add_u32 s55, s55, 1
    s_cmp_lt_u32 s55, 64
    s_cbranch_scc1 .gemm_wo0_kernel_loop
    s_waitcnt vmcnt(0)
    s_nop 15
    s_nop 15
    s_add_u32 s4, s6, 0x400000
    s_addc_u32 s5, s7, 0
    s_mov_b32 s16, s4
    s_and_b32 s17, s5, 0xffff
    s_mov_b32 s18, 0x400000
    s_mov_b32 s19, 0x00020000
    s_mov_b32 s4, s36
    s_mov_b32 s5, s37
    s_mov_b32 s20, s4
    s_and_b32 s21, s5, 0xffff
    s_mov_b32 s22, 0x400000
    s_mov_b32 s23, 0x00020000
    s_mul_i32 s4, s40, 128
    v_mul_u32_u24 v7, 64, v3
    v_add_u32 v7, v7, v5
    v_add_u32 v7, s4, v7
    s_mov_b32 s47, 2048
    v_mul_lo_u32 v7, v7, s47
    v_mul_u32_u24 v8, 32, v4
    v_lshl_add_u32 v8, v6, 2, v8
    v_add_u32 v8, s42, v8
    v_lshlrev_b32 v8, 1, v8
    v_add_u32 v7, v7, v8
    s_mov_b32 s4, 0
    buffer_load_dwordx2 v[40:41], v7, s[20:23], s4 offen offset:0
    buffer_load_dwordx2 v[42:43], v7, s[20:23], s4 offen offset:16
    buffer_load_dwordx2 v[44:45], v7, s[20:23], s4 offen offset:32
    buffer_load_dwordx2 v[46:47], v7, s[20:23], s4 offen offset:48
    s_waitcnt vmcnt(0)
    v_cvt_pk_bf16_f32 v32, v128, v129
    v_cvt_pk_bf16_f32 v33, v130, v131
    v_lshlrev_b32 v34, 16, v32
    v_and_b32 v35, 0xffff0000, v32
    v_lshlrev_b32 v36, 16, v33
    v_and_b32 v37, 0xffff0000, v33
    v_lshlrev_b32 v38, 16, v40
    v_add_f32 v34, v34, v38
    v_and_b32 v38, 0xffff0000, v40
    v_add_f32 v35, v35, v38
    v_lshlrev_b32 v38, 16, v41
    v_add_f32 v36, v36, v38
    v_and_b32 v38, 0xffff0000, v41
    v_add_f32 v37, v37, v38
    v_cvt_pk_bf16_f32 v32, v34, v35
    v_cvt_pk_bf16_f32 v33, v36, v37
    buffer_store_dwordx2 v[32:33], v7, s[16:19], s4 offen offset:0
    s_nop 1
    v_cvt_pk_bf16_f32 v32, v132, v133
    v_cvt_pk_bf16_f32 v33, v134, v135
    v_lshlrev_b32 v34, 16, v32
    v_and_b32 v35, 0xffff0000, v32
    v_lshlrev_b32 v36, 16, v33
    v_and_b32 v37, 0xffff0000, v33
    v_lshlrev_b32 v38, 16, v42
    v_add_f32 v34, v34, v38
    v_and_b32 v38, 0xffff0000, v42
    v_add_f32 v35, v35, v38
    v_lshlrev_b32 v38, 16, v43
    v_add_f32 v36, v36, v38
    v_and_b32 v38, 0xffff0000, v43
    v_add_f32 v37, v37, v38
    v_cvt_pk_bf16_f32 v32, v34, v35
    v_cvt_pk_bf16_f32 v33, v36, v37
    buffer_store_dwordx2 v[32:33], v7, s[16:19], s4 offen offset:16
    s_nop 1
    v_cvt_pk_bf16_f32 v32, v136, v137
    v_cvt_pk_bf16_f32 v33, v138, v139
    v_lshlrev_b32 v34, 16, v32
    v_and_b32 v35, 0xffff0000, v32
    v_lshlrev_b32 v36, 16, v33
    v_and_b32 v37, 0xffff0000, v33
    v_lshlrev_b32 v38, 16, v44
    v_add_f32 v34, v34, v38
    v_and_b32 v38, 0xffff0000, v44
    v_add_f32 v35, v35, v38
    v_lshlrev_b32 v38, 16, v45
    v_add_f32 v36, v36, v38
    v_and_b32 v38, 0xffff0000, v45
    v_add_f32 v37, v37, v38
    v_cvt_pk_bf16_f32 v32, v34, v35
    v_cvt_pk_bf16_f32 v33, v36, v37
    buffer_store_dwordx2 v[32:33], v7, s[16:19], s4 offen offset:32
    s_nop 1
    v_cvt_pk_bf16_f32 v32, v140, v141
    v_cvt_pk_bf16_f32 v33, v142, v143
    v_lshlrev_b32 v34, 16, v32
    v_and_b32 v35, 0xffff0000, v32
    v_lshlrev_b32 v36, 16, v33
    v_and_b32 v37, 0xffff0000, v33
    v_lshlrev_b32 v38, 16, v46
    v_add_f32 v34, v34, v38
    v_and_b32 v38, 0xffff0000, v46
    v_add_f32 v35, v35, v38
    v_lshlrev_b32 v38, 16, v47
    v_add_f32 v36, v36, v38
    v_and_b32 v38, 0xffff0000, v47
    v_add_f32 v37, v37, v38
    v_cvt_pk_bf16_f32 v32, v34, v35
    v_cvt_pk_bf16_f32 v33, v36, v37
    buffer_store_dwordx2 v[32:33], v7, s[16:19], s4 offen offset:48
    s_nop 1
    s_mov_b32 s4, 65536
    buffer_load_dwordx2 v[40:41], v7, s[20:23], s4 offen offset:0
    buffer_load_dwordx2 v[42:43], v7, s[20:23], s4 offen offset:16
    buffer_load_dwordx2 v[44:45], v7, s[20:23], s4 offen offset:32
    buffer_load_dwordx2 v[46:47], v7, s[20:23], s4 offen offset:48
    s_waitcnt vmcnt(0)
    v_cvt_pk_bf16_f32 v32, v144, v145
    v_cvt_pk_bf16_f32 v33, v146, v147
    v_lshlrev_b32 v34, 16, v32
    v_and_b32 v35, 0xffff0000, v32
    v_lshlrev_b32 v36, 16, v33
    v_and_b32 v37, 0xffff0000, v33
    v_lshlrev_b32 v38, 16, v40
    v_add_f32 v34, v34, v38
    v_and_b32 v38, 0xffff0000, v40
    v_add_f32 v35, v35, v38
    v_lshlrev_b32 v38, 16, v41
    v_add_f32 v36, v36, v38
    v_and_b32 v38, 0xffff0000, v41
    v_add_f32 v37, v37, v38
    v_cvt_pk_bf16_f32 v32, v34, v35
    v_cvt_pk_bf16_f32 v33, v36, v37
    buffer_store_dwordx2 v[32:33], v7, s[16:19], s4 offen offset:0
    s_nop 1
    v_cvt_pk_bf16_f32 v32, v148, v149
    v_cvt_pk_bf16_f32 v33, v150, v151
    v_lshlrev_b32 v34, 16, v32
    v_and_b32 v35, 0xffff0000, v32
    v_lshlrev_b32 v36, 16, v33
    v_and_b32 v37, 0xffff0000, v33
    v_lshlrev_b32 v38, 16, v42
    v_add_f32 v34, v34, v38
    v_and_b32 v38, 0xffff0000, v42
    v_add_f32 v35, v35, v38
    v_lshlrev_b32 v38, 16, v43
    v_add_f32 v36, v36, v38
    v_and_b32 v38, 0xffff0000, v43
    v_add_f32 v37, v37, v38
    v_cvt_pk_bf16_f32 v32, v34, v35
    v_cvt_pk_bf16_f32 v33, v36, v37
    buffer_store_dwordx2 v[32:33], v7, s[16:19], s4 offen offset:16
    s_nop 1
    v_cvt_pk_bf16_f32 v32, v152, v153
    v_cvt_pk_bf16_f32 v33, v154, v155
    v_lshlrev_b32 v34, 16, v32
    v_and_b32 v35, 0xffff0000, v32
    v_lshlrev_b32 v36, 16, v33
    v_and_b32 v37, 0xffff0000, v33
    v_lshlrev_b32 v38, 16, v44
    v_add_f32 v34, v34, v38
    v_and_b32 v38, 0xffff0000, v44
    v_add_f32 v35, v35, v38
    v_lshlrev_b32 v38, 16, v45
    v_add_f32 v36, v36, v38
    v_and_b32 v38, 0xffff0000, v45
    v_add_f32 v37, v37, v38
    v_cvt_pk_bf16_f32 v32, v34, v35
    v_cvt_pk_bf16_f32 v33, v36, v37
    buffer_store_dwordx2 v[32:33], v7, s[16:19], s4 offen offset:32
    s_nop 1
    v_cvt_pk_bf16_f32 v32, v156, v157
    v_cvt_pk_bf16_f32 v33, v158, v159
    v_lshlrev_b32 v34, 16, v32
    v_and_b32 v35, 0xffff0000, v32
    v_lshlrev_b32 v36, 16, v33
    v_and_b32 v37, 0xffff0000, v33
    v_lshlrev_b32 v38, 16, v46
    v_add_f32 v34, v34, v38
    v_and_b32 v38, 0xffff0000, v46
    v_add_f32 v35, v35, v38
    v_lshlrev_b32 v38, 16, v47
    v_add_f32 v36, v36, v38
    v_and_b32 v38, 0xffff0000, v47
    v_add_f32 v37, v37, v38
    v_cvt_pk_bf16_f32 v32, v34, v35
    v_cvt_pk_bf16_f32 v33, v36, v37
    buffer_store_dwordx2 v[32:33], v7, s[16:19], s4 offen offset:48
    s_nop 1
.gemm_wo0_kernel_done:
    s_endpgm
.section .rodata,"a"
.p2align 6
.amdhsa_kernel gemm_wo0_kernel
  .amdhsa_next_free_vgpr 256
  .amdhsa_next_free_sgpr 64
  .amdhsa_accum_offset 256
  .amdhsa_group_segment_fixed_size 0
  .amdhsa_kernarg_size 120
  .amdhsa_user_sgpr_count 2
  .amdhsa_user_sgpr_kernarg_segment_ptr 1
  .amdhsa_system_sgpr_workgroup_id_x 1
.end_amdhsa_kernel
.text
.globl gemm_wo1_kernel
.p2align 8
.type gemm_wo1_kernel,@function
gemm_wo1_kernel:
    s_cmp_ge_u32 s2, 256
    s_cbranch_scc1 .gemm_wo1_kernel_done
    s_load_dwordx2 s[6:7], s[0:1], 112
    s_load_dwordx2 s[28:29], s[0:1], 40
    s_and_b32 s40, s2, 15
    s_lshr_b32 s41, s2, 4
    s_waitcnt lgkmcnt(0)
    s_add_u32 s4, s6, 0x4000000
    s_addc_u32 s5, s7, 0
    s_mov_b32 s8, s4
    s_and_b32 s9, s5, 0xffff
    s_mov_b32 s10, 0x1000000
    s_mov_b32 s11, 0x00020000
    s_mul_i32 s42, s41, 64
    s_mov_b32 s4, s28
    s_mov_b32 s5, s29
    s_mov_b32 s43, s42
    s_mov_b32 s12, s4
    s_and_b32 s13, s5, 0xffff
    s_mov_b32 s14, 0x800000
    s_mov_b32 s15, 0x00020000
    s_mul_i32 s44, s40, 1048576
    s_lshl_b32 s45, s43, 1
    v_and_b32 v1, 63, v0
    v_lshrrev_b32 v2, 6, v0
    s_nop 0
    v_readfirstlane_b32 s46, v2
    v_lshrrev_b32 v3, 3, v1
    v_and_b32 v4, 7, v1
    v_xor_b32 v4, v4, v3
    v_lshlrev_b32 v4, 4, v4
    s_mov_b32 s47, 8192
    v_mul_lo_u32 v3, v3, s47
    v_add_u32 v10, v3, v4
    v_lshrrev_b32 v3, 3, v1
    v_and_b32 v4, 7, v1
    v_lshrrev_b32 v5, 1, v3
    v_and_b32 v5, 1, v5
    v_lshlrev_b32 v5, 2, v5
    v_xor_b32 v4, v4, v5
    v_lshlrev_b32 v4, 4, v4
    s_mov_b32 s47, 2048
    v_mul_lo_u32 v3, v3, s47
    v_add_u32 v11, v3, v4
    s_mul_i32 s48, s46, 262144
    s_add_u32 s44, s44, s48
    s_mul_i32 s48, s46, 32768
    s_add_u32 s45, s45, s48
    s_mul_i32 s49, s46, 4096
    s_mul_i32 s50, s46, 2048
    s_add_u32 s50, s50, 16384
    v_lshrrev_b32 v3, 1, v2
    v_and_b32 v4, 1, v2
    v_and_b32 v5, 31, v1
    v_lshrrev_b32 v6, 5, v1
    v_mul_u32_u24 v7, 64, v3
    v_add_u32 v7, v7, v5
    v_lshlrev_b32 v7, 7, v7
    v_and_b32 v8, 7, v1
    v_xor_b32 v8, v8, v6
    v_lshlrev_b32 v8, 4, v8
    v_add_u32 v12, v7, v8
    v_xor_b32 v13, 32, v12
    v_xor_b32 v14, 64, v12
    v_xor_b32 v15, 96, v12
    v_lshrrev_b32 v7, 4, v1
    v_and_b32 v7, 1, v7
    v_lshrrev_b32 v8, 2, v1
    v_and_b32 v8, 3, v8
    v_and_b32 v9, 3, v1
    v_mul_u32_u24 v16, 4, v4
    v_lshl_add_u32 v16, v7, 1, v16
    v_lshrrev_b32 v17, 1, v9
    v_add_u32 v16, v16, v17
    v_lshrrev_b32 v17, 1, v8
    v_lshlrev_b32 v17, 2, v17
    v_lshl_add_u32 v18, v6, 3, v8
    v_mul_u32_u24 v18, 128, v18
    v_and_b32 v19, 1, v9
    v_lshl_add_u32 v18, v19, 3, v18
    v_add_u32 v18, 16384, v18
    v_add_u32 v19, 0, v16
    v_xor_b32 v19, v19, v17
    v_lshl_add_u32 v20, v19, 4, v18
    v_mov_b32 v128, 0
    v_mov_b32 v129, 0
    v_mov_b32 v130, 0
    v_mov_b32 v131, 0
    v_mov_b32 v132, 0
    v_mov_b32 v133, 0
    v_mov_b32 v134, 0
    v_mov_b32 v135, 0
    v_mov_b32 v136, 0
    v_mov_b32 v137, 0
    v_mov_b32 v138, 0
    v_mov_b32 v139, 0
    v_mov_b32 v140, 0
    v_mov_b32 v141, 0
    v_mov_b32 v142, 0
    v_mov_b32 v143, 0
    v_mov_b32 v144, 0
    v_mov_b32 v145, 0
    v_mov_b32 v146, 0
    v_mov_b32 v147, 0
    v_mov_b32 v148, 0
    v_mov_b32 v149, 0
    v_mov_b32 v150, 0
    v_mov_b32 v151, 0
    v_mov_b32 v152, 0
    v_mov_b32 v153, 0
    v_mov_b32 v154, 0
    v_mov_b32 v155, 0
    v_mov_b32 v156, 0
    v_mov_b32 v157, 0
    v_mov_b32 v158, 0
    v_mov_b32 v159, 0
    s_mov_b32 s51, 0
    s_add_u32 s52, s51, s49
    s_mov_b32 m0, s52
    s_add_u32 s53, s44, 0
    buffer_load_dwordx4 v10, s[8:11], s53 offen lds
    s_add_u32 s52, s51, s49
    s_add_u32 s52, s52, 1024
    s_mov_b32 m0, s52
    s_add_u32 s53, s44, 65536
    buffer_load_dwordx4 v10, s[8:11], s53 offen lds
    s_add_u32 s52, s51, s49
    s_add_u32 s52, s52, 2048
    s_mov_b32 m0, s52
    s_add_u32 s53, s44, 131072
    buffer_load_dwordx4 v10, s[8:11], s53 offen lds
    s_add_u32 s52, s51, s49
    s_add_u32 s52, s52, 3072
    s_mov_b32 m0, s52
    s_add_u32 s53, s44, 196608
    buffer_load_dwordx4 v10, s[8:11], s53 offen lds
    s_add_u32 s52, s51, s50
    s_mov_b32 m0, s52
    s_add_u32 s53, s45, 0
    buffer_load_dwordx4 v11, s[12:15], s53 offen lds
    s_add_u32 s52, s51, s50
    s_add_u32 s52, s52, 1024
    s_mov_b32 m0, s52
    s_add_u32 s53, s45, 16384
    buffer_load_dwordx4 v11, s[12:15], s53 offen lds
    s_add_u32 s44, s44, 128
    s_add_u32 s45, s45, 131072
    s_add_u32 s51, s51, 24576
    s_cmp_eq_u32 s51, 73728
    s_cselect_b32 s51, 0, s51
    s_add_u32 s52, s51, s49
    s_mov_b32 m0, s52
    s_add_u32 s53, s44, 0
    buffer_load_dwordx4 v10, s[8:11], s53 offen lds
    s_add_u32 s52, s51, s49
    s_add_u32 s52, s52, 1024
    s_mov_b32 m0, s52
    s_add_u32 s53, s44, 65536
    buffer_load_dwordx4 v10, s[8:11], s53 offen lds
    s_add_u32 s52, s51, s49
    s_add_u32 s52, s52, 2048
    s_mov_b32 m0, s52
    s_add_u32 s53, s44, 131072
    buffer_load_dwordx4 v10, s[8:11], s53 offen lds
    s_add_u32 s52, s51, s49
    s_add_u32 s52, s52, 3072
    s_mov_b32 m0, s52
    s_add_u32 s53, s44, 196608
    buffer_load_dwordx4 v10, s[8:11], s53 offen lds
    s_add_u32 s52, s51, s50
    s_mov_b32 m0, s52
    s_add_u32 s53, s45, 0
    buffer_load_dwordx4 v11, s[12:15], s53 offen lds
    s_add_u32 s52, s51, s50
    s_add_u32 s52, s52, 1024
    s_mov_b32 m0, s52
    s_add_u32 s53, s45, 16384
    buffer_load_dwordx4 v11, s[12:15], s53 offen lds
    s_add_u32 s44, s44, 128
    s_add_u32 s45, s45, 131072
    s_add_u32 s51, s51, 24576
    s_cmp_eq_u32 s51, 73728
    s_cselect_b32 s51, 0, s51
    s_mov_b32 s54, 0
    s_mov_b32 s55, 0
.gemm_wo1_kernel_loop:
    s_waitcnt vmcnt(6)
    s_barrier
    v_add_u32 v24, s54, v12
    v_add_u32 v25, s54, v13
    v_add_u32 v26, s54, v14
    v_add_u32 v27, s54, v15
    v_add_u32 v28, s54, v20
    ds_read_b128 v[32:35], v24 offset:0
    ds_read_b128 v[36:39], v24 offset:4096
    ds_read_b64_tr_b16 v[48:49], v28 offset:0
    ds_read_b64_tr_b16 v[50:51], v28 offset:512
    ds_read_b128 v[56:59], v25 offset:0
    ds_read_b128 v[60:63], v25 offset:4096
    ds_read_b64_tr_b16 v[72:73], v28 offset:2048
    ds_read_b64_tr_b16 v[74:75], v28 offset:2560
    s_waitcnt lgkmcnt(4)
    v_mfma_f32_32x32x16_bf16 v[128:143], v[48:51], v[32:35], v[128:143]
    s_add_u32 s52, s51, s49
    s_mov_b32 m0, s52
    s_add_u32 s53, s44, 0
    buffer_load_dwordx4 v10, s[8:11], s53 offen lds
    v_mfma_f32_32x32x16_bf16 v[144:159], v[48:51], v[36:39], v[144:159]
    s_add_u32 s52, s51, s49
    s_add_u32 s52, s52, 1024
    s_mov_b32 m0, s52
    s_add_u32 s53, s44, 65536
    buffer_load_dwordx4 v10, s[8:11], s53 offen lds
    ds_read_b128 v[32:35], v26 offset:0
    ds_read_b128 v[36:39], v26 offset:4096
    ds_read_b64_tr_b16 v[48:49], v28 offset:4096
    ds_read_b64_tr_b16 v[50:51], v28 offset:4608
    s_waitcnt lgkmcnt(4)
    v_mfma_f32_32x32x16_bf16 v[128:143], v[72:75], v[56:59], v[128:143]
    s_add_u32 s52, s51, s49
    s_add_u32 s52, s52, 2048
    s_mov_b32 m0, s52
    s_add_u32 s53, s44, 131072
    buffer_load_dwordx4 v10, s[8:11], s53 offen lds
    v_mfma_f32_32x32x16_bf16 v[144:159], v[72:75], v[60:63], v[144:159]
    ds_read_b128 v[56:59], v27 offset:0
    ds_read_b128 v[60:63], v27 offset:4096
    ds_read_b64_tr_b16 v[72:73], v28 offset:6144
    ds_read_b64_tr_b16 v[74:75], v28 offset:6656
    s_waitcnt lgkmcnt(4)
    v_mfma_f32_32x32x16_bf16 v[128:143], v[48:51], v[32:35], v[128:143]
    s_add_u32 s52, s51, s49
    s_add_u32 s52, s52, 3072
    s_mov_b32 m0, s52
    s_add_u32 s53, s44, 196608
    buffer_load_dwordx4 v10, s[8:11], s53 offen lds
    v_mfma_f32_32x32x16_bf16 v[144:159], v[48:51], v[36:39], v[144:159]
    s_add_u32 s52, s51, s50
    s_mov_b32 m0, s52
    s_add_u32 s53, s45, 0
    buffer_load_dwordx4 v11, s[12:15], s53 offen lds
    s_waitcnt lgkmcnt(0)
    v_mfma_f32_32x32x16_bf16 v[128:143], v[72:75], v[56:59], v[128:143]
    s_add_u32 s52, s51, s50
    s_add_u32 s52, s52, 1024
    s_mov_b32 m0, s52
    s_add_u32 s53, s45, 16384
    buffer_load_dwordx4 v11, s[12:15], s53 offen lds
    v_mfma_f32_32x32x16_bf16 v[144:159], v[72:75], v[60:63], v[144:159]
    s_add_u32 s44, s44, 128
    s_add_u32 s45, s45, 131072
    s_add_u32 s51, s51, 24576
    s_cmp_eq_u32 s51, 73728
    s_cselect_b32 s51, 0, s51
    s_add_u32 s54, s54, 24576
    s_cmp_eq_u32 s54, 73728
    s_cselect_b32 s54, 0, s54
    s_add_u32 s55, s55, 1
    s_cmp_lt_u32 s55, 64
    s_cbranch_scc1 .gemm_wo1_kernel_loop
    s_waitcnt vmcnt(0)
    s_nop 15
    s_nop 15
    s_add_u32 s4, s6, 0x400000
    s_addc_u32 s5, s7, 0
    s_mov_b32 s16, s4
    s_and_b32 s17, s5, 0xffff
    s_mov_b32 s18, 0x400000
    s_mov_b32 s19, 0x00020000
    s_add_u32 s4, s6, 0x800000
    s_addc_u32 s5, s7, 0
    s_mov_b32 s20, s4
    s_and_b32 s21, s5, 0xffff
    s_mov_b32 s22, 0x400000
    s_mov_b32 s23, 0x00020000
    s_mul_i32 s4, s40, 128
    v_mul_u32_u24 v7, 64, v3
    v_add_u32 v7, v7, v5
    v_add_u32 v7, s4, v7
    s_mov_b32 s47, 2048
    v_mul_lo_u32 v7, v7, s47
    v_mul_u32_u24 v8, 32, v4
    v_lshl_add_u32 v8, v6, 2, v8
    v_add_u32 v8, s42, v8
    v_lshlrev_b32 v8, 1, v8
    v_add_u32 v7, v7, v8
    s_mov_b32 s4, 0
    buffer_load_dwordx2 v[40:41], v7, s[20:23], s4 offen offset:0
    buffer_load_dwordx2 v[42:43], v7, s[20:23], s4 offen offset:16
    buffer_load_dwordx2 v[44:45], v7, s[20:23], s4 offen offset:32
    buffer_load_dwordx2 v[46:47], v7, s[20:23], s4 offen offset:48
    s_waitcnt vmcnt(0)
    v_cvt_pk_bf16_f32 v32, v128, v129
    v_cvt_pk_bf16_f32 v33, v130, v131
    v_lshlrev_b32 v34, 16, v32
    v_and_b32 v35, 0xffff0000, v32
    v_lshlrev_b32 v36, 16, v33
    v_and_b32 v37, 0xffff0000, v33
    v_lshlrev_b32 v38, 16, v40
    v_add_f32 v34, v34, v38
    v_and_b32 v38, 0xffff0000, v40
    v_add_f32 v35, v35, v38
    v_lshlrev_b32 v38, 16, v41
    v_add_f32 v36, v36, v38
    v_and_b32 v38, 0xffff0000, v41
    v_add_f32 v37, v37, v38
    v_cvt_pk_bf16_f32 v32, v34, v35
    v_cvt_pk_bf16_f32 v33, v36, v37
    buffer_store_dwordx2 v[32:33], v7, s[16:19], s4 offen offset:0
    s_nop 1
    v_cvt_pk_bf16_f32 v32, v132, v133
    v_cvt_pk_bf16_f32 v33, v134, v135
    v_lshlrev_b32 v34, 16, v32
    v_and_b32 v35, 0xffff0000, v32
    v_lshlrev_b32 v36, 16, v33
    v_and_b32 v37, 0xffff0000, v33
    v_lshlrev_b32 v38, 16, v42
    v_add_f32 v34, v34, v38
    v_and_b32 v38, 0xffff0000, v42
    v_add_f32 v35, v35, v38
    v_lshlrev_b32 v38, 16, v43
    v_add_f32 v36, v36, v38
    v_and_b32 v38, 0xffff0000, v43
    v_add_f32 v37, v37, v38
    v_cvt_pk_bf16_f32 v32, v34, v35
    v_cvt_pk_bf16_f32 v33, v36, v37
    buffer_store_dwordx2 v[32:33], v7, s[16:19], s4 offen offset:16
    s_nop 1
    v_cvt_pk_bf16_f32 v32, v136, v137
    v_cvt_pk_bf16_f32 v33, v138, v139
    v_lshlrev_b32 v34, 16, v32
    v_and_b32 v35, 0xffff0000, v32
    v_lshlrev_b32 v36, 16, v33
    v_and_b32 v37, 0xffff0000, v33
    v_lshlrev_b32 v38, 16, v44
    v_add_f32 v34, v34, v38
    v_and_b32 v38, 0xffff0000, v44
    v_add_f32 v35, v35, v38
    v_lshlrev_b32 v38, 16, v45
    v_add_f32 v36, v36, v38
    v_and_b32 v38, 0xffff0000, v45
    v_add_f32 v37, v37, v38
    v_cvt_pk_bf16_f32 v32, v34, v35
    v_cvt_pk_bf16_f32 v33, v36, v37
    buffer_store_dwordx2 v[32:33], v7, s[16:19], s4 offen offset:32
    s_nop 1
    v_cvt_pk_bf16_f32 v32, v140, v141
    v_cvt_pk_bf16_f32 v33, v142, v143
    v_lshlrev_b32 v34, 16, v32
    v_and_b32 v35, 0xffff0000, v32
    v_lshlrev_b32 v36, 16, v33
    v_and_b32 v37, 0xffff0000, v33
    v_lshlrev_b32 v38, 16, v46
    v_add_f32 v34, v34, v38
    v_and_b32 v38, 0xffff0000, v46
    v_add_f32 v35, v35, v38
    v_lshlrev_b32 v38, 16, v47
    v_add_f32 v36, v36, v38
    v_and_b32 v38, 0xffff0000, v47
    v_add_f32 v37, v37, v38
    v_cvt_pk_bf16_f32 v32, v34, v35
    v_cvt_pk_bf16_f32 v33, v36, v37
    buffer_store_dwordx2 v[32:33], v7, s[16:19], s4 offen offset:48
    s_nop 1
    s_mov_b32 s4, 65536
    buffer_load_dwordx2 v[40:41], v7, s[20:23], s4 offen offset:0
    buffer_load_dwordx2 v[42:43], v7, s[20:23], s4 offen offset:16
    buffer_load_dwordx2 v[44:45], v7, s[20:23], s4 offen offset:32
    buffer_load_dwordx2 v[46:47], v7, s[20:23], s4 offen offset:48
    s_waitcnt vmcnt(0)
    v_cvt_pk_bf16_f32 v32, v144, v145
    v_cvt_pk_bf16_f32 v33, v146, v147
    v_lshlrev_b32 v34, 16, v32
    v_and_b32 v35, 0xffff0000, v32
    v_lshlrev_b32 v36, 16, v33
    v_and_b32 v37, 0xffff0000, v33
    v_lshlrev_b32 v38, 16, v40
    v_add_f32 v34, v34, v38
    v_and_b32 v38, 0xffff0000, v40
    v_add_f32 v35, v35, v38
    v_lshlrev_b32 v38, 16, v41
    v_add_f32 v36, v36, v38
    v_and_b32 v38, 0xffff0000, v41
    v_add_f32 v37, v37, v38
    v_cvt_pk_bf16_f32 v32, v34, v35
    v_cvt_pk_bf16_f32 v33, v36, v37
    buffer_store_dwordx2 v[32:33], v7, s[16:19], s4 offen offset:0
    s_nop 1
    v_cvt_pk_bf16_f32 v32, v148, v149
    v_cvt_pk_bf16_f32 v33, v150, v151
    v_lshlrev_b32 v34, 16, v32
    v_and_b32 v35, 0xffff0000, v32
    v_lshlrev_b32 v36, 16, v33
    v_and_b32 v37, 0xffff0000, v33
    v_lshlrev_b32 v38, 16, v42
    v_add_f32 v34, v34, v38
    v_and_b32 v38, 0xffff0000, v42
    v_add_f32 v35, v35, v38
    v_lshlrev_b32 v38, 16, v43
    v_add_f32 v36, v36, v38
    v_and_b32 v38, 0xffff0000, v43
    v_add_f32 v37, v37, v38
    v_cvt_pk_bf16_f32 v32, v34, v35
    v_cvt_pk_bf16_f32 v33, v36, v37
    buffer_store_dwordx2 v[32:33], v7, s[16:19], s4 offen offset:16
    s_nop 1
    v_cvt_pk_bf16_f32 v32, v152, v153
    v_cvt_pk_bf16_f32 v33, v154, v155
    v_lshlrev_b32 v34, 16, v32
    v_and_b32 v35, 0xffff0000, v32
    v_lshlrev_b32 v36, 16, v33
    v_and_b32 v37, 0xffff0000, v33
    v_lshlrev_b32 v38, 16, v44
    v_add_f32 v34, v34, v38
    v_and_b32 v38, 0xffff0000, v44
    v_add_f32 v35, v35, v38
    v_lshlrev_b32 v38, 16, v45
    v_add_f32 v36, v36, v38
    v_and_b32 v38, 0xffff0000, v45
    v_add_f32 v37, v37, v38
    v_cvt_pk_bf16_f32 v32, v34, v35
    v_cvt_pk_bf16_f32 v33, v36, v37
    buffer_store_dwordx2 v[32:33], v7, s[16:19], s4 offen offset:32
    s_nop 1
    v_cvt_pk_bf16_f32 v32, v156, v157
    v_cvt_pk_bf16_f32 v33, v158, v159
    v_lshlrev_b32 v34, 16, v32
    v_and_b32 v35, 0xffff0000, v32
    v_lshlrev_b32 v36, 16, v33
    v_and_b32 v37, 0xffff0000, v33
    v_lshlrev_b32 v38, 16, v46
    v_add_f32 v34, v34, v38
    v_and_b32 v38, 0xffff0000, v46
    v_add_f32 v35, v35, v38
    v_lshlrev_b32 v38, 16, v47
    v_add_f32 v36, v36, v38
    v_and_b32 v38, 0xffff0000, v47
    v_add_f32 v37, v37, v38
    v_cvt_pk_bf16_f32 v32, v34, v35
    v_cvt_pk_bf16_f32 v33, v36, v37
    buffer_store_dwordx2 v[32:33], v7, s[16:19], s4 offen offset:48
    s_nop 1
.gemm_wo1_kernel_done:
    s_endpgm
.section .rodata,"a"
.p2align 6
.amdhsa_kernel gemm_wo1_kernel
  .amdhsa_next_free_vgpr 256
  .amdhsa_next_free_sgpr 64
  .amdhsa_accum_offset 256
  .amdhsa_group_segment_fixed_size 0
  .amdhsa_kernarg_size 120
  .amdhsa_user_sgpr_count 2
  .amdhsa_user_sgpr_kernarg_segment_ptr 1
  .amdhsa_system_sgpr_workgroup_id_x 1
.end_amdhsa_kernel
.text
.globl gemm_w1_kernel
.p2align 8
.type gemm_w1_kernel,@function
gemm_w1_kernel:
    s_cmp_ge_u32 s2, 224
    s_cbranch_scc1 .gemm_w1_kernel_done
    s_load_dwordx2 s[6:7], s[0:1], 112
    s_load_dwordx2 s[28:29], s[0:1], 64
    s_load_dwordx2 s[38:39], s[0:1], 72
    s_and_b32 s40, s2, 7
    s_lshr_b32 s41, s2, 3
    s_waitcnt lgkmcnt(0)
    s_add_u32 s4, s6, 0x0
    s_addc_u32 s5, s7, 0
    s_mov_b32 s8, s4
    s_and_b32 s9, s5, 0xffff
    s_mov_b32 s10, 0x400000
    s_mov_b32 s11, 0x00020000
    s_mul_i32 s42, s41, 128
    s_mov_b32 s4, s28
    s_mov_b32 s5, s29
    s_mov_b32 s43, s42
    s_mov_b32 s12, s4
    s_and_b32 s13, s5, 0xffff
    s_mov_b32 s14, 0x700000
    s_mov_b32 s15, 0x00020000
    s_mul_i32 s44, s40, 524288
    s_lshl_b32 s45, s43, 1
    v_and_b32 v1, 63, v0
    v_lshrrev_b32 v2, 6, v0
    s_nop 0
    v_readfirstlane_b32 s46, v2
    v_lshrrev_b32 v3, 3, v1
    v_and_b32 v4, 7, v1
    v_xor_b32 v4, v4, v3
    v_lshlrev_b32 v4, 4, v4
    s_mov_b32 s47, 2048
    v_mul_lo_u32 v3, v3, s47
    v_add_u32 v10, v3, v4
    v_lshrrev_b32 v3, 4, v1
    v_and_b32 v4, 15, v1
    v_lshlrev_b32 v5, 2, v3
    v_xor_b32 v4, v4, v5
    v_lshlrev_b32 v4, 4, v4
    s_mov_b32 s47, 7168
    v_mul_lo_u32 v3, v3, s47
    v_add_u32 v11, v3, v4
    s_mul_i32 s48, s46, 131072
    s_add_u32 s44, s44, s48
    s_mul_i32 s48, s46, 114688
    s_add_u32 s45, s45, s48
    s_mul_i32 s49, s46, 8192
    s_mul_i32 s50, s46, 4096
    s_add_u32 s50, s50, 32768
    v_lshrrev_b32 v3, 1, v2
    v_and_b32 v4, 1, v2
    v_and_b32 v5, 31, v1
    v_lshrrev_b32 v6, 5, v1
    v_mul_u32_u24 v7, 128, v3
    v_add_u32 v7, v7, v5
    v_lshlrev_b32 v7, 7, v7
    v_and_b32 v8, 7, v1
    v_xor_b32 v8, v8, v6
    v_lshlrev_b32 v8, 4, v8
    v_add_u32 v12, v7, v8
    v_xor_b32 v13, 32, v12
    v_xor_b32 v14, 64, v12
    v_xor_b32 v15, 96, v12
    v_lshrrev_b32 v7, 4, v1
    v_and_b32 v7, 1, v7
    v_lshrrev_b32 v8, 2, v1
    v_and_b32 v8, 3, v8
    v_and_b32 v9, 3, v1
    v_mul_u32_u24 v16, 8, v4
    v_lshl_add_u32 v16, v7, 1, v16
    v_lshrrev_b32 v17, 1, v9
    v_add_u32 v16, v16, v17
    v_lshlrev_b32 v17, 2, v8
    v_lshl_add_u32 v18, v6, 3, v8
    v_mul_u32_u24 v18, 256, v18
    v_and_b32 v19, 1, v9
    v_lshl_add_u32 v18, v19, 3, v18
    v_add_u32 v18, 32768, v18
    v_add_u32 v19, 0, v16
    v_xor_b32 v19, v19, v17
    v_lshl_add_u32 v20, v19, 4, v18
    v_add_u32 v19, 4, v16
    v_xor_b32 v19, v19, v17
    v_lshl_add_u32 v21, v19, 4, v18
    v_mov_b32 v128, 0
    v_mov_b32 v129, 0
    v_mov_b32 v130, 0
    v_mov_b32 v131, 0
    v_mov_b32 v132, 0
    v_mov_b32 v133, 0
    v_mov_b32 v134, 0
    v_mov_b32 v135, 0
    v_mov_b32 v136, 0
    v_mov_b32 v137, 0
    v_mov_b32 v138, 0
    v_mov_b32 v139, 0
    v_mov_b32 v140, 0
    v_mov_b32 v141, 0
    v_mov_b32 v142, 0
    v_mov_b32 v143, 0
    v_mov_b32 v144, 0
    v_mov_b32 v145, 0
    v_mov_b32 v146, 0
    v_mov_b32 v147, 0
    v_mov_b32 v148, 0
    v_mov_b32 v149, 0
    v_mov_b32 v150, 0
    v_mov_b32 v151, 0
    v_mov_b32 v152, 0
    v_mov_b32 v153, 0
    v_mov_b32 v154, 0
    v_mov_b32 v155, 0
    v_mov_b32 v156, 0
    v_mov_b32 v157, 0
    v_mov_b32 v158, 0
    v_mov_b32 v159, 0
    v_mov_b32 v160, 0
    v_mov_b32 v161, 0
    v_mov_b32 v162, 0
    v_mov_b32 v163, 0
    v_mov_b32 v164, 0
    v_mov_b32 v165, 0
    v_mov_b32 v166, 0
    v_mov_b32 v167, 0
    v_mov_b32 v168, 0
    v_mov_b32 v169, 0
    v_mov_b32 v170, 0
    v_mov_b32 v171, 0
    v_mov_b32 v172, 0
    v_mov_b32 v173, 0
    v_mov_b32 v174, 0
    v_mov_b32 v175, 0
    v_mov_b32 v176, 0
    v_mov_b32 v177, 0
    v_mov_b32 v178, 0
    v_mov_b32 v179, 0
    v_mov_b32 v180, 0
    v_mov_b32 v181, 0
    v_mov_b32 v182, 0
    v_mov_b32 v183, 0
    v_mov_b32 v184, 0
    v_mov_b32 v185, 0
    v_mov_b32 v186, 0
    v_mov_b32 v187, 0
    v_mov_b32 v188, 0
    v_mov_b32 v189, 0
    v_mov_b32 v190, 0
    v_mov_b32 v191, 0
    v_mov_b32 v192, 0
    v_mov_b32 v193, 0
    v_mov_b32 v194, 0
    v_mov_b32 v195, 0
    v_mov_b32 v196, 0
    v_mov_b32 v197, 0
    v_mov_b32 v198, 0
    v_mov_b32 v199, 0
    v_mov_b32 v200, 0
    v_mov_b32 v201, 0
    v_mov_b32 v202, 0
    v_mov_b32 v203, 0
    v_mov_b32 v204, 0
    v_mov_b32 v205, 0
    v_mov_b32 v206, 0
    v_mov_b32 v207, 0
    v_mov_b32 v208, 0
    v_mov_b32 v209, 0
    v_mov_b32 v210, 0
    v_mov_b32 v211, 0
    v_mov_b32 v212, 0
    v_mov_b32 v213, 0
    v_mov_b32 v214, 0
    v_mov_b32 v215, 0
    v_mov_b32 v216, 0
    v_mov_b32 v217, 0
    v_mov_b32 v218, 0
    v_mov_b32 v219, 0
    v_mov_b32 v220, 0
    v_mov_b32 v221, 0
    v_mov_b32 v222, 0
    v_mov_b32 v223, 0
    v_mov_b32 v224, 0
    v_mov_b32 v225, 0
    v_mov_b32 v226, 0
    v_mov_b32 v227, 0
    v_mov_b32 v228, 0
    v_mov_b32 v229, 0
    v_mov_b32 v230, 0
    v_mov_b32 v231, 0
    v_mov_b32 v232, 0
    v_mov_b32 v233, 0
    v_mov_b32 v234, 0
    v_mov_b32 v235, 0
    v_mov_b32 v236, 0
    v_mov_b32 v237, 0
    v_mov_b32 v238, 0
    v_mov_b32 v239, 0
    v_mov_b32 v240, 0
    v_mov_b32 v241, 0
    v_mov_b32 v242, 0
    v_mov_b32 v243, 0
    v_mov_b32 v244, 0
    v_mov_b32 v245, 0
    v_mov_b32 v246, 0
    v_mov_b32 v247, 0
    v_mov_b32 v248, 0
    v_mov_b32 v249, 0
    v_mov_b32 v250, 0
    v_mov_b32 v251, 0
    v_mov_b32 v252, 0
    v_mov_b32 v253, 0
    v_mov_b32 v254, 0
    v_mov_b32 v255, 0
    s_mov_b32 s51, 0
    s_add_u32 s52, s51, s49
    s_mov_b32 m0, s52
    s_add_u32 s53, s44, 0
    buffer_load_dwordx4 v10, s[8:11], s53 offen lds
    s_add_u32 s52, s51, s49
    s_add_u32 s52, s52, 1024
    s_mov_b32 m0, s52
    s_add_u32 s53, s44, 16384
    buffer_load_dwordx4 v10, s[8:11], s53 offen lds
    s_add_u32 s52, s51, s49
    s_add_u32 s52, s52, 2048
    s_mov_b32 m0, s52
    s_add_u32 s53, s44, 32768
    buffer_load_dwordx4 v10, s[8:11], s53 offen lds
    s_add_u32 s52, s51, s49
    s_add_u32 s52, s52, 3072
    s_mov_b32 m0, s52
    s_add_u32 s53, s44, 49152
    buffer_load_dwordx4 v10, s[8:11], s53 offen lds
    s_add_u32 s52, s51, s49
    s_add_u32 s52, s52, 4096
    s_mov_b32 m0, s52
    s_add_u32 s53, s44, 65536
    buffer_load_dwordx4 v10, s[8:11], s53 offen lds
    s_add_u32 s52, s51, s49
    s_add_u32 s52, s52, 5120
    s_mov_b32 m0, s52
    s_add_u32 s53, s44, 81920
    buffer_load_dwordx4 v10, s[8:11], s53 offen lds
    s_add_u32 s52, s51, s49
    s_add_u32 s52, s52, 6144
    s_mov_b32 m0, s52
    s_add_u32 s53, s44, 98304
    buffer_load_dwordx4 v10, s[8:11], s53 offen lds
    s_add_u32 s52, s51, s49
    s_add_u32 s52, s52, 7168
    s_mov_b32 m0, s52
    s_add_u32 s53, s44, 114688
    buffer_load_dwordx4 v10, s[8:11], s53 offen lds
    s_add_u32 s52, s51, s50
    s_mov_b32 m0, s52
    s_add_u32 s53, s45, 0
    buffer_load_dwordx4 v11, s[12:15], s53 offen lds
    s_add_u32 s52, s51, s50
    s_add_u32 s52, s52, 1024
    s_mov_b32 m0, s52
    s_add_u32 s53, s45, 28672
    buffer_load_dwordx4 v11, s[12:15], s53 offen lds
    s_add_u32 s52, s51, s50
    s_add_u32 s52, s52, 2048
    s_mov_b32 m0, s52
    s_add_u32 s53, s45, 57344
    buffer_load_dwordx4 v11, s[12:15], s53 offen lds
    s_add_u32 s52, s51, s50
    s_add_u32 s52, s52, 3072
    s_mov_b32 m0, s52
    s_add_u32 s53, s45, 86016
    buffer_load_dwordx4 v11, s[12:15], s53 offen lds
    s_add_u32 s44, s44, 128
    s_add_u32 s45, s45, 458752
    s_add_u32 s51, s51, 49152
    s_cmp_eq_u32 s51, 147456
    s_cselect_b32 s51, 0, s51
    s_add_u32 s52, s51, s49
    s_mov_b32 m0, s52
    s_add_u32 s53, s44, 0
    buffer_load_dwordx4 v10, s[8:11], s53 offen lds
    s_add_u32 s52, s51, s49
    s_add_u32 s52, s52, 1024
    s_mov_b32 m0, s52
    s_add_u32 s53, s44, 16384
    buffer_load_dwordx4 v10, s[8:11], s53 offen lds
    s_add_u32 s52, s51, s49
    s_add_u32 s52, s52, 2048
    s_mov_b32 m0, s52
    s_add_u32 s53, s44, 32768
    buffer_load_dwordx4 v10, s[8:11], s53 offen lds
    s_add_u32 s52, s51, s49
    s_add_u32 s52, s52, 3072
    s_mov_b32 m0, s52
    s_add_u32 s53, s44, 49152
    buffer_load_dwordx4 v10, s[8:11], s53 offen lds
    s_add_u32 s52, s51, s49
    s_add_u32 s52, s52, 4096
    s_mov_b32 m0, s52
    s_add_u32 s53, s44, 65536
    buffer_load_dwordx4 v10, s[8:11], s53 offen lds
    s_add_u32 s52, s51, s49
    s_add_u32 s52, s52, 5120
    s_mov_b32 m0, s52
    s_add_u32 s53, s44, 81920
    buffer_load_dwordx4 v10, s[8:11], s53 offen lds
    s_add_u32 s52, s51, s49
    s_add_u32 s52, s52, 6144
    s_mov_b32 m0, s52
    s_add_u32 s53, s44, 98304
    buffer_load_dwordx4 v10, s[8:11], s53 offen lds
    s_add_u32 s52, s51, s49
    s_add_u32 s52, s52, 7168
    s_mov_b32 m0, s52
    s_add_u32 s53, s44, 114688
    buffer_load_dwordx4 v10, s[8:11], s53 offen lds
    s_add_u32 s52, s51, s50
    s_mov_b32 m0, s52
    s_add_u32 s53, s45, 0
    buffer_load_dwordx4 v11, s[12:15], s53 offen lds
    s_add_u32 s52, s51, s50
    s_add_u32 s52, s52, 1024
    s_mov_b32 m0, s52
    s_add_u32 s53, s45, 28672
    buffer_load_dwordx4 v11, s[12:15], s53 offen lds
    s_add_u32 s52, s51, s50
    s_add_u32 s52, s52, 2048
    s_mov_b32 m0, s52
    s_add_u32 s53, s45, 57344
    buffer_load_dwordx4 v11, s[12:15], s53 offen lds
    s_add_u32 s52, s51, s50
    s_add_u32 s52, s52, 3072
    s_mov_b32 m0, s52
    s_add_u32 s53, s45, 86016
    buffer_load_dwordx4 v11, s[12:15], s53 offen lds
    s_add_u32 s44, s44, 128
    s_add_u32 s45, s45, 458752
    s_add_u32 s51, s51, 49152
    s_cmp_eq_u32 s51, 147456
    s_cselect_b32 s51, 0, s51
    s_mov_b32 s54, 0
    s_mov_b32 s55, 0
.gemm_w1_kernel_loop:
    s_waitcnt vmcnt(12)
    s_barrier
    v_add_u32 v24, s54, v12
    v_add_u32 v25, s54, v13
    v_add_u32 v26, s54, v14
    v_add_u32 v27, s54, v15
    v_add_u32 v28, s54, v20
    v_add_u32 v29, s54, v21
    ds_read_b128 v[32:35], v24 offset:0
    ds_read_b128 v[36:39], v24 offset:4096
    ds_read_b128 v[40:43], v24 offset:8192
    ds_read_b128 v[44:47], v24 offset:12288
    ds_read_b64_tr_b16 v[48:49], v28 offset:0
    ds_read_b64_tr_b16 v[50:51], v28 offset:1024
    ds_read_b64_tr_b16 v[52:53], v29 offset:0
    ds_read_b64_tr_b16 v[54:55], v29 offset:1024
    ds_read_b128 v[56:59], v25 offset:0
    ds_read_b128 v[60:63], v25 offset:4096
    ds_read_b128 v[64:67], v25 offset:8192
    ds_read_b128 v[68:71], v25 offset:12288
    ds_read_b64_tr_b16 v[72:73], v28 offset:4096
    ds_read_b64_tr_b16 v[74:75], v28 offset:5120
    ds_read_b64_tr_b16 v[76:77], v29 offset:4096
    ds_read_b64_tr_b16 v[78:79], v29 offset:5120
    s_waitcnt lgkmcnt(8)
    v_mfma_f32_32x32x16_bf16 v[128:143], v[48:51], v[32:35], v[128:143]
    s_add_u32 s52, s51, s49
    s_mov_b32 m0, s52
    s_add_u32 s53, s44, 0
    buffer_load_dwordx4 v10, s[8:11], s53 offen lds
    v_mfma_f32_32x32x16_bf16 v[144:159], v[52:55], v[32:35], v[144:159]
    v_mfma_f32_32x32x16_bf16 v[160:175], v[48:51], v[36:39], v[160:175]
    s_add_u32 s52, s51, s49
    s_add_u32 s52, s52, 1024
    s_mov_b32 m0, s52
    s_add_u32 s53, s44, 16384
    buffer_load_dwordx4 v10, s[8:11], s53 offen lds
    v_mfma_f32_32x32x16_bf16 v[176:191], v[52:55], v[36:39], v[176:191]
    v_mfma_f32_32x32x16_bf16 v[192:207], v[48:51], v[40:43], v[192:207]
    v_mfma_f32_32x32x16_bf16 v[208:223], v[52:55], v[40:43], v[208:223]
    s_add_u32 s52, s51, s49
    s_add_u32 s52, s52, 2048
    s_mov_b32 m0, s52
    s_add_u32 s53, s44, 32768
    buffer_load_dwordx4 v10, s[8:11], s53 offen lds
    v_mfma_f32_32x32x16_bf16 v[224:239], v[48:51], v[44:47], v[224:239]
    v_mfma_f32_32x32x16_bf16 v[240:255], v[52:55], v[44:47], v[240:255]
    ds_read_b128 v[32:35], v26 offset:0
    ds_read_b128 v[36:39], v26 offset:4096
    ds_read_b128 v[40:43], v26 offset:8192
    ds_read_b128 v[44:47], v26 offset:12288
    ds_read_b64_tr_b16 v[48:49], v28 offset:8192
    ds_read_b64_tr_b16 v[50:51], v28 offset:9216
    ds_read_b64_tr_b16 v[52:53], v29 offset:8192
    ds_read_b64_tr_b16 v[54:55], v29 offset:9216
    s_waitcnt lgkmcnt(8)
    v_mfma_f32_32x32x16_bf16 v[128:143], v[72:75], v[56:59], v[128:143]
    s_add_u32 s52, s51, s49
    s_add_u32 s52, s52, 3072
    s_mov_b32 m0, s52
    s_add_u32 s53, s44, 49152
    buffer_load_dwordx4 v10, s[8:11], s53 offen lds
    v_mfma_f32_32x32x16_bf16 v[144:159], v[76:79], v[56:59], v[144:159]
    v_mfma_f32_32x32x16_bf16 v[160:175], v[72:75], v[60:63], v[160:175]
    s_add_u32 s52, s51, s49
    s_add_u32 s52, s52, 4096
    s_mov_b32 m0, s52
    s_add_u32 s53, s44, 65536
    buffer_load_dwordx4 v10, s[8:11], s53 offen lds
    v_mfma_f32_32x32x16_bf16 v[176:191], v[76:79], v[60:63], v[176:191]
    v_mfma_f32_32x32x16_bf16 v[192:207], v[72:75], v[64:67], v[192:207]
    v_mfma_f32_32x32x16_bf16 v[208:223], v[76:79], v[64:67], v[208:223]
    s_add_u32 s52, s51, s49
    s_add_u32 s52, s52, 5120
    s_mov_b32 m0, s52
    s_add_u32 s53, s44, 81920
    buffer_load_dwordx4 v10, s[8:11], s53 offen lds
    v_mfma_f32_32x32x16_bf16 v[224:239], v[72:75], v[68:71], v[224:239]
    v_mfma_f32_32x32x16_bf16 v[240:255], v[76:79], v[68:71], v[240:255]
    ds_read_b128 v[56:59], v27 offset:0
    ds_read_b128 v[60:63], v27 offset:4096
    ds_read_b128 v[64:67], v27 offset:8192
    ds_read_b128 v[68:71], v27 offset:12288
    ds_read_b64_tr_b16 v[72:73], v28 offset:12288
    ds_read_b64_tr_b16 v[74:75], v28 offset:13312
    ds_read_b64_tr_b16 v[76:77], v29 offset:12288
    ds_read_b64_tr_b16 v[78:79], v29 offset:13312
    s_waitcnt lgkmcnt(8)
    v_mfma_f32_32x32x16_bf16 v[128:143], v[48:51], v[32:35], v[128:143]
    s_add_u32 s52, s51, s49
    s_add_u32 s52, s52, 6144
    s_mov_b32 m0, s52
    s_add_u32 s53, s44, 98304
    buffer_load_dwordx4 v10, s[8:11], s53 offen lds
    v_mfma_f32_32x32x16_bf16 v[144:159], v[52:55], v[32:35], v[144:159]
    v_mfma_f32_32x32x16_bf16 v[160:175], v[48:51], v[36:39], v[160:175]
    s_add_u32 s52, s51, s49
    s_add_u32 s52, s52, 7168
    s_mov_b32 m0, s52
    s_add_u32 s53, s44, 114688
    buffer_load_dwordx4 v10, s[8:11], s53 offen lds
    v_mfma_f32_32x32x16_bf16 v[176:191], v[52:55], v[36:39], v[176:191]
    v_mfma_f32_32x32x16_bf16 v[192:207], v[48:51], v[40:43], v[192:207]
    v_mfma_f32_32x32x16_bf16 v[208:223], v[52:55], v[40:43], v[208:223]
    s_add_u32 s52, s51, s50
    s_mov_b32 m0, s52
    s_add_u32 s53, s45, 0
    buffer_load_dwordx4 v11, s[12:15], s53 offen lds
    v_mfma_f32_32x32x16_bf16 v[224:239], v[48:51], v[44:47], v[224:239]
    v_mfma_f32_32x32x16_bf16 v[240:255], v[52:55], v[44:47], v[240:255]
    s_waitcnt lgkmcnt(0)
    v_mfma_f32_32x32x16_bf16 v[128:143], v[72:75], v[56:59], v[128:143]
    s_add_u32 s52, s51, s50
    s_add_u32 s52, s52, 1024
    s_mov_b32 m0, s52
    s_add_u32 s53, s45, 28672
    buffer_load_dwordx4 v11, s[12:15], s53 offen lds
    v_mfma_f32_32x32x16_bf16 v[144:159], v[76:79], v[56:59], v[144:159]
    v_mfma_f32_32x32x16_bf16 v[160:175], v[72:75], v[60:63], v[160:175]
    s_add_u32 s52, s51, s50
    s_add_u32 s52, s52, 2048
    s_mov_b32 m0, s52
    s_add_u32 s53, s45, 57344
    buffer_load_dwordx4 v11, s[12:15], s53 offen lds
    v_mfma_f32_32x32x16_bf16 v[176:191], v[76:79], v[60:63], v[176:191]
    v_mfma_f32_32x32x16_bf16 v[192:207], v[72:75], v[64:67], v[192:207]
    v_mfma_f32_32x32x16_bf16 v[208:223], v[76:79], v[64:67], v[208:223]
    s_add_u32 s52, s51, s50
    s_add_u32 s52, s52, 3072
    s_mov_b32 m0, s52
    s_add_u32 s53, s45, 86016
    buffer_load_dwordx4 v11, s[12:15], s53 offen lds
    v_mfma_f32_32x32x16_bf16 v[224:239], v[72:75], v[68:71], v[224:239]
    v_mfma_f32_32x32x16_bf16 v[240:255], v[76:79], v[68:71], v[240:255]
    s_add_u32 s44, s44, 128
    s_add_u32 s45, s45, 458752
    s_add_u32 s51, s51, 49152
    s_cmp_eq_u32 s51, 147456
    s_cselect_b32 s51, 0, s51
    s_add_u32 s54, s54, 49152
    s_cmp_eq_u32 s54, 147456
    s_cselect_b32 s54, 0, s54
    s_add_u32 s55, s55, 1
    s_cmp_lt_u32 s55, 16
    s_cbranch_scc1 .gemm_w1_kernel_loop
    s_waitcnt vmcnt(0)
    s_nop 15
    s_nop 15
    s_add_u32 s4, s6, 0x5000000
    s_addc_u32 s5, s7, 0
    s_mov_b32 s16, s4
    s_and_b32 s17, s5, 0xffff
    s_mov_b32 s18, 0xe00000
    s_mov_b32 s19, 0x00020000
    s_mov_b32 s24, s38
    s_and_b32 s25, s39, 0xffff
    s_mov_b32 s26, 0x1c00
    s_mov_b32 s27, 0x00020000
    s_mul_i32 s4, s40, 256
    v_mul_u32_u24 v7, 128, v3
    v_add_u32 v7, v7, v5
    v_add_u32 v7, s4, v7
    s_mov_b32 s47, 7168
    v_mul_lo_u32 v7, v7, s47
    v_mul_u32_u24 v8, 64, v4
    v_lshl_add_u32 v8, v6, 2, v8
    v_add_u32 v8, s42, v8
    v_lshlrev_b32 v8, 1, v8
    v_add_u32 v7, v7, v8
    buffer_load_dwordx2 v[56:57], v8, s[24:27], 0 offen offset:0
    buffer_load_dwordx2 v[58:59], v8, s[24:27], 0 offen offset:16
    buffer_load_dwordx2 v[60:61], v8, s[24:27], 0 offen offset:32
    buffer_load_dwordx2 v[62:63], v8, s[24:27], 0 offen offset:48
    s_mov_b32 s4, 0
    s_waitcnt vmcnt(0)
    v_cvt_pk_bf16_f32 v32, v128, v129
    v_cvt_pk_bf16_f32 v33, v130, v131
    v_lshlrev_b32 v34, 16, v32
    v_and_b32 v35, 0xffff0000, v32
    v_lshlrev_b32 v36, 16, v33
    v_and_b32 v37, 0xffff0000, v33
    v_lshlrev_b32 v38, 16, v56
    v_add_f32 v34, v34, v38
    v_and_b32 v38, 0xffff0000, v56
    v_add_f32 v35, v35, v38
    v_lshlrev_b32 v38, 16, v57
    v_add_f32 v36, v36, v38
    v_and_b32 v38, 0xffff0000, v57
    v_add_f32 v37, v37, v38
    v_cvt_pk_bf16_f32 v32, v34, v35
    v_cvt_pk_bf16_f32 v33, v36, v37
    v_lshlrev_b32 v34, 16, v32
    v_and_b32 v35, 0xffff0000, v32
    v_lshlrev_b32 v36, 16, v33
    v_and_b32 v37, 0xffff0000, v33
    v_mul_f32 v38, v34, v34
    v_mul_f32 v38, v38, v34
    v_mov_b32 v39, v34
    v_fmac_f32 v39, 0x3d372713, v38
    v_mul_f32 v39, 0xc0135761, v39
    v_exp_f32 v39, v39
    s_nop 0
    v_add_f32 v39, 1.0, v39
    v_rcp_f32 v39, v39
    s_nop 0
    v_mul_f32 v34, v34, v39
    v_mul_f32 v38, v35, v35
    v_mul_f32 v38, v38, v35
    v_mov_b32 v39, v35
    v_fmac_f32 v39, 0x3d372713, v38
    v_mul_f32 v39, 0xc0135761, v39
    v_exp_f32 v39, v39
    s_nop 0
    v_add_f32 v39, 1.0, v39
    v_rcp_f32 v39, v39
    s_nop 0
    v_mul_f32 v35, v35, v39
    v_mul_f32 v38, v36, v36
    v_mul_f32 v38, v38, v36
    v_mov_b32 v39, v36
    v_fmac_f32 v39, 0x3d372713, v38
    v_mul_f32 v39, 0xc0135761, v39
    v_exp_f32 v39, v39
    s_nop 0
    v_add_f32 v39, 1.0, v39
    v_rcp_f32 v39, v39
    s_nop 0
    v_mul_f32 v36, v36, v39
    v_mul_f32 v38, v37, v37
    v_mul_f32 v38, v38, v37
    v_mov_b32 v39, v37
    v_fmac_f32 v39, 0x3d372713, v38
    v_mul_f32 v39, 0xc0135761, v39
    v_exp_f32 v39, v39
    s_nop 0
    v_add_f32 v39, 1.0, v39
    v_rcp_f32 v39, v39
    s_nop 0
    v_mul_f32 v37, v37, v39
    v_cvt_pk_bf16_f32 v32, v34, v35
    v_cvt_pk_bf16_f32 v33, v36, v37
    buffer_store_dwordx2 v[32:33], v7, s[16:19], s4 offen offset:0
    s_nop 1
    v_cvt_pk_bf16_f32 v32, v132, v133
    v_cvt_pk_bf16_f32 v33, v134, v135
    v_lshlrev_b32 v34, 16, v32
    v_and_b32 v35, 0xffff0000, v32
    v_lshlrev_b32 v36, 16, v33
    v_and_b32 v37, 0xffff0000, v33
    v_lshlrev_b32 v38, 16, v58
    v_add_f32 v34, v34, v38
    v_and_b32 v38, 0xffff0000, v58
    v_add_f32 v35, v35, v38
    v_lshlrev_b32 v38, 16, v59
    v_add_f32 v36, v36, v38
    v_and_b32 v38, 0xffff0000, v59
    v_add_f32 v37, v37, v38
    v_cvt_pk_bf16_f32 v32, v34, v35
    v_cvt_pk_bf16_f32 v33, v36, v37
    v_lshlrev_b32 v34, 16, v32
    v_and_b32 v35, 0xffff0000, v32
    v_lshlrev_b32 v36, 16, v33
    v_and_b32 v37, 0xffff0000, v33
    v_mul_f32 v38, v34, v34
    v_mul_f32 v38, v38, v34
    v_mov_b32 v39, v34
    v_fmac_f32 v39, 0x3d372713, v38
    v_mul_f32 v39, 0xc0135761, v39
    v_exp_f32 v39, v39
    s_nop 0
    v_add_f32 v39, 1.0, v39
    v_rcp_f32 v39, v39
    s_nop 0
    v_mul_f32 v34, v34, v39
    v_mul_f32 v38, v35, v35
    v_mul_f32 v38, v38, v35
    v_mov_b32 v39, v35
    v_fmac_f32 v39, 0x3d372713, v38
    v_mul_f32 v39, 0xc0135761, v39
    v_exp_f32 v39, v39
    s_nop 0
    v_add_f32 v39, 1.0, v39
    v_rcp_f32 v39, v39
    s_nop 0
    v_mul_f32 v35, v35, v39
    v_mul_f32 v38, v36, v36
    v_mul_f32 v38, v38, v36
    v_mov_b32 v39, v36
    v_fmac_f32 v39, 0x3d372713, v38
    v_mul_f32 v39, 0xc0135761, v39
    v_exp_f32 v39, v39
    s_nop 0
    v_add_f32 v39, 1.0, v39
    v_rcp_f32 v39, v39
    s_nop 0
    v_mul_f32 v36, v36, v39
    v_mul_f32 v38, v37, v37
    v_mul_f32 v38, v38, v37
    v_mov_b32 v39, v37
    v_fmac_f32 v39, 0x3d372713, v38
    v_mul_f32 v39, 0xc0135761, v39
    v_exp_f32 v39, v39
    s_nop 0
    v_add_f32 v39, 1.0, v39
    v_rcp_f32 v39, v39
    s_nop 0
    v_mul_f32 v37, v37, v39
    v_cvt_pk_bf16_f32 v32, v34, v35
    v_cvt_pk_bf16_f32 v33, v36, v37
    buffer_store_dwordx2 v[32:33], v7, s[16:19], s4 offen offset:16
    s_nop 1
    v_cvt_pk_bf16_f32 v32, v136, v137
    v_cvt_pk_bf16_f32 v33, v138, v139
    v_lshlrev_b32 v34, 16, v32
    v_and_b32 v35, 0xffff0000, v32
    v_lshlrev_b32 v36, 16, v33
    v_and_b32 v37, 0xffff0000, v33
    v_lshlrev_b32 v38, 16, v60
    v_add_f32 v34, v34, v38
    v_and_b32 v38, 0xffff0000, v60
    v_add_f32 v35, v35, v38
    v_lshlrev_b32 v38, 16, v61
    v_add_f32 v36, v36, v38
    v_and_b32 v38, 0xffff0000, v61
    v_add_f32 v37, v37, v38
    v_cvt_pk_bf16_f32 v32, v34, v35
    v_cvt_pk_bf16_f32 v33, v36, v37
    v_lshlrev_b32 v34, 16, v32
    v_and_b32 v35, 0xffff0000, v32
    v_lshlrev_b32 v36, 16, v33
    v_and_b32 v37, 0xffff0000, v33
    v_mul_f32 v38, v34, v34
    v_mul_f32 v38, v38, v34
    v_mov_b32 v39, v34
    v_fmac_f32 v39, 0x3d372713, v38
    v_mul_f32 v39, 0xc0135761, v39
    v_exp_f32 v39, v39
    s_nop 0
    v_add_f32 v39, 1.0, v39
    v_rcp_f32 v39, v39
    s_nop 0
    v_mul_f32 v34, v34, v39
    v_mul_f32 v38, v35, v35
    v_mul_f32 v38, v38, v35
    v_mov_b32 v39, v35
    v_fmac_f32 v39, 0x3d372713, v38
    v_mul_f32 v39, 0xc0135761, v39
    v_exp_f32 v39, v39
    s_nop 0
    v_add_f32 v39, 1.0, v39
    v_rcp_f32 v39, v39
    s_nop 0
    v_mul_f32 v35, v35, v39
    v_mul_f32 v38, v36, v36
    v_mul_f32 v38, v38, v36
    v_mov_b32 v39, v36
    v_fmac_f32 v39, 0x3d372713, v38
    v_mul_f32 v39, 0xc0135761, v39
    v_exp_f32 v39, v39
    s_nop 0
    v_add_f32 v39, 1.0, v39
    v_rcp_f32 v39, v39
    s_nop 0
    v_mul_f32 v36, v36, v39
    v_mul_f32 v38, v37, v37
    v_mul_f32 v38, v38, v37
    v_mov_b32 v39, v37
    v_fmac_f32 v39, 0x3d372713, v38
    v_mul_f32 v39, 0xc0135761, v39
    v_exp_f32 v39, v39
    s_nop 0
    v_add_f32 v39, 1.0, v39
    v_rcp_f32 v39, v39
    s_nop 0
    v_mul_f32 v37, v37, v39
    v_cvt_pk_bf16_f32 v32, v34, v35
    v_cvt_pk_bf16_f32 v33, v36, v37
    buffer_store_dwordx2 v[32:33], v7, s[16:19], s4 offen offset:32
    s_nop 1
    v_cvt_pk_bf16_f32 v32, v140, v141
    v_cvt_pk_bf16_f32 v33, v142, v143
    v_lshlrev_b32 v34, 16, v32
    v_and_b32 v35, 0xffff0000, v32
    v_lshlrev_b32 v36, 16, v33
    v_and_b32 v37, 0xffff0000, v33
    v_lshlrev_b32 v38, 16, v62
    v_add_f32 v34, v34, v38
    v_and_b32 v38, 0xffff0000, v62
    v_add_f32 v35, v35, v38
    v_lshlrev_b32 v38, 16, v63
    v_add_f32 v36, v36, v38
    v_and_b32 v38, 0xffff0000, v63
    v_add_f32 v37, v37, v38
    v_cvt_pk_bf16_f32 v32, v34, v35
    v_cvt_pk_bf16_f32 v33, v36, v37
    v_lshlrev_b32 v34, 16, v32
    v_and_b32 v35, 0xffff0000, v32
    v_lshlrev_b32 v36, 16, v33
    v_and_b32 v37, 0xffff0000, v33
    v_mul_f32 v38, v34, v34
    v_mul_f32 v38, v38, v34
    v_mov_b32 v39, v34
    v_fmac_f32 v39, 0x3d372713, v38
    v_mul_f32 v39, 0xc0135761, v39
    v_exp_f32 v39, v39
    s_nop 0
    v_add_f32 v39, 1.0, v39
    v_rcp_f32 v39, v39
    s_nop 0
    v_mul_f32 v34, v34, v39
    v_mul_f32 v38, v35, v35
    v_mul_f32 v38, v38, v35
    v_mov_b32 v39, v35
    v_fmac_f32 v39, 0x3d372713, v38
    v_mul_f32 v39, 0xc0135761, v39
    v_exp_f32 v39, v39
    s_nop 0
    v_add_f32 v39, 1.0, v39
    v_rcp_f32 v39, v39
    s_nop 0
    v_mul_f32 v35, v35, v39
    v_mul_f32 v38, v36, v36
    v_mul_f32 v38, v38, v36
    v_mov_b32 v39, v36
    v_fmac_f32 v39, 0x3d372713, v38
    v_mul_f32 v39, 0xc0135761, v39
    v_exp_f32 v39, v39
    s_nop 0
    v_add_f32 v39, 1.0, v39
    v_rcp_f32 v39, v39
    s_nop 0
    v_mul_f32 v36, v36, v39
    v_mul_f32 v38, v37, v37
    v_mul_f32 v38, v38, v37
    v_mov_b32 v39, v37
    v_fmac_f32 v39, 0x3d372713, v38
    v_mul_f32 v39, 0xc0135761, v39
    v_exp_f32 v39, v39
    s_nop 0
    v_add_f32 v39, 1.0, v39
    v_rcp_f32 v39, v39
    s_nop 0
    v_mul_f32 v37, v37, v39
    v_cvt_pk_bf16_f32 v32, v34, v35
    v_cvt_pk_bf16_f32 v33, v36, v37
    buffer_store_dwordx2 v[32:33], v7, s[16:19], s4 offen offset:48
    s_nop 1
    s_mov_b32 s4, 229376
    s_waitcnt vmcnt(0)
    v_cvt_pk_bf16_f32 v32, v160, v161
    v_cvt_pk_bf16_f32 v33, v162, v163
    v_lshlrev_b32 v34, 16, v32
    v_and_b32 v35, 0xffff0000, v32
    v_lshlrev_b32 v36, 16, v33
    v_and_b32 v37, 0xffff0000, v33
    v_lshlrev_b32 v38, 16, v56
    v_add_f32 v34, v34, v38
    v_and_b32 v38, 0xffff0000, v56
    v_add_f32 v35, v35, v38
    v_lshlrev_b32 v38, 16, v57
    v_add_f32 v36, v36, v38
    v_and_b32 v38, 0xffff0000, v57
    v_add_f32 v37, v37, v38
    v_cvt_pk_bf16_f32 v32, v34, v35
    v_cvt_pk_bf16_f32 v33, v36, v37
    v_lshlrev_b32 v34, 16, v32
    v_and_b32 v35, 0xffff0000, v32
    v_lshlrev_b32 v36, 16, v33
    v_and_b32 v37, 0xffff0000, v33
    v_mul_f32 v38, v34, v34
    v_mul_f32 v38, v38, v34
    v_mov_b32 v39, v34
    v_fmac_f32 v39, 0x3d372713, v38
    v_mul_f32 v39, 0xc0135761, v39
    v_exp_f32 v39, v39
    s_nop 0
    v_add_f32 v39, 1.0, v39
    v_rcp_f32 v39, v39
    s_nop 0
    v_mul_f32 v34, v34, v39
    v_mul_f32 v38, v35, v35
    v_mul_f32 v38, v38, v35
    v_mov_b32 v39, v35
    v_fmac_f32 v39, 0x3d372713, v38
    v_mul_f32 v39, 0xc0135761, v39
    v_exp_f32 v39, v39
    s_nop 0
    v_add_f32 v39, 1.0, v39
    v_rcp_f32 v39, v39
    s_nop 0
    v_mul_f32 v35, v35, v39
    v_mul_f32 v38, v36, v36
    v_mul_f32 v38, v38, v36
    v_mov_b32 v39, v36
    v_fmac_f32 v39, 0x3d372713, v38
    v_mul_f32 v39, 0xc0135761, v39
    v_exp_f32 v39, v39
    s_nop 0
    v_add_f32 v39, 1.0, v39
    v_rcp_f32 v39, v39
    s_nop 0
    v_mul_f32 v36, v36, v39
    v_mul_f32 v38, v37, v37
    v_mul_f32 v38, v38, v37
    v_mov_b32 v39, v37
    v_fmac_f32 v39, 0x3d372713, v38
    v_mul_f32 v39, 0xc0135761, v39
    v_exp_f32 v39, v39
    s_nop 0
    v_add_f32 v39, 1.0, v39
    v_rcp_f32 v39, v39
    s_nop 0
    v_mul_f32 v37, v37, v39
    v_cvt_pk_bf16_f32 v32, v34, v35
    v_cvt_pk_bf16_f32 v33, v36, v37
    buffer_store_dwordx2 v[32:33], v7, s[16:19], s4 offen offset:0
    s_nop 1
    v_cvt_pk_bf16_f32 v32, v164, v165
    v_cvt_pk_bf16_f32 v33, v166, v167
    v_lshlrev_b32 v34, 16, v32
    v_and_b32 v35, 0xffff0000, v32
    v_lshlrev_b32 v36, 16, v33
    v_and_b32 v37, 0xffff0000, v33
    v_lshlrev_b32 v38, 16, v58
    v_add_f32 v34, v34, v38
    v_and_b32 v38, 0xffff0000, v58
    v_add_f32 v35, v35, v38
    v_lshlrev_b32 v38, 16, v59
    v_add_f32 v36, v36, v38
    v_and_b32 v38, 0xffff0000, v59
    v_add_f32 v37, v37, v38
    v_cvt_pk_bf16_f32 v32, v34, v35
    v_cvt_pk_bf16_f32 v33, v36, v37
    v_lshlrev_b32 v34, 16, v32
    v_and_b32 v35, 0xffff0000, v32
    v_lshlrev_b32 v36, 16, v33
    v_and_b32 v37, 0xffff0000, v33
    v_mul_f32 v38, v34, v34
    v_mul_f32 v38, v38, v34
    v_mov_b32 v39, v34
    v_fmac_f32 v39, 0x3d372713, v38
    v_mul_f32 v39, 0xc0135761, v39
    v_exp_f32 v39, v39
    s_nop 0
    v_add_f32 v39, 1.0, v39
    v_rcp_f32 v39, v39
    s_nop 0
    v_mul_f32 v34, v34, v39
    v_mul_f32 v38, v35, v35
    v_mul_f32 v38, v38, v35
    v_mov_b32 v39, v35
    v_fmac_f32 v39, 0x3d372713, v38
    v_mul_f32 v39, 0xc0135761, v39
    v_exp_f32 v39, v39
    s_nop 0
    v_add_f32 v39, 1.0, v39
    v_rcp_f32 v39, v39
    s_nop 0
    v_mul_f32 v35, v35, v39
    v_mul_f32 v38, v36, v36
    v_mul_f32 v38, v38, v36
    v_mov_b32 v39, v36
    v_fmac_f32 v39, 0x3d372713, v38
    v_mul_f32 v39, 0xc0135761, v39
    v_exp_f32 v39, v39
    s_nop 0
    v_add_f32 v39, 1.0, v39
    v_rcp_f32 v39, v39
    s_nop 0
    v_mul_f32 v36, v36, v39
    v_mul_f32 v38, v37, v37
    v_mul_f32 v38, v38, v37
    v_mov_b32 v39, v37
    v_fmac_f32 v39, 0x3d372713, v38
    v_mul_f32 v39, 0xc0135761, v39
    v_exp_f32 v39, v39
    s_nop 0
    v_add_f32 v39, 1.0, v39
    v_rcp_f32 v39, v39
    s_nop 0
    v_mul_f32 v37, v37, v39
    v_cvt_pk_bf16_f32 v32, v34, v35
    v_cvt_pk_bf16_f32 v33, v36, v37
    buffer_store_dwordx2 v[32:33], v7, s[16:19], s4 offen offset:16
    s_nop 1
    v_cvt_pk_bf16_f32 v32, v168, v169
    v_cvt_pk_bf16_f32 v33, v170, v171
    v_lshlrev_b32 v34, 16, v32
    v_and_b32 v35, 0xffff0000, v32
    v_lshlrev_b32 v36, 16, v33
    v_and_b32 v37, 0xffff0000, v33
    v_lshlrev_b32 v38, 16, v60
    v_add_f32 v34, v34, v38
    v_and_b32 v38, 0xffff0000, v60
    v_add_f32 v35, v35, v38
    v_lshlrev_b32 v38, 16, v61
    v_add_f32 v36, v36, v38
    v_and_b32 v38, 0xffff0000, v61
    v_add_f32 v37, v37, v38
    v_cvt_pk_bf16_f32 v32, v34, v35
    v_cvt_pk_bf16_f32 v33, v36, v37
    v_lshlrev_b32 v34, 16, v32
    v_and_b32 v35, 0xffff0000, v32
    v_lshlrev_b32 v36, 16, v33
    v_and_b32 v37, 0xffff0000, v33
    v_mul_f32 v38, v34, v34
    v_mul_f32 v38, v38, v34
    v_mov_b32 v39, v34
    v_fmac_f32 v39, 0x3d372713, v38
    v_mul_f32 v39, 0xc0135761, v39
    v_exp_f32 v39, v39
    s_nop 0
    v_add_f32 v39, 1.0, v39
    v_rcp_f32 v39, v39
    s_nop 0
    v_mul_f32 v34, v34, v39
    v_mul_f32 v38, v35, v35
    v_mul_f32 v38, v38, v35
    v_mov_b32 v39, v35
    v_fmac_f32 v39, 0x3d372713, v38
    v_mul_f32 v39, 0xc0135761, v39
    v_exp_f32 v39, v39
    s_nop 0
    v_add_f32 v39, 1.0, v39
    v_rcp_f32 v39, v39
    s_nop 0
    v_mul_f32 v35, v35, v39
    v_mul_f32 v38, v36, v36
    v_mul_f32 v38, v38, v36
    v_mov_b32 v39, v36
    v_fmac_f32 v39, 0x3d372713, v38
    v_mul_f32 v39, 0xc0135761, v39
    v_exp_f32 v39, v39
    s_nop 0
    v_add_f32 v39, 1.0, v39
    v_rcp_f32 v39, v39
    s_nop 0
    v_mul_f32 v36, v36, v39
    v_mul_f32 v38, v37, v37
    v_mul_f32 v38, v38, v37
    v_mov_b32 v39, v37
    v_fmac_f32 v39, 0x3d372713, v38
    v_mul_f32 v39, 0xc0135761, v39
    v_exp_f32 v39, v39
    s_nop 0
    v_add_f32 v39, 1.0, v39
    v_rcp_f32 v39, v39
    s_nop 0
    v_mul_f32 v37, v37, v39
    v_cvt_pk_bf16_f32 v32, v34, v35
    v_cvt_pk_bf16_f32 v33, v36, v37
    buffer_store_dwordx2 v[32:33], v7, s[16:19], s4 offen offset:32
    s_nop 1
    v_cvt_pk_bf16_f32 v32, v172, v173
    v_cvt_pk_bf16_f32 v33, v174, v175
    v_lshlrev_b32 v34, 16, v32
    v_and_b32 v35, 0xffff0000, v32
    v_lshlrev_b32 v36, 16, v33
    v_and_b32 v37, 0xffff0000, v33
    v_lshlrev_b32 v38, 16, v62
    v_add_f32 v34, v34, v38
    v_and_b32 v38, 0xffff0000, v62
    v_add_f32 v35, v35, v38
    v_lshlrev_b32 v38, 16, v63
    v_add_f32 v36, v36, v38
    v_and_b32 v38, 0xffff0000, v63
    v_add_f32 v37, v37, v38
    v_cvt_pk_bf16_f32 v32, v34, v35
    v_cvt_pk_bf16_f32 v33, v36, v37
    v_lshlrev_b32 v34, 16, v32
    v_and_b32 v35, 0xffff0000, v32
    v_lshlrev_b32 v36, 16, v33
    v_and_b32 v37, 0xffff0000, v33
    v_mul_f32 v38, v34, v34
    v_mul_f32 v38, v38, v34
    v_mov_b32 v39, v34
    v_fmac_f32 v39, 0x3d372713, v38
    v_mul_f32 v39, 0xc0135761, v39
    v_exp_f32 v39, v39
    s_nop 0
    v_add_f32 v39, 1.0, v39
    v_rcp_f32 v39, v39
    s_nop 0
    v_mul_f32 v34, v34, v39
    v_mul_f32 v38, v35, v35
    v_mul_f32 v38, v38, v35
    v_mov_b32 v39, v35
    v_fmac_f32 v39, 0x3d372713, v38
    v_mul_f32 v39, 0xc0135761, v39
    v_exp_f32 v39, v39
    s_nop 0
    v_add_f32 v39, 1.0, v39
    v_rcp_f32 v39, v39
    s_nop 0
    v_mul_f32 v35, v35, v39
    v_mul_f32 v38, v36, v36
    v_mul_f32 v38, v38, v36
    v_mov_b32 v39, v36
    v_fmac_f32 v39, 0x3d372713, v38
    v_mul_f32 v39, 0xc0135761, v39
    v_exp_f32 v39, v39
    s_nop 0
    v_add_f32 v39, 1.0, v39
    v_rcp_f32 v39, v39
    s_nop 0
    v_mul_f32 v36, v36, v39
    v_mul_f32 v38, v37, v37
    v_mul_f32 v38, v38, v37
    v_mov_b32 v39, v37
    v_fmac_f32 v39, 0x3d372713, v38
    v_mul_f32 v39, 0xc0135761, v39
    v_exp_f32 v39, v39
    s_nop 0
    v_add_f32 v39, 1.0, v39
    v_rcp_f32 v39, v39
    s_nop 0
    v_mul_f32 v37, v37, v39
    v_cvt_pk_bf16_f32 v32, v34, v35
    v_cvt_pk_bf16_f32 v33, v36, v37
    buffer_store_dwordx2 v[32:33], v7, s[16:19], s4 offen offset:48
    s_nop 1
    s_mov_b32 s4, 458752
    s_waitcnt vmcnt(0)
    v_cvt_pk_bf16_f32 v32, v192, v193
    v_cvt_pk_bf16_f32 v33, v194, v195
    v_lshlrev_b32 v34, 16, v32
    v_and_b32 v35, 0xffff0000, v32
    v_lshlrev_b32 v36, 16, v33
    v_and_b32 v37, 0xffff0000, v33
    v_lshlrev_b32 v38, 16, v56
    v_add_f32 v34, v34, v38
    v_and_b32 v38, 0xffff0000, v56
    v_add_f32 v35, v35, v38
    v_lshlrev_b32 v38, 16, v57
    v_add_f32 v36, v36, v38
    v_and_b32 v38, 0xffff0000, v57
    v_add_f32 v37, v37, v38
    v_cvt_pk_bf16_f32 v32, v34, v35
    v_cvt_pk_bf16_f32 v33, v36, v37
    v_lshlrev_b32 v34, 16, v32
    v_and_b32 v35, 0xffff0000, v32
    v_lshlrev_b32 v36, 16, v33
    v_and_b32 v37, 0xffff0000, v33
    v_mul_f32 v38, v34, v34
    v_mul_f32 v38, v38, v34
    v_mov_b32 v39, v34
    v_fmac_f32 v39, 0x3d372713, v38
    v_mul_f32 v39, 0xc0135761, v39
    v_exp_f32 v39, v39
    s_nop 0
    v_add_f32 v39, 1.0, v39
    v_rcp_f32 v39, v39
    s_nop 0
    v_mul_f32 v34, v34, v39
    v_mul_f32 v38, v35, v35
    v_mul_f32 v38, v38, v35
    v_mov_b32 v39, v35
    v_fmac_f32 v39, 0x3d372713, v38
    v_mul_f32 v39, 0xc0135761, v39
    v_exp_f32 v39, v39
    s_nop 0
    v_add_f32 v39, 1.0, v39
    v_rcp_f32 v39, v39
    s_nop 0
    v_mul_f32 v35, v35, v39
    v_mul_f32 v38, v36, v36
    v_mul_f32 v38, v38, v36
    v_mov_b32 v39, v36
    v_fmac_f32 v39, 0x3d372713, v38
    v_mul_f32 v39, 0xc0135761, v39
    v_exp_f32 v39, v39
    s_nop 0
    v_add_f32 v39, 1.0, v39
    v_rcp_f32 v39, v39
    s_nop 0
    v_mul_f32 v36, v36, v39
    v_mul_f32 v38, v37, v37
    v_mul_f32 v38, v38, v37
    v_mov_b32 v39, v37
    v_fmac_f32 v39, 0x3d372713, v38
    v_mul_f32 v39, 0xc0135761, v39
    v_exp_f32 v39, v39
    s_nop 0
    v_add_f32 v39, 1.0, v39
    v_rcp_f32 v39, v39
    s_nop 0
    v_mul_f32 v37, v37, v39
    v_cvt_pk_bf16_f32 v32, v34, v35
    v_cvt_pk_bf16_f32 v33, v36, v37
    buffer_store_dwordx2 v[32:33], v7, s[16:19], s4 offen offset:0
    s_nop 1
    v_cvt_pk_bf16_f32 v32, v196, v197
    v_cvt_pk_bf16_f32 v33, v198, v199
    v_lshlrev_b32 v34, 16, v32
    v_and_b32 v35, 0xffff0000, v32
    v_lshlrev_b32 v36, 16, v33
    v_and_b32 v37, 0xffff0000, v33
    v_lshlrev_b32 v38, 16, v58
    v_add_f32 v34, v34, v38
    v_and_b32 v38, 0xffff0000, v58
    v_add_f32 v35, v35, v38
    v_lshlrev_b32 v38, 16, v59
    v_add_f32 v36, v36, v38
    v_and_b32 v38, 0xffff0000, v59
    v_add_f32 v37, v37, v38
    v_cvt_pk_bf16_f32 v32, v34, v35
    v_cvt_pk_bf16_f32 v33, v36, v37
    v_lshlrev_b32 v34, 16, v32
    v_and_b32 v35, 0xffff0000, v32
    v_lshlrev_b32 v36, 16, v33
    v_and_b32 v37, 0xffff0000, v33
    v_mul_f32 v38, v34, v34
    v_mul_f32 v38, v38, v34
    v_mov_b32 v39, v34
    v_fmac_f32 v39, 0x3d372713, v38
    v_mul_f32 v39, 0xc0135761, v39
    v_exp_f32 v39, v39
    s_nop 0
    v_add_f32 v39, 1.0, v39
    v_rcp_f32 v39, v39
    s_nop 0
    v_mul_f32 v34, v34, v39
    v_mul_f32 v38, v35, v35
    v_mul_f32 v38, v38, v35
    v_mov_b32 v39, v35
    v_fmac_f32 v39, 0x3d372713, v38
    v_mul_f32 v39, 0xc0135761, v39
    v_exp_f32 v39, v39
    s_nop 0
    v_add_f32 v39, 1.0, v39
    v_rcp_f32 v39, v39
    s_nop 0
    v_mul_f32 v35, v35, v39
    v_mul_f32 v38, v36, v36
    v_mul_f32 v38, v38, v36
    v_mov_b32 v39, v36
    v_fmac_f32 v39, 0x3d372713, v38
    v_mul_f32 v39, 0xc0135761, v39
    v_exp_f32 v39, v39
    s_nop 0
    v_add_f32 v39, 1.0, v39
    v_rcp_f32 v39, v39
    s_nop 0
    v_mul_f32 v36, v36, v39
    v_mul_f32 v38, v37, v37
    v_mul_f32 v38, v38, v37
    v_mov_b32 v39, v37
    v_fmac_f32 v39, 0x3d372713, v38
    v_mul_f32 v39, 0xc0135761, v39
    v_exp_f32 v39, v39
    s_nop 0
    v_add_f32 v39, 1.0, v39
    v_rcp_f32 v39, v39
    s_nop 0
    v_mul_f32 v37, v37, v39
    v_cvt_pk_bf16_f32 v32, v34, v35
    v_cvt_pk_bf16_f32 v33, v36, v37
    buffer_store_dwordx2 v[32:33], v7, s[16:19], s4 offen offset:16
    s_nop 1
    v_cvt_pk_bf16_f32 v32, v200, v201
    v_cvt_pk_bf16_f32 v33, v202, v203
    v_lshlrev_b32 v34, 16, v32
    v_and_b32 v35, 0xffff0000, v32
    v_lshlrev_b32 v36, 16, v33
    v_and_b32 v37, 0xffff0000, v33
    v_lshlrev_b32 v38, 16, v60
    v_add_f32 v34, v34, v38
    v_and_b32 v38, 0xffff0000, v60
    v_add_f32 v35, v35, v38
    v_lshlrev_b32 v38, 16, v61
    v_add_f32 v36, v36, v38
    v_and_b32 v38, 0xffff0000, v61
    v_add_f32 v37, v37, v38
    v_cvt_pk_bf16_f32 v32, v34, v35
    v_cvt_pk_bf16_f32 v33, v36, v37
    v_lshlrev_b32 v34, 16, v32
    v_and_b32 v35, 0xffff0000, v32
    v_lshlrev_b32 v36, 16, v33
    v_and_b32 v37, 0xffff0000, v33
    v_mul_f32 v38, v34, v34
    v_mul_f32 v38, v38, v34
    v_mov_b32 v39, v34
    v_fmac_f32 v39, 0x3d372713, v38
    v_mul_f32 v39, 0xc0135761, v39
    v_exp_f32 v39, v39
    s_nop 0
    v_add_f32 v39, 1.0, v39
    v_rcp_f32 v39, v39
    s_nop 0
    v_mul_f32 v34, v34, v39
    v_mul_f32 v38, v35, v35
    v_mul_f32 v38, v38, v35
    v_mov_b32 v39, v35
    v_fmac_f32 v39, 0x3d372713, v38
    v_mul_f32 v39, 0xc0135761, v39
    v_exp_f32 v39, v39
    s_nop 0
    v_add_f32 v39, 1.0, v39
    v_rcp_f32 v39, v39
    s_nop 0
    v_mul_f32 v35, v35, v39
    v_mul_f32 v38, v36, v36
    v_mul_f32 v38, v38, v36
    v_mov_b32 v39, v36
    v_fmac_f32 v39, 0x3d372713, v38
    v_mul_f32 v39, 0xc0135761, v39
    v_exp_f32 v39, v39
    s_nop 0
    v_add_f32 v39, 1.0, v39
    v_rcp_f32 v39, v39
    s_nop 0
    v_mul_f32 v36, v36, v39
    v_mul_f32 v38, v37, v37
    v_mul_f32 v38, v38, v37
    v_mov_b32 v39, v37
    v_fmac_f32 v39, 0x3d372713, v38
    v_mul_f32 v39, 0xc0135761, v39
    v_exp_f32 v39, v39
    s_nop 0
    v_add_f32 v39, 1.0, v39
    v_rcp_f32 v39, v39
    s_nop 0
    v_mul_f32 v37, v37, v39
    v_cvt_pk_bf16_f32 v32, v34, v35
    v_cvt_pk_bf16_f32 v33, v36, v37
    buffer_store_dwordx2 v[32:33], v7, s[16:19], s4 offen offset:32
    s_nop 1
    v_cvt_pk_bf16_f32 v32, v204, v205
    v_cvt_pk_bf16_f32 v33, v206, v207
    v_lshlrev_b32 v34, 16, v32
    v_and_b32 v35, 0xffff0000, v32
    v_lshlrev_b32 v36, 16, v33
    v_and_b32 v37, 0xffff0000, v33
    v_lshlrev_b32 v38, 16, v62
    v_add_f32 v34, v34, v38
    v_and_b32 v38, 0xffff0000, v62
    v_add_f32 v35, v35, v38
    v_lshlrev_b32 v38, 16, v63
    v_add_f32 v36, v36, v38
    v_and_b32 v38, 0xffff0000, v63
    v_add_f32 v37, v37, v38
    v_cvt_pk_bf16_f32 v32, v34, v35
    v_cvt_pk_bf16_f32 v33, v36, v37
    v_lshlrev_b32 v34, 16, v32
    v_and_b32 v35, 0xffff0000, v32
    v_lshlrev_b32 v36, 16, v33
    v_and_b32 v37, 0xffff0000, v33
    v_mul_f32 v38, v34, v34
    v_mul_f32 v38, v38, v34
    v_mov_b32 v39, v34
    v_fmac_f32 v39, 0x3d372713, v38
    v_mul_f32 v39, 0xc0135761, v39
    v_exp_f32 v39, v39
    s_nop 0
    v_add_f32 v39, 1.0, v39
    v_rcp_f32 v39, v39
    s_nop 0
    v_mul_f32 v34, v34, v39
    v_mul_f32 v38, v35, v35
    v_mul_f32 v38, v38, v35
    v_mov_b32 v39, v35
    v_fmac_f32 v39, 0x3d372713, v38
    v_mul_f32 v39, 0xc0135761, v39
    v_exp_f32 v39, v39
    s_nop 0
    v_add_f32 v39, 1.0, v39
    v_rcp_f32 v39, v39
    s_nop 0
    v_mul_f32 v35, v35, v39
    v_mul_f32 v38, v36, v36
    v_mul_f32 v38, v38, v36
    v_mov_b32 v39, v36
    v_fmac_f32 v39, 0x3d372713, v38
    v_mul_f32 v39, 0xc0135761, v39
    v_exp_f32 v39, v39
    s_nop 0
    v_add_f32 v39, 1.0, v39
    v_rcp_f32 v39, v39
    s_nop 0
    v_mul_f32 v36, v36, v39
    v_mul_f32 v38, v37, v37
    v_mul_f32 v38, v38, v37
    v_mov_b32 v39, v37
    v_fmac_f32 v39, 0x3d372713, v38
    v_mul_f32 v39, 0xc0135761, v39
    v_exp_f32 v39, v39
    s_nop 0
    v_add_f32 v39, 1.0, v39
    v_rcp_f32 v39, v39
    s_nop 0
    v_mul_f32 v37, v37, v39
    v_cvt_pk_bf16_f32 v32, v34, v35
    v_cvt_pk_bf16_f32 v33, v36, v37
    buffer_store_dwordx2 v[32:33], v7, s[16:19], s4 offen offset:48
    s_nop 1
    s_mov_b32 s4, 688128
    s_waitcnt vmcnt(0)
    v_cvt_pk_bf16_f32 v32, v224, v225
    v_cvt_pk_bf16_f32 v33, v226, v227
    v_lshlrev_b32 v34, 16, v32
    v_and_b32 v35, 0xffff0000, v32
    v_lshlrev_b32 v36, 16, v33
    v_and_b32 v37, 0xffff0000, v33
    v_lshlrev_b32 v38, 16, v56
    v_add_f32 v34, v34, v38
    v_and_b32 v38, 0xffff0000, v56
    v_add_f32 v35, v35, v38
    v_lshlrev_b32 v38, 16, v57
    v_add_f32 v36, v36, v38
    v_and_b32 v38, 0xffff0000, v57
    v_add_f32 v37, v37, v38
    v_cvt_pk_bf16_f32 v32, v34, v35
    v_cvt_pk_bf16_f32 v33, v36, v37
    v_lshlrev_b32 v34, 16, v32
    v_and_b32 v35, 0xffff0000, v32
    v_lshlrev_b32 v36, 16, v33
    v_and_b32 v37, 0xffff0000, v33
    v_mul_f32 v38, v34, v34
    v_mul_f32 v38, v38, v34
    v_mov_b32 v39, v34
    v_fmac_f32 v39, 0x3d372713, v38
    v_mul_f32 v39, 0xc0135761, v39
    v_exp_f32 v39, v39
    s_nop 0
    v_add_f32 v39, 1.0, v39
    v_rcp_f32 v39, v39
    s_nop 0
    v_mul_f32 v34, v34, v39
    v_mul_f32 v38, v35, v35
    v_mul_f32 v38, v38, v35
    v_mov_b32 v39, v35
    v_fmac_f32 v39, 0x3d372713, v38
    v_mul_f32 v39, 0xc0135761, v39
    v_exp_f32 v39, v39
    s_nop 0
    v_add_f32 v39, 1.0, v39
    v_rcp_f32 v39, v39
    s_nop 0
    v_mul_f32 v35, v35, v39
    v_mul_f32 v38, v36, v36
    v_mul_f32 v38, v38, v36
    v_mov_b32 v39, v36
    v_fmac_f32 v39, 0x3d372713, v38
    v_mul_f32 v39, 0xc0135761, v39
    v_exp_f32 v39, v39
    s_nop 0
    v_add_f32 v39, 1.0, v39
    v_rcp_f32 v39, v39
    s_nop 0
    v_mul_f32 v36, v36, v39
    v_mul_f32 v38, v37, v37
    v_mul_f32 v38, v38, v37
    v_mov_b32 v39, v37
    v_fmac_f32 v39, 0x3d372713, v38
    v_mul_f32 v39, 0xc0135761, v39
    v_exp_f32 v39, v39
    s_nop 0
    v_add_f32 v39, 1.0, v39
    v_rcp_f32 v39, v39
    s_nop 0
    v_mul_f32 v37, v37, v39
    v_cvt_pk_bf16_f32 v32, v34, v35
    v_cvt_pk_bf16_f32 v33, v36, v37
    buffer_store_dwordx2 v[32:33], v7, s[16:19], s4 offen offset:0
    s_nop 1
    v_cvt_pk_bf16_f32 v32, v228, v229
    v_cvt_pk_bf16_f32 v33, v230, v231
    v_lshlrev_b32 v34, 16, v32
    v_and_b32 v35, 0xffff0000, v32
    v_lshlrev_b32 v36, 16, v33
    v_and_b32 v37, 0xffff0000, v33
    v_lshlrev_b32 v38, 16, v58
    v_add_f32 v34, v34, v38
    v_and_b32 v38, 0xffff0000, v58
    v_add_f32 v35, v35, v38
    v_lshlrev_b32 v38, 16, v59
    v_add_f32 v36, v36, v38
    v_and_b32 v38, 0xffff0000, v59
    v_add_f32 v37, v37, v38
    v_cvt_pk_bf16_f32 v32, v34, v35
    v_cvt_pk_bf16_f32 v33, v36, v37
    v_lshlrev_b32 v34, 16, v32
    v_and_b32 v35, 0xffff0000, v32
    v_lshlrev_b32 v36, 16, v33
    v_and_b32 v37, 0xffff0000, v33
    v_mul_f32 v38, v34, v34
    v_mul_f32 v38, v38, v34
    v_mov_b32 v39, v34
    v_fmac_f32 v39, 0x3d372713, v38
    v_mul_f32 v39, 0xc0135761, v39
    v_exp_f32 v39, v39
    s_nop 0
    v_add_f32 v39, 1.0, v39
    v_rcp_f32 v39, v39
    s_nop 0
    v_mul_f32 v34, v34, v39
    v_mul_f32 v38, v35, v35
    v_mul_f32 v38, v38, v35
    v_mov_b32 v39, v35
    v_fmac_f32 v39, 0x3d372713, v38
    v_mul_f32 v39, 0xc0135761, v39
    v_exp_f32 v39, v39
    s_nop 0
    v_add_f32 v39, 1.0, v39
    v_rcp_f32 v39, v39
    s_nop 0
    v_mul_f32 v35, v35, v39
    v_mul_f32 v38, v36, v36
    v_mul_f32 v38, v38, v36
    v_mov_b32 v39, v36
    v_fmac_f32 v39, 0x3d372713, v38
    v_mul_f32 v39, 0xc0135761, v39
    v_exp_f32 v39, v39
    s_nop 0
    v_add_f32 v39, 1.0, v39
    v_rcp_f32 v39, v39
    s_nop 0
    v_mul_f32 v36, v36, v39
    v_mul_f32 v38, v37, v37
    v_mul_f32 v38, v38, v37
    v_mov_b32 v39, v37
    v_fmac_f32 v39, 0x3d372713, v38
    v_mul_f32 v39, 0xc0135761, v39
    v_exp_f32 v39, v39
    s_nop 0
    v_add_f32 v39, 1.0, v39
    v_rcp_f32 v39, v39
    s_nop 0
    v_mul_f32 v37, v37, v39
    v_cvt_pk_bf16_f32 v32, v34, v35
    v_cvt_pk_bf16_f32 v33, v36, v37
    buffer_store_dwordx2 v[32:33], v7, s[16:19], s4 offen offset:16
    s_nop 1
    v_cvt_pk_bf16_f32 v32, v232, v233
    v_cvt_pk_bf16_f32 v33, v234, v235
    v_lshlrev_b32 v34, 16, v32
    v_and_b32 v35, 0xffff0000, v32
    v_lshlrev_b32 v36, 16, v33
    v_and_b32 v37, 0xffff0000, v33
    v_lshlrev_b32 v38, 16, v60
    v_add_f32 v34, v34, v38
    v_and_b32 v38, 0xffff0000, v60
    v_add_f32 v35, v35, v38
    v_lshlrev_b32 v38, 16, v61
    v_add_f32 v36, v36, v38
    v_and_b32 v38, 0xffff0000, v61
    v_add_f32 v37, v37, v38
    v_cvt_pk_bf16_f32 v32, v34, v35
    v_cvt_pk_bf16_f32 v33, v36, v37
    v_lshlrev_b32 v34, 16, v32
    v_and_b32 v35, 0xffff0000, v32
    v_lshlrev_b32 v36, 16, v33
    v_and_b32 v37, 0xffff0000, v33
    v_mul_f32 v38, v34, v34
    v_mul_f32 v38, v38, v34
    v_mov_b32 v39, v34
    v_fmac_f32 v39, 0x3d372713, v38
    v_mul_f32 v39, 0xc0135761, v39
    v_exp_f32 v39, v39
    s_nop 0
    v_add_f32 v39, 1.0, v39
    v_rcp_f32 v39, v39
    s_nop 0
    v_mul_f32 v34, v34, v39
    v_mul_f32 v38, v35, v35
    v_mul_f32 v38, v38, v35
    v_mov_b32 v39, v35
    v_fmac_f32 v39, 0x3d372713, v38
    v_mul_f32 v39, 0xc0135761, v39
    v_exp_f32 v39, v39
    s_nop 0
    v_add_f32 v39, 1.0, v39
    v_rcp_f32 v39, v39
    s_nop 0
    v_mul_f32 v35, v35, v39
    v_mul_f32 v38, v36, v36
    v_mul_f32 v38, v38, v36
    v_mov_b32 v39, v36
    v_fmac_f32 v39, 0x3d372713, v38
    v_mul_f32 v39, 0xc0135761, v39
    v_exp_f32 v39, v39
    s_nop 0
    v_add_f32 v39, 1.0, v39
    v_rcp_f32 v39, v39
    s_nop 0
    v_mul_f32 v36, v36, v39
    v_mul_f32 v38, v37, v37
    v_mul_f32 v38, v38, v37
    v_mov_b32 v39, v37
    v_fmac_f32 v39, 0x3d372713, v38
    v_mul_f32 v39, 0xc0135761, v39
    v_exp_f32 v39, v39
    s_nop 0
    v_add_f32 v39, 1.0, v39
    v_rcp_f32 v39, v39
    s_nop 0
    v_mul_f32 v37, v37, v39
    v_cvt_pk_bf16_f32 v32, v34, v35
    v_cvt_pk_bf16_f32 v33, v36, v37
    buffer_store_dwordx2 v[32:33], v7, s[16:19], s4 offen offset:32
    s_nop 1
    v_cvt_pk_bf16_f32 v32, v236, v237
    v_cvt_pk_bf16_f32 v33, v238, v239
    v_lshlrev_b32 v34, 16, v32
    v_and_b32 v35, 0xffff0000, v32
    v_lshlrev_b32 v36, 16, v33
    v_and_b32 v37, 0xffff0000, v33
    v_lshlrev_b32 v38, 16, v62
    v_add_f32 v34, v34, v38
    v_and_b32 v38, 0xffff0000, v62
    v_add_f32 v35, v35, v38
    v_lshlrev_b32 v38, 16, v63
    v_add_f32 v36, v36, v38
    v_and_b32 v38, 0xffff0000, v63
    v_add_f32 v37, v37, v38
    v_cvt_pk_bf16_f32 v32, v34, v35
    v_cvt_pk_bf16_f32 v33, v36, v37
    v_lshlrev_b32 v34, 16, v32
    v_and_b32 v35, 0xffff0000, v32
    v_lshlrev_b32 v36, 16, v33
    v_and_b32 v37, 0xffff0000, v33
    v_mul_f32 v38, v34, v34
    v_mul_f32 v38, v38, v34
    v_mov_b32 v39, v34
    v_fmac_f32 v39, 0x3d372713, v38
    v_mul_f32 v39, 0xc0135761, v39
    v_exp_f32 v39, v39
    s_nop 0
    v_add_f32 v39, 1.0, v39
    v_rcp_f32 v39, v39
    s_nop 0
    v_mul_f32 v34, v34, v39
    v_mul_f32 v38, v35, v35
    v_mul_f32 v38, v38, v35
    v_mov_b32 v39, v35
    v_fmac_f32 v39, 0x3d372713, v38
    v_mul_f32 v39, 0xc0135761, v39
    v_exp_f32 v39, v39
    s_nop 0
    v_add_f32 v39, 1.0, v39
    v_rcp_f32 v39, v39
    s_nop 0
    v_mul_f32 v35, v35, v39
    v_mul_f32 v38, v36, v36
    v_mul_f32 v38, v38, v36
    v_mov_b32 v39, v36
    v_fmac_f32 v39, 0x3d372713, v38
    v_mul_f32 v39, 0xc0135761, v39
    v_exp_f32 v39, v39
    s_nop 0
    v_add_f32 v39, 1.0, v39
    v_rcp_f32 v39, v39
    s_nop 0
    v_mul_f32 v36, v36, v39
    v_mul_f32 v38, v37, v37
    v_mul_f32 v38, v38, v37
    v_mov_b32 v39, v37
    v_fmac_f32 v39, 0x3d372713, v38
    v_mul_f32 v39, 0xc0135761, v39
    v_exp_f32 v39, v39
    s_nop 0
    v_add_f32 v39, 1.0, v39
    v_rcp_f32 v39, v39
    s_nop 0
    v_mul_f32 v37, v37, v39
    v_cvt_pk_bf16_f32 v32, v34, v35
    v_cvt_pk_bf16_f32 v33, v36, v37
    buffer_store_dwordx2 v[32:33], v7, s[16:19], s4 offen offset:48
    s_nop 1
    buffer_load_dwordx2 v[56:57], v8, s[24:27], 0 offen offset:64
    buffer_load_dwordx2 v[58:59], v8, s[24:27], 0 offen offset:80
    buffer_load_dwordx2 v[60:61], v8, s[24:27], 0 offen offset:96
    buffer_load_dwordx2 v[62:63], v8, s[24:27], 0 offen offset:112
    s_mov_b32 s4, 0
    s_waitcnt vmcnt(0)
    v_cvt_pk_bf16_f32 v32, v144, v145
    v_cvt_pk_bf16_f32 v33, v146, v147
    v_lshlrev_b32 v34, 16, v32
    v_and_b32 v35, 0xffff0000, v32
    v_lshlrev_b32 v36, 16, v33
    v_and_b32 v37, 0xffff0000, v33
    v_lshlrev_b32 v38, 16, v56
    v_add_f32 v34, v34, v38
    v_and_b32 v38, 0xffff0000, v56
    v_add_f32 v35, v35, v38
    v_lshlrev_b32 v38, 16, v57
    v_add_f32 v36, v36, v38
    v_and_b32 v38, 0xffff0000, v57
    v_add_f32 v37, v37, v38
    v_cvt_pk_bf16_f32 v32, v34, v35
    v_cvt_pk_bf16_f32 v33, v36, v37
    v_lshlrev_b32 v34, 16, v32
    v_and_b32 v35, 0xffff0000, v32
    v_lshlrev_b32 v36, 16, v33
    v_and_b32 v37, 0xffff0000, v33
    v_mul_f32 v38, v34, v34
    v_mul_f32 v38, v38, v34
    v_mov_b32 v39, v34
    v_fmac_f32 v39, 0x3d372713, v38
    v_mul_f32 v39, 0xc0135761, v39
    v_exp_f32 v39, v39
    s_nop 0
    v_add_f32 v39, 1.0, v39
    v_rcp_f32 v39, v39
    s_nop 0
    v_mul_f32 v34, v34, v39
    v_mul_f32 v38, v35, v35
    v_mul_f32 v38, v38, v35
    v_mov_b32 v39, v35
    v_fmac_f32 v39, 0x3d372713, v38
    v_mul_f32 v39, 0xc0135761, v39
    v_exp_f32 v39, v39
    s_nop 0
    v_add_f32 v39, 1.0, v39
    v_rcp_f32 v39, v39
    s_nop 0
    v_mul_f32 v35, v35, v39
    v_mul_f32 v38, v36, v36
    v_mul_f32 v38, v38, v36
    v_mov_b32 v39, v36
    v_fmac_f32 v39, 0x3d372713, v38
    v_mul_f32 v39, 0xc0135761, v39
    v_exp_f32 v39, v39
    s_nop 0
    v_add_f32 v39, 1.0, v39
    v_rcp_f32 v39, v39
    s_nop 0
    v_mul_f32 v36, v36, v39
    v_mul_f32 v38, v37, v37
    v_mul_f32 v38, v38, v37
    v_mov_b32 v39, v37
    v_fmac_f32 v39, 0x3d372713, v38
    v_mul_f32 v39, 0xc0135761, v39
    v_exp_f32 v39, v39
    s_nop 0
    v_add_f32 v39, 1.0, v39
    v_rcp_f32 v39, v39
    s_nop 0
    v_mul_f32 v37, v37, v39
    v_cvt_pk_bf16_f32 v32, v34, v35
    v_cvt_pk_bf16_f32 v33, v36, v37
    buffer_store_dwordx2 v[32:33], v7, s[16:19], s4 offen offset:64
    s_nop 1
    v_cvt_pk_bf16_f32 v32, v148, v149
    v_cvt_pk_bf16_f32 v33, v150, v151
    v_lshlrev_b32 v34, 16, v32
    v_and_b32 v35, 0xffff0000, v32
    v_lshlrev_b32 v36, 16, v33
    v_and_b32 v37, 0xffff0000, v33
    v_lshlrev_b32 v38, 16, v58
    v_add_f32 v34, v34, v38
    v_and_b32 v38, 0xffff0000, v58
    v_add_f32 v35, v35, v38
    v_lshlrev_b32 v38, 16, v59
    v_add_f32 v36, v36, v38
    v_and_b32 v38, 0xffff0000, v59
    v_add_f32 v37, v37, v38
    v_cvt_pk_bf16_f32 v32, v34, v35
    v_cvt_pk_bf16_f32 v33, v36, v37
    v_lshlrev_b32 v34, 16, v32
    v_and_b32 v35, 0xffff0000, v32
    v_lshlrev_b32 v36, 16, v33
    v_and_b32 v37, 0xffff0000, v33
    v_mul_f32 v38, v34, v34
    v_mul_f32 v38, v38, v34
    v_mov_b32 v39, v34
    v_fmac_f32 v39, 0x3d372713, v38
    v_mul_f32 v39, 0xc0135761, v39
    v_exp_f32 v39, v39
    s_nop 0
    v_add_f32 v39, 1.0, v39
    v_rcp_f32 v39, v39
    s_nop 0
    v_mul_f32 v34, v34, v39
    v_mul_f32 v38, v35, v35
    v_mul_f32 v38, v38, v35
    v_mov_b32 v39, v35
    v_fmac_f32 v39, 0x3d372713, v38
    v_mul_f32 v39, 0xc0135761, v39
    v_exp_f32 v39, v39
    s_nop 0
    v_add_f32 v39, 1.0, v39
    v_rcp_f32 v39, v39
    s_nop 0
    v_mul_f32 v35, v35, v39
    v_mul_f32 v38, v36, v36
    v_mul_f32 v38, v38, v36
    v_mov_b32 v39, v36
    v_fmac_f32 v39, 0x3d372713, v38
    v_mul_f32 v39, 0xc0135761, v39
    v_exp_f32 v39, v39
    s_nop 0
    v_add_f32 v39, 1.0, v39
    v_rcp_f32 v39, v39
    s_nop 0
    v_mul_f32 v36, v36, v39
    v_mul_f32 v38, v37, v37
    v_mul_f32 v38, v38, v37
    v_mov_b32 v39, v37
    v_fmac_f32 v39, 0x3d372713, v38
    v_mul_f32 v39, 0xc0135761, v39
    v_exp_f32 v39, v39
    s_nop 0
    v_add_f32 v39, 1.0, v39
    v_rcp_f32 v39, v39
    s_nop 0
    v_mul_f32 v37, v37, v39
    v_cvt_pk_bf16_f32 v32, v34, v35
    v_cvt_pk_bf16_f32 v33, v36, v37
    buffer_store_dwordx2 v[32:33], v7, s[16:19], s4 offen offset:80
    s_nop 1
    v_cvt_pk_bf16_f32 v32, v152, v153
    v_cvt_pk_bf16_f32 v33, v154, v155
    v_lshlrev_b32 v34, 16, v32
    v_and_b32 v35, 0xffff0000, v32
    v_lshlrev_b32 v36, 16, v33
    v_and_b32 v37, 0xffff0000, v33
    v_lshlrev_b32 v38, 16, v60
    v_add_f32 v34, v34, v38
    v_and_b32 v38, 0xffff0000, v60
    v_add_f32 v35, v35, v38
    v_lshlrev_b32 v38, 16, v61
    v_add_f32 v36, v36, v38
    v_and_b32 v38, 0xffff0000, v61
    v_add_f32 v37, v37, v38
    v_cvt_pk_bf16_f32 v32, v34, v35
    v_cvt_pk_bf16_f32 v33, v36, v37
    v_lshlrev_b32 v34, 16, v32
    v_and_b32 v35, 0xffff0000, v32
    v_lshlrev_b32 v36, 16, v33
    v_and_b32 v37, 0xffff0000, v33
    v_mul_f32 v38, v34, v34
    v_mul_f32 v38, v38, v34
    v_mov_b32 v39, v34
    v_fmac_f32 v39, 0x3d372713, v38
    v_mul_f32 v39, 0xc0135761, v39
    v_exp_f32 v39, v39
    s_nop 0
    v_add_f32 v39, 1.0, v39
    v_rcp_f32 v39, v39
    s_nop 0
    v_mul_f32 v34, v34, v39
    v_mul_f32 v38, v35, v35
    v_mul_f32 v38, v38, v35
    v_mov_b32 v39, v35
    v_fmac_f32 v39, 0x3d372713, v38
    v_mul_f32 v39, 0xc0135761, v39
    v_exp_f32 v39, v39
    s_nop 0
    v_add_f32 v39, 1.0, v39
    v_rcp_f32 v39, v39
    s_nop 0
    v_mul_f32 v35, v35, v39
    v_mul_f32 v38, v36, v36
    v_mul_f32 v38, v38, v36
    v_mov_b32 v39, v36
    v_fmac_f32 v39, 0x3d372713, v38
    v_mul_f32 v39, 0xc0135761, v39
    v_exp_f32 v39, v39
    s_nop 0
    v_add_f32 v39, 1.0, v39
    v_rcp_f32 v39, v39
    s_nop 0
    v_mul_f32 v36, v36, v39
    v_mul_f32 v38, v37, v37
    v_mul_f32 v38, v38, v37
    v_mov_b32 v39, v37
    v_fmac_f32 v39, 0x3d372713, v38
    v_mul_f32 v39, 0xc0135761, v39
    v_exp_f32 v39, v39
    s_nop 0
    v_add_f32 v39, 1.0, v39
    v_rcp_f32 v39, v39
    s_nop 0
    v_mul_f32 v37, v37, v39
    v_cvt_pk_bf16_f32 v32, v34, v35
    v_cvt_pk_bf16_f32 v33, v36, v37
    buffer_store_dwordx2 v[32:33], v7, s[16:19], s4 offen offset:96
    s_nop 1
    v_cvt_pk_bf16_f32 v32, v156, v157
    v_cvt_pk_bf16_f32 v33, v158, v159
    v_lshlrev_b32 v34, 16, v32
    v_and_b32 v35, 0xffff0000, v32
    v_lshlrev_b32 v36, 16, v33
    v_and_b32 v37, 0xffff0000, v33
    v_lshlrev_b32 v38, 16, v62
    v_add_f32 v34, v34, v38
    v_and_b32 v38, 0xffff0000, v62
    v_add_f32 v35, v35, v38
    v_lshlrev_b32 v38, 16, v63
    v_add_f32 v36, v36, v38
    v_and_b32 v38, 0xffff0000, v63
    v_add_f32 v37, v37, v38
    v_cvt_pk_bf16_f32 v32, v34, v35
    v_cvt_pk_bf16_f32 v33, v36, v37
    v_lshlrev_b32 v34, 16, v32
    v_and_b32 v35, 0xffff0000, v32
    v_lshlrev_b32 v36, 16, v33
    v_and_b32 v37, 0xffff0000, v33
    v_mul_f32 v38, v34, v34
    v_mul_f32 v38, v38, v34
    v_mov_b32 v39, v34
    v_fmac_f32 v39, 0x3d372713, v38
    v_mul_f32 v39, 0xc0135761, v39
    v_exp_f32 v39, v39
    s_nop 0
    v_add_f32 v39, 1.0, v39
    v_rcp_f32 v39, v39
    s_nop 0
    v_mul_f32 v34, v34, v39
    v_mul_f32 v38, v35, v35
    v_mul_f32 v38, v38, v35
    v_mov_b32 v39, v35
    v_fmac_f32 v39, 0x3d372713, v38
    v_mul_f32 v39, 0xc0135761, v39
    v_exp_f32 v39, v39
    s_nop 0
    v_add_f32 v39, 1.0, v39
    v_rcp_f32 v39, v39
    s_nop 0
    v_mul_f32 v35, v35, v39
    v_mul_f32 v38, v36, v36
    v_mul_f32 v38, v38, v36
    v_mov_b32 v39, v36
    v_fmac_f32 v39, 0x3d372713, v38
    v_mul_f32 v39, 0xc0135761, v39
    v_exp_f32 v39, v39
    s_nop 0
    v_add_f32 v39, 1.0, v39
    v_rcp_f32 v39, v39
    s_nop 0
    v_mul_f32 v36, v36, v39
    v_mul_f32 v38, v37, v37
    v_mul_f32 v38, v38, v37
    v_mov_b32 v39, v37
    v_fmac_f32 v39, 0x3d372713, v38
    v_mul_f32 v39, 0xc0135761, v39
    v_exp_f32 v39, v39
    s_nop 0
    v_add_f32 v39, 1.0, v39
    v_rcp_f32 v39, v39
    s_nop 0
    v_mul_f32 v37, v37, v39
    v_cvt_pk_bf16_f32 v32, v34, v35
    v_cvt_pk_bf16_f32 v33, v36, v37
    buffer_store_dwordx2 v[32:33], v7, s[16:19], s4 offen offset:112
    s_nop 1
    s_mov_b32 s4, 229376
    s_waitcnt vmcnt(0)
    v_cvt_pk_bf16_f32 v32, v176, v177
    v_cvt_pk_bf16_f32 v33, v178, v179
    v_lshlrev_b32 v34, 16, v32
    v_and_b32 v35, 0xffff0000, v32
    v_lshlrev_b32 v36, 16, v33
    v_and_b32 v37, 0xffff0000, v33
    v_lshlrev_b32 v38, 16, v56
    v_add_f32 v34, v34, v38
    v_and_b32 v38, 0xffff0000, v56
    v_add_f32 v35, v35, v38
    v_lshlrev_b32 v38, 16, v57
    v_add_f32 v36, v36, v38
    v_and_b32 v38, 0xffff0000, v57
    v_add_f32 v37, v37, v38
    v_cvt_pk_bf16_f32 v32, v34, v35
    v_cvt_pk_bf16_f32 v33, v36, v37
    v_lshlrev_b32 v34, 16, v32
    v_and_b32 v35, 0xffff0000, v32
    v_lshlrev_b32 v36, 16, v33
    v_and_b32 v37, 0xffff0000, v33
    v_mul_f32 v38, v34, v34
    v_mul_f32 v38, v38, v34
    v_mov_b32 v39, v34
    v_fmac_f32 v39, 0x3d372713, v38
    v_mul_f32 v39, 0xc0135761, v39
    v_exp_f32 v39, v39
    s_nop 0
    v_add_f32 v39, 1.0, v39
    v_rcp_f32 v39, v39
    s_nop 0
    v_mul_f32 v34, v34, v39
    v_mul_f32 v38, v35, v35
    v_mul_f32 v38, v38, v35
    v_mov_b32 v39, v35
    v_fmac_f32 v39, 0x3d372713, v38
    v_mul_f32 v39, 0xc0135761, v39
    v_exp_f32 v39, v39
    s_nop 0
    v_add_f32 v39, 1.0, v39
    v_rcp_f32 v39, v39
    s_nop 0
    v_mul_f32 v35, v35, v39
    v_mul_f32 v38, v36, v36
    v_mul_f32 v38, v38, v36
    v_mov_b32 v39, v36
    v_fmac_f32 v39, 0x3d372713, v38
    v_mul_f32 v39, 0xc0135761, v39
    v_exp_f32 v39, v39
    s_nop 0
    v_add_f32 v39, 1.0, v39
    v_rcp_f32 v39, v39
    s_nop 0
    v_mul_f32 v36, v36, v39
    v_mul_f32 v38, v37, v37
    v_mul_f32 v38, v38, v37
    v_mov_b32 v39, v37
    v_fmac_f32 v39, 0x3d372713, v38
    v_mul_f32 v39, 0xc0135761, v39
    v_exp_f32 v39, v39
    s_nop 0
    v_add_f32 v39, 1.0, v39
    v_rcp_f32 v39, v39
    s_nop 0
    v_mul_f32 v37, v37, v39
    v_cvt_pk_bf16_f32 v32, v34, v35
    v_cvt_pk_bf16_f32 v33, v36, v37
    buffer_store_dwordx2 v[32:33], v7, s[16:19], s4 offen offset:64
    s_nop 1
    v_cvt_pk_bf16_f32 v32, v180, v181
    v_cvt_pk_bf16_f32 v33, v182, v183
    v_lshlrev_b32 v34, 16, v32
    v_and_b32 v35, 0xffff0000, v32
    v_lshlrev_b32 v36, 16, v33
    v_and_b32 v37, 0xffff0000, v33
    v_lshlrev_b32 v38, 16, v58
    v_add_f32 v34, v34, v38
    v_and_b32 v38, 0xffff0000, v58
    v_add_f32 v35, v35, v38
    v_lshlrev_b32 v38, 16, v59
    v_add_f32 v36, v36, v38
    v_and_b32 v38, 0xffff0000, v59
    v_add_f32 v37, v37, v38
    v_cvt_pk_bf16_f32 v32, v34, v35
    v_cvt_pk_bf16_f32 v33, v36, v37
    v_lshlrev_b32 v34, 16, v32
    v_and_b32 v35, 0xffff0000, v32
    v_lshlrev_b32 v36, 16, v33
    v_and_b32 v37, 0xffff0000, v33
    v_mul_f32 v38, v34, v34
    v_mul_f32 v38, v38, v34
    v_mov_b32 v39, v34
    v_fmac_f32 v39, 0x3d372713, v38
    v_mul_f32 v39, 0xc0135761, v39
    v_exp_f32 v39, v39
    s_nop 0
    v_add_f32 v39, 1.0, v39
    v_rcp_f32 v39, v39
    s_nop 0
    v_mul_f32 v34, v34, v39
    v_mul_f32 v38, v35, v35
    v_mul_f32 v38, v38, v35
    v_mov_b32 v39, v35
    v_fmac_f32 v39, 0x3d372713, v38
    v_mul_f32 v39, 0xc0135761, v39
    v_exp_f32 v39, v39
    s_nop 0
    v_add_f32 v39, 1.0, v39
    v_rcp_f32 v39, v39
    s_nop 0
    v_mul_f32 v35, v35, v39
    v_mul_f32 v38, v36, v36
    v_mul_f32 v38, v38, v36
    v_mov_b32 v39, v36
    v_fmac_f32 v39, 0x3d372713, v38
    v_mul_f32 v39, 0xc0135761, v39
    v_exp_f32 v39, v39
    s_nop 0
    v_add_f32 v39, 1.0, v39
    v_rcp_f32 v39, v39
    s_nop 0
    v_mul_f32 v36, v36, v39
    v_mul_f32 v38, v37, v37
    v_mul_f32 v38, v38, v37
    v_mov_b32 v39, v37
    v_fmac_f32 v39, 0x3d372713, v38
    v_mul_f32 v39, 0xc0135761, v39
    v_exp_f32 v39, v39
    s_nop 0
    v_add_f32 v39, 1.0, v39
    v_rcp_f32 v39, v39
    s_nop 0
    v_mul_f32 v37, v37, v39
    v_cvt_pk_bf16_f32 v32, v34, v35
    v_cvt_pk_bf16_f32 v33, v36, v37
    buffer_store_dwordx2 v[32:33], v7, s[16:19], s4 offen offset:80
    s_nop 1
    v_cvt_pk_bf16_f32 v32, v184, v185
    v_cvt_pk_bf16_f32 v33, v186, v187
    v_lshlrev_b32 v34, 16, v32
    v_and_b32 v35, 0xffff0000, v32
    v_lshlrev_b32 v36, 16, v33
    v_and_b32 v37, 0xffff0000, v33
    v_lshlrev_b32 v38, 16, v60
    v_add_f32 v34, v34, v38
    v_and_b32 v38, 0xffff0000, v60
    v_add_f32 v35, v35, v38
    v_lshlrev_b32 v38, 16, v61
    v_add_f32 v36, v36, v38
    v_and_b32 v38, 0xffff0000, v61
    v_add_f32 v37, v37, v38
    v_cvt_pk_bf16_f32 v32, v34, v35
    v_cvt_pk_bf16_f32 v33, v36, v37
    v_lshlrev_b32 v34, 16, v32
    v_and_b32 v35, 0xffff0000, v32
    v_lshlrev_b32 v36, 16, v33
    v_and_b32 v37, 0xffff0000, v33
    v_mul_f32 v38, v34, v34
    v_mul_f32 v38, v38, v34
    v_mov_b32 v39, v34
    v_fmac_f32 v39, 0x3d372713, v38
    v_mul_f32 v39, 0xc0135761, v39
    v_exp_f32 v39, v39
    s_nop 0
    v_add_f32 v39, 1.0, v39
    v_rcp_f32 v39, v39
    s_nop 0
    v_mul_f32 v34, v34, v39
    v_mul_f32 v38, v35, v35
    v_mul_f32 v38, v38, v35
    v_mov_b32 v39, v35
    v_fmac_f32 v39, 0x3d372713, v38
    v_mul_f32 v39, 0xc0135761, v39
    v_exp_f32 v39, v39
    s_nop 0
    v_add_f32 v39, 1.0, v39
    v_rcp_f32 v39, v39
    s_nop 0
    v_mul_f32 v35, v35, v39
    v_mul_f32 v38, v36, v36
    v_mul_f32 v38, v38, v36
    v_mov_b32 v39, v36
    v_fmac_f32 v39, 0x3d372713, v38
    v_mul_f32 v39, 0xc0135761, v39
    v_exp_f32 v39, v39
    s_nop 0
    v_add_f32 v39, 1.0, v39
    v_rcp_f32 v39, v39
    s_nop 0
    v_mul_f32 v36, v36, v39
    v_mul_f32 v38, v37, v37
    v_mul_f32 v38, v38, v37
    v_mov_b32 v39, v37
    v_fmac_f32 v39, 0x3d372713, v38
    v_mul_f32 v39, 0xc0135761, v39
    v_exp_f32 v39, v39
    s_nop 0
    v_add_f32 v39, 1.0, v39
    v_rcp_f32 v39, v39
    s_nop 0
    v_mul_f32 v37, v37, v39
    v_cvt_pk_bf16_f32 v32, v34, v35
    v_cvt_pk_bf16_f32 v33, v36, v37
    buffer_store_dwordx2 v[32:33], v7, s[16:19], s4 offen offset:96
    s_nop 1
    v_cvt_pk_bf16_f32 v32, v188, v189
    v_cvt_pk_bf16_f32 v33, v190, v191
    v_lshlrev_b32 v34, 16, v32
    v_and_b32 v35, 0xffff0000, v32
    v_lshlrev_b32 v36, 16, v33
    v_and_b32 v37, 0xffff0000, v33
    v_lshlrev_b32 v38, 16, v62
    v_add_f32 v34, v34, v38
    v_and_b32 v38, 0xffff0000, v62
    v_add_f32 v35, v35, v38
    v_lshlrev_b32 v38, 16, v63
    v_add_f32 v36, v36, v38
    v_and_b32 v38, 0xffff0000, v63
    v_add_f32 v37, v37, v38
    v_cvt_pk_bf16_f32 v32, v34, v35
    v_cvt_pk_bf16_f32 v33, v36, v37
    v_lshlrev_b32 v34, 16, v32
    v_and_b32 v35, 0xffff0000, v32
    v_lshlrev_b32 v36, 16, v33
    v_and_b32 v37, 0xffff0000, v33
    v_mul_f32 v38, v34, v34
    v_mul_f32 v38, v38, v34
    v_mov_b32 v39, v34
    v_fmac_f32 v39, 0x3d372713, v38
    v_mul_f32 v39, 0xc0135761, v39
    v_exp_f32 v39, v39
    s_nop 0
    v_add_f32 v39, 1.0, v39
    v_rcp_f32 v39, v39
    s_nop 0
    v_mul_f32 v34, v34, v39
    v_mul_f32 v38, v35, v35
    v_mul_f32 v38, v38, v35
    v_mov_b32 v39, v35
    v_fmac_f32 v39, 0x3d372713, v38
    v_mul_f32 v39, 0xc0135761, v39
    v_exp_f32 v39, v39
    s_nop 0
    v_add_f32 v39, 1.0, v39
    v_rcp_f32 v39, v39
    s_nop 0
    v_mul_f32 v35, v35, v39
    v_mul_f32 v38, v36, v36
    v_mul_f32 v38, v38, v36
    v_mov_b32 v39, v36
    v_fmac_f32 v39, 0x3d372713, v38
    v_mul_f32 v39, 0xc0135761, v39
    v_exp_f32 v39, v39
    s_nop 0
    v_add_f32 v39, 1.0, v39
    v_rcp_f32 v39, v39
    s_nop 0
    v_mul_f32 v36, v36, v39
    v_mul_f32 v38, v37, v37
    v_mul_f32 v38, v38, v37
    v_mov_b32 v39, v37
    v_fmac_f32 v39, 0x3d372713, v38
    v_mul_f32 v39, 0xc0135761, v39
    v_exp_f32 v39, v39
    s_nop 0
    v_add_f32 v39, 1.0, v39
    v_rcp_f32 v39, v39
    s_nop 0
    v_mul_f32 v37, v37, v39
    v_cvt_pk_bf16_f32 v32, v34, v35
    v_cvt_pk_bf16_f32 v33, v36, v37
    buffer_store_dwordx2 v[32:33], v7, s[16:19], s4 offen offset:112
    s_nop 1
    s_mov_b32 s4, 458752
    s_waitcnt vmcnt(0)
    v_cvt_pk_bf16_f32 v32, v208, v209
    v_cvt_pk_bf16_f32 v33, v210, v211
    v_lshlrev_b32 v34, 16, v32
    v_and_b32 v35, 0xffff0000, v32
    v_lshlrev_b32 v36, 16, v33
    v_and_b32 v37, 0xffff0000, v33
    v_lshlrev_b32 v38, 16, v56
    v_add_f32 v34, v34, v38
    v_and_b32 v38, 0xffff0000, v56
    v_add_f32 v35, v35, v38
    v_lshlrev_b32 v38, 16, v57
    v_add_f32 v36, v36, v38
    v_and_b32 v38, 0xffff0000, v57
    v_add_f32 v37, v37, v38
    v_cvt_pk_bf16_f32 v32, v34, v35
    v_cvt_pk_bf16_f32 v33, v36, v37
    v_lshlrev_b32 v34, 16, v32
    v_and_b32 v35, 0xffff0000, v32
    v_lshlrev_b32 v36, 16, v33
    v_and_b32 v37, 0xffff0000, v33
    v_mul_f32 v38, v34, v34
    v_mul_f32 v38, v38, v34
    v_mov_b32 v39, v34
    v_fmac_f32 v39, 0x3d372713, v38
    v_mul_f32 v39, 0xc0135761, v39
    v_exp_f32 v39, v39
    s_nop 0
    v_add_f32 v39, 1.0, v39
    v_rcp_f32 v39, v39
    s_nop 0
    v_mul_f32 v34, v34, v39
    v_mul_f32 v38, v35, v35
    v_mul_f32 v38, v38, v35
    v_mov_b32 v39, v35
    v_fmac_f32 v39, 0x3d372713, v38
    v_mul_f32 v39, 0xc0135761, v39
    v_exp_f32 v39, v39
    s_nop 0
    v_add_f32 v39, 1.0, v39
    v_rcp_f32 v39, v39
    s_nop 0
    v_mul_f32 v35, v35, v39
    v_mul_f32 v38, v36, v36
    v_mul_f32 v38, v38, v36
    v_mov_b32 v39, v36
    v_fmac_f32 v39, 0x3d372713, v38
    v_mul_f32 v39, 0xc0135761, v39
    v_exp_f32 v39, v39
    s_nop 0
    v_add_f32 v39, 1.0, v39
    v_rcp_f32 v39, v39
    s_nop 0
    v_mul_f32 v36, v36, v39
    v_mul_f32 v38, v37, v37
    v_mul_f32 v38, v38, v37
    v_mov_b32 v39, v37
    v_fmac_f32 v39, 0x3d372713, v38
    v_mul_f32 v39, 0xc0135761, v39
    v_exp_f32 v39, v39
    s_nop 0
    v_add_f32 v39, 1.0, v39
    v_rcp_f32 v39, v39
    s_nop 0
    v_mul_f32 v37, v37, v39
    v_cvt_pk_bf16_f32 v32, v34, v35
    v_cvt_pk_bf16_f32 v33, v36, v37
    buffer_store_dwordx2 v[32:33], v7, s[16:19], s4 offen offset:64
    s_nop 1
    v_cvt_pk_bf16_f32 v32, v212, v213
    v_cvt_pk_bf16_f32 v33, v214, v215
    v_lshlrev_b32 v34, 16, v32
    v_and_b32 v35, 0xffff0000, v32
    v_lshlrev_b32 v36, 16, v33
    v_and_b32 v37, 0xffff0000, v33
    v_lshlrev_b32 v38, 16, v58
    v_add_f32 v34, v34, v38
    v_and_b32 v38, 0xffff0000, v58
    v_add_f32 v35, v35, v38
    v_lshlrev_b32 v38, 16, v59
    v_add_f32 v36, v36, v38
    v_and_b32 v38, 0xffff0000, v59
    v_add_f32 v37, v37, v38
    v_cvt_pk_bf16_f32 v32, v34, v35
    v_cvt_pk_bf16_f32 v33, v36, v37
    v_lshlrev_b32 v34, 16, v32
    v_and_b32 v35, 0xffff0000, v32
    v_lshlrev_b32 v36, 16, v33
    v_and_b32 v37, 0xffff0000, v33
    v_mul_f32 v38, v34, v34
    v_mul_f32 v38, v38, v34
    v_mov_b32 v39, v34
    v_fmac_f32 v39, 0x3d372713, v38
    v_mul_f32 v39, 0xc0135761, v39
    v_exp_f32 v39, v39
    s_nop 0
    v_add_f32 v39, 1.0, v39
    v_rcp_f32 v39, v39
    s_nop 0
    v_mul_f32 v34, v34, v39
    v_mul_f32 v38, v35, v35
    v_mul_f32 v38, v38, v35
    v_mov_b32 v39, v35
    v_fmac_f32 v39, 0x3d372713, v38
    v_mul_f32 v39, 0xc0135761, v39
    v_exp_f32 v39, v39
    s_nop 0
    v_add_f32 v39, 1.0, v39
    v_rcp_f32 v39, v39
    s_nop 0
    v_mul_f32 v35, v35, v39
    v_mul_f32 v38, v36, v36
    v_mul_f32 v38, v38, v36
    v_mov_b32 v39, v36
    v_fmac_f32 v39, 0x3d372713, v38
    v_mul_f32 v39, 0xc0135761, v39
    v_exp_f32 v39, v39
    s_nop 0
    v_add_f32 v39, 1.0, v39
    v_rcp_f32 v39, v39
    s_nop 0
    v_mul_f32 v36, v36, v39
    v_mul_f32 v38, v37, v37
    v_mul_f32 v38, v38, v37
    v_mov_b32 v39, v37
    v_fmac_f32 v39, 0x3d372713, v38
    v_mul_f32 v39, 0xc0135761, v39
    v_exp_f32 v39, v39
    s_nop 0
    v_add_f32 v39, 1.0, v39
    v_rcp_f32 v39, v39
    s_nop 0
    v_mul_f32 v37, v37, v39
    v_cvt_pk_bf16_f32 v32, v34, v35
    v_cvt_pk_bf16_f32 v33, v36, v37
    buffer_store_dwordx2 v[32:33], v7, s[16:19], s4 offen offset:80
    s_nop 1
    v_cvt_pk_bf16_f32 v32, v216, v217
    v_cvt_pk_bf16_f32 v33, v218, v219
    v_lshlrev_b32 v34, 16, v32
    v_and_b32 v35, 0xffff0000, v32
    v_lshlrev_b32 v36, 16, v33
    v_and_b32 v37, 0xffff0000, v33
    v_lshlrev_b32 v38, 16, v60
    v_add_f32 v34, v34, v38
    v_and_b32 v38, 0xffff0000, v60
    v_add_f32 v35, v35, v38
    v_lshlrev_b32 v38, 16, v61
    v_add_f32 v36, v36, v38
    v_and_b32 v38, 0xffff0000, v61
    v_add_f32 v37, v37, v38
    v_cvt_pk_bf16_f32 v32, v34, v35
    v_cvt_pk_bf16_f32 v33, v36, v37
    v_lshlrev_b32 v34, 16, v32
    v_and_b32 v35, 0xffff0000, v32
    v_lshlrev_b32 v36, 16, v33
    v_and_b32 v37, 0xffff0000, v33
    v_mul_f32 v38, v34, v34
    v_mul_f32 v38, v38, v34
    v_mov_b32 v39, v34
    v_fmac_f32 v39, 0x3d372713, v38
    v_mul_f32 v39, 0xc0135761, v39
    v_exp_f32 v39, v39
    s_nop 0
    v_add_f32 v39, 1.0, v39
    v_rcp_f32 v39, v39
    s_nop 0
    v_mul_f32 v34, v34, v39
    v_mul_f32 v38, v35, v35
    v_mul_f32 v38, v38, v35
    v_mov_b32 v39, v35
    v_fmac_f32 v39, 0x3d372713, v38
    v_mul_f32 v39, 0xc0135761, v39
    v_exp_f32 v39, v39
    s_nop 0
    v_add_f32 v39, 1.0, v39
    v_rcp_f32 v39, v39
    s_nop 0
    v_mul_f32 v35, v35, v39
    v_mul_f32 v38, v36, v36
    v_mul_f32 v38, v38, v36
    v_mov_b32 v39, v36
    v_fmac_f32 v39, 0x3d372713, v38
    v_mul_f32 v39, 0xc0135761, v39
    v_exp_f32 v39, v39
    s_nop 0
    v_add_f32 v39, 1.0, v39
    v_rcp_f32 v39, v39
    s_nop 0
    v_mul_f32 v36, v36, v39
    v_mul_f32 v38, v37, v37
    v_mul_f32 v38, v38, v37
    v_mov_b32 v39, v37
    v_fmac_f32 v39, 0x3d372713, v38
    v_mul_f32 v39, 0xc0135761, v39
    v_exp_f32 v39, v39
    s_nop 0
    v_add_f32 v39, 1.0, v39
    v_rcp_f32 v39, v39
    s_nop 0
    v_mul_f32 v37, v37, v39
    v_cvt_pk_bf16_f32 v32, v34, v35
    v_cvt_pk_bf16_f32 v33, v36, v37
    buffer_store_dwordx2 v[32:33], v7, s[16:19], s4 offen offset:96
    s_nop 1
    v_cvt_pk_bf16_f32 v32, v220, v221
    v_cvt_pk_bf16_f32 v33, v222, v223
    v_lshlrev_b32 v34, 16, v32
    v_and_b32 v35, 0xffff0000, v32
    v_lshlrev_b32 v36, 16, v33
    v_and_b32 v37, 0xffff0000, v33
    v_lshlrev_b32 v38, 16, v62
    v_add_f32 v34, v34, v38
    v_and_b32 v38, 0xffff0000, v62
    v_add_f32 v35, v35, v38
    v_lshlrev_b32 v38, 16, v63
    v_add_f32 v36, v36, v38
    v_and_b32 v38, 0xffff0000, v63
    v_add_f32 v37, v37, v38
    v_cvt_pk_bf16_f32 v32, v34, v35
    v_cvt_pk_bf16_f32 v33, v36, v37
    v_lshlrev_b32 v34, 16, v32
    v_and_b32 v35, 0xffff0000, v32
    v_lshlrev_b32 v36, 16, v33
    v_and_b32 v37, 0xffff0000, v33
    v_mul_f32 v38, v34, v34
    v_mul_f32 v38, v38, v34
    v_mov_b32 v39, v34
    v_fmac_f32 v39, 0x3d372713, v38
    v_mul_f32 v39, 0xc0135761, v39
    v_exp_f32 v39, v39
    s_nop 0
    v_add_f32 v39, 1.0, v39
    v_rcp_f32 v39, v39
    s_nop 0
    v_mul_f32 v34, v34, v39
    v_mul_f32 v38, v35, v35
    v_mul_f32 v38, v38, v35
    v_mov_b32 v39, v35
    v_fmac_f32 v39, 0x3d372713, v38
    v_mul_f32 v39, 0xc0135761, v39
    v_exp_f32 v39, v39
    s_nop 0
    v_add_f32 v39, 1.0, v39
    v_rcp_f32 v39, v39
    s_nop 0
    v_mul_f32 v35, v35, v39
    v_mul_f32 v38, v36, v36
    v_mul_f32 v38, v38, v36
    v_mov_b32 v39, v36
    v_fmac_f32 v39, 0x3d372713, v38
    v_mul_f32 v39, 0xc0135761, v39
    v_exp_f32 v39, v39
    s_nop 0
    v_add_f32 v39, 1.0, v39
    v_rcp_f32 v39, v39
    s_nop 0
    v_mul_f32 v36, v36, v39
    v_mul_f32 v38, v37, v37
    v_mul_f32 v38, v38, v37
    v_mov_b32 v39, v37
    v_fmac_f32 v39, 0x3d372713, v38
    v_mul_f32 v39, 0xc0135761, v39
    v_exp_f32 v39, v39
    s_nop 0
    v_add_f32 v39, 1.0, v39
    v_rcp_f32 v39, v39
    s_nop 0
    v_mul_f32 v37, v37, v39
    v_cvt_pk_bf16_f32 v32, v34, v35
    v_cvt_pk_bf16_f32 v33, v36, v37
    buffer_store_dwordx2 v[32:33], v7, s[16:19], s4 offen offset:112
    s_nop 1
    s_mov_b32 s4, 688128
    s_waitcnt vmcnt(0)
    v_cvt_pk_bf16_f32 v32, v240, v241
    v_cvt_pk_bf16_f32 v33, v242, v243
    v_lshlrev_b32 v34, 16, v32
    v_and_b32 v35, 0xffff0000, v32
    v_lshlrev_b32 v36, 16, v33
    v_and_b32 v37, 0xffff0000, v33
    v_lshlrev_b32 v38, 16, v56
    v_add_f32 v34, v34, v38
    v_and_b32 v38, 0xffff0000, v56
    v_add_f32 v35, v35, v38
    v_lshlrev_b32 v38, 16, v57
    v_add_f32 v36, v36, v38
    v_and_b32 v38, 0xffff0000, v57
    v_add_f32 v37, v37, v38
    v_cvt_pk_bf16_f32 v32, v34, v35
    v_cvt_pk_bf16_f32 v33, v36, v37
    v_lshlrev_b32 v34, 16, v32
    v_and_b32 v35, 0xffff0000, v32
    v_lshlrev_b32 v36, 16, v33
    v_and_b32 v37, 0xffff0000, v33
    v_mul_f32 v38, v34, v34
    v_mul_f32 v38, v38, v34
    v_mov_b32 v39, v34
    v_fmac_f32 v39, 0x3d372713, v38
    v_mul_f32 v39, 0xc0135761, v39
    v_exp_f32 v39, v39
    s_nop 0
    v_add_f32 v39, 1.0, v39
    v_rcp_f32 v39, v39
    s_nop 0
    v_mul_f32 v34, v34, v39
    v_mul_f32 v38, v35, v35
    v_mul_f32 v38, v38, v35
    v_mov_b32 v39, v35
    v_fmac_f32 v39, 0x3d372713, v38
    v_mul_f32 v39, 0xc0135761, v39
    v_exp_f32 v39, v39
    s_nop 0
    v_add_f32 v39, 1.0, v39
    v_rcp_f32 v39, v39
    s_nop 0
    v_mul_f32 v35, v35, v39
    v_mul_f32 v38, v36, v36
    v_mul_f32 v38, v38, v36
    v_mov_b32 v39, v36
    v_fmac_f32 v39, 0x3d372713, v38
    v_mul_f32 v39, 0xc0135761, v39
    v_exp_f32 v39, v39
    s_nop 0
    v_add_f32 v39, 1.0, v39
    v_rcp_f32 v39, v39
    s_nop 0
    v_mul_f32 v36, v36, v39
    v_mul_f32 v38, v37, v37
    v_mul_f32 v38, v38, v37
    v_mov_b32 v39, v37
    v_fmac_f32 v39, 0x3d372713, v38
    v_mul_f32 v39, 0xc0135761, v39
    v_exp_f32 v39, v39
    s_nop 0
    v_add_f32 v39, 1.0, v39
    v_rcp_f32 v39, v39
    s_nop 0
    v_mul_f32 v37, v37, v39
    v_cvt_pk_bf16_f32 v32, v34, v35
    v_cvt_pk_bf16_f32 v33, v36, v37
    buffer_store_dwordx2 v[32:33], v7, s[16:19], s4 offen offset:64
    s_nop 1
    v_cvt_pk_bf16_f32 v32, v244, v245
    v_cvt_pk_bf16_f32 v33, v246, v247
    v_lshlrev_b32 v34, 16, v32
    v_and_b32 v35, 0xffff0000, v32
    v_lshlrev_b32 v36, 16, v33
    v_and_b32 v37, 0xffff0000, v33
    v_lshlrev_b32 v38, 16, v58
    v_add_f32 v34, v34, v38
    v_and_b32 v38, 0xffff0000, v58
    v_add_f32 v35, v35, v38
    v_lshlrev_b32 v38, 16, v59
    v_add_f32 v36, v36, v38
    v_and_b32 v38, 0xffff0000, v59
    v_add_f32 v37, v37, v38
    v_cvt_pk_bf16_f32 v32, v34, v35
    v_cvt_pk_bf16_f32 v33, v36, v37
    v_lshlrev_b32 v34, 16, v32
    v_and_b32 v35, 0xffff0000, v32
    v_lshlrev_b32 v36, 16, v33
    v_and_b32 v37, 0xffff0000, v33
    v_mul_f32 v38, v34, v34
    v_mul_f32 v38, v38, v34
    v_mov_b32 v39, v34
    v_fmac_f32 v39, 0x3d372713, v38
    v_mul_f32 v39, 0xc0135761, v39
    v_exp_f32 v39, v39
    s_nop 0
    v_add_f32 v39, 1.0, v39
    v_rcp_f32 v39, v39
    s_nop 0
    v_mul_f32 v34, v34, v39
    v_mul_f32 v38, v35, v35
    v_mul_f32 v38, v38, v35
    v_mov_b32 v39, v35
    v_fmac_f32 v39, 0x3d372713, v38
    v_mul_f32 v39, 0xc0135761, v39
    v_exp_f32 v39, v39
    s_nop 0
    v_add_f32 v39, 1.0, v39
    v_rcp_f32 v39, v39
    s_nop 0
    v_mul_f32 v35, v35, v39
    v_mul_f32 v38, v36, v36
    v_mul_f32 v38, v38, v36
    v_mov_b32 v39, v36
    v_fmac_f32 v39, 0x3d372713, v38
    v_mul_f32 v39, 0xc0135761, v39
    v_exp_f32 v39, v39
    s_nop 0
    v_add_f32 v39, 1.0, v39
    v_rcp_f32 v39, v39
    s_nop 0
    v_mul_f32 v36, v36, v39
    v_mul_f32 v38, v37, v37
    v_mul_f32 v38, v38, v37
    v_mov_b32 v39, v37
    v_fmac_f32 v39, 0x3d372713, v38
    v_mul_f32 v39, 0xc0135761, v39
    v_exp_f32 v39, v39
    s_nop 0
    v_add_f32 v39, 1.0, v39
    v_rcp_f32 v39, v39
    s_nop 0
    v_mul_f32 v37, v37, v39
    v_cvt_pk_bf16_f32 v32, v34, v35
    v_cvt_pk_bf16_f32 v33, v36, v37
    buffer_store_dwordx2 v[32:33], v7, s[16:19], s4 offen offset:80
    s_nop 1
    v_cvt_pk_bf16_f32 v32, v248, v249
    v_cvt_pk_bf16_f32 v33, v250, v251
    v_lshlrev_b32 v34, 16, v32
    v_and_b32 v35, 0xffff0000, v32
    v_lshlrev_b32 v36, 16, v33
    v_and_b32 v37, 0xffff0000, v33
    v_lshlrev_b32 v38, 16, v60
    v_add_f32 v34, v34, v38
    v_and_b32 v38, 0xffff0000, v60
    v_add_f32 v35, v35, v38
    v_lshlrev_b32 v38, 16, v61
    v_add_f32 v36, v36, v38
    v_and_b32 v38, 0xffff0000, v61
    v_add_f32 v37, v37, v38
    v_cvt_pk_bf16_f32 v32, v34, v35
    v_cvt_pk_bf16_f32 v33, v36, v37
    v_lshlrev_b32 v34, 16, v32
    v_and_b32 v35, 0xffff0000, v32
    v_lshlrev_b32 v36, 16, v33
    v_and_b32 v37, 0xffff0000, v33
    v_mul_f32 v38, v34, v34
    v_mul_f32 v38, v38, v34
    v_mov_b32 v39, v34
    v_fmac_f32 v39, 0x3d372713, v38
    v_mul_f32 v39, 0xc0135761, v39
    v_exp_f32 v39, v39
    s_nop 0
    v_add_f32 v39, 1.0, v39
    v_rcp_f32 v39, v39
    s_nop 0
    v_mul_f32 v34, v34, v39
    v_mul_f32 v38, v35, v35
    v_mul_f32 v38, v38, v35
    v_mov_b32 v39, v35
    v_fmac_f32 v39, 0x3d372713, v38
    v_mul_f32 v39, 0xc0135761, v39
    v_exp_f32 v39, v39
    s_nop 0
    v_add_f32 v39, 1.0, v39
    v_rcp_f32 v39, v39
    s_nop 0
    v_mul_f32 v35, v35, v39
    v_mul_f32 v38, v36, v36
    v_mul_f32 v38, v38, v36
    v_mov_b32 v39, v36
    v_fmac_f32 v39, 0x3d372713, v38
    v_mul_f32 v39, 0xc0135761, v39
    v_exp_f32 v39, v39
    s_nop 0
    v_add_f32 v39, 1.0, v39
    v_rcp_f32 v39, v39
    s_nop 0
    v_mul_f32 v36, v36, v39
    v_mul_f32 v38, v37, v37
    v_mul_f32 v38, v38, v37
    v_mov_b32 v39, v37
    v_fmac_f32 v39, 0x3d372713, v38
    v_mul_f32 v39, 0xc0135761, v39
    v_exp_f32 v39, v39
    s_nop 0
    v_add_f32 v39, 1.0, v39
    v_rcp_f32 v39, v39
    s_nop 0
    v_mul_f32 v37, v37, v39
    v_cvt_pk_bf16_f32 v32, v34, v35
    v_cvt_pk_bf16_f32 v33, v36, v37
    buffer_store_dwordx2 v[32:33], v7, s[16:19], s4 offen offset:96
    s_nop 1
    v_cvt_pk_bf16_f32 v32, v252, v253
    v_cvt_pk_bf16_f32 v33, v254, v255
    v_lshlrev_b32 v34, 16, v32
    v_and_b32 v35, 0xffff0000, v32
    v_lshlrev_b32 v36, 16, v33
    v_and_b32 v37, 0xffff0000, v33
    v_lshlrev_b32 v38, 16, v62
    v_add_f32 v34, v34, v38
    v_and_b32 v38, 0xffff0000, v62
    v_add_f32 v35, v35, v38
    v_lshlrev_b32 v38, 16, v63
    v_add_f32 v36, v36, v38
    v_and_b32 v38, 0xffff0000, v63
    v_add_f32 v37, v37, v38
    v_cvt_pk_bf16_f32 v32, v34, v35
    v_cvt_pk_bf16_f32 v33, v36, v37
    v_lshlrev_b32 v34, 16, v32
    v_and_b32 v35, 0xffff0000, v32
    v_lshlrev_b32 v36, 16, v33
    v_and_b32 v37, 0xffff0000, v33
    v_mul_f32 v38, v34, v34
    v_mul_f32 v38, v38, v34
    v_mov_b32 v39, v34
    v_fmac_f32 v39, 0x3d372713, v38
    v_mul_f32 v39, 0xc0135761, v39
    v_exp_f32 v39, v39
    s_nop 0
    v_add_f32 v39, 1.0, v39
    v_rcp_f32 v39, v39
    s_nop 0
    v_mul_f32 v34, v34, v39
    v_mul_f32 v38, v35, v35
    v_mul_f32 v38, v38, v35
    v_mov_b32 v39, v35
    v_fmac_f32 v39, 0x3d372713, v38
    v_mul_f32 v39, 0xc0135761, v39
    v_exp_f32 v39, v39
    s_nop 0
    v_add_f32 v39, 1.0, v39
    v_rcp_f32 v39, v39
    s_nop 0
    v_mul_f32 v35, v35, v39
    v_mul_f32 v38, v36, v36
    v_mul_f32 v38, v38, v36
    v_mov_b32 v39, v36
    v_fmac_f32 v39, 0x3d372713, v38
    v_mul_f32 v39, 0xc0135761, v39
    v_exp_f32 v39, v39
    s_nop 0
    v_add_f32 v39, 1.0, v39
    v_rcp_f32 v39, v39
    s_nop 0
    v_mul_f32 v36, v36, v39
    v_mul_f32 v38, v37, v37
    v_mul_f32 v38, v38, v37
    v_mov_b32 v39, v37
    v_fmac_f32 v39, 0x3d372713, v38
    v_mul_f32 v39, 0xc0135761, v39
    v_exp_f32 v39, v39
    s_nop 0
    v_add_f32 v39, 1.0, v39
    v_rcp_f32 v39, v39
    s_nop 0
    v_mul_f32 v37, v37, v39
    v_cvt_pk_bf16_f32 v32, v34, v35
    v_cvt_pk_bf16_f32 v33, v36, v37
    buffer_store_dwordx2 v[32:33], v7, s[16:19], s4 offen offset:112
    s_nop 1
.gemm_w1_kernel_done:
    s_endpgm
.section .rodata,"a"
.p2align 6
.amdhsa_kernel gemm_w1_kernel
  .amdhsa_next_free_vgpr 256
  .amdhsa_next_free_sgpr 64
  .amdhsa_accum_offset 256
  .amdhsa_group_segment_fixed_size 0
  .amdhsa_kernarg_size 120
  .amdhsa_user_sgpr_count 2
  .amdhsa_user_sgpr_kernarg_segment_ptr 1
  .amdhsa_system_sgpr_workgroup_id_x 1
.end_amdhsa_kernel
.text
.globl gemm_w2a_kernel
.p2align 8
.type gemm_w2a_kernel,@function
gemm_w2a_kernel:
    s_cmp_ge_u32 s2, 256
    s_cbranch_scc1 .gemm_w2a_kernel_done
    s_load_dwordx2 s[6:7], s[0:1], 112
    s_load_dwordx2 s[28:29], s[0:1], 80
    s_load_dwordx2 s[38:39], s[0:1], 88
    s_and_b32 s40, s2, 15
    s_lshr_b32 s41, s2, 4
    s_waitcnt lgkmcnt(0)
    s_add_u32 s4, s6, 0x5000000
    s_addc_u32 s5, s7, 0
    s_mov_b32 s8, s4
    s_and_b32 s9, s5, 0xffff
    s_mov_b32 s10, 0xe00000
    s_mov_b32 s11, 0x00020000
    s_mul_i32 s42, s41, 64
    s_mov_b32 s4, s28
    s_mov_b32 s5, s29
    s_mov_b32 s43, s42
    s_mov_b32 s12, s4
    s_and_b32 s13, s5, 0xffff
    s_mov_b32 s14, 0x700000
    s_mov_b32 s15, 0x00020000
    s_mul_i32 s44, s40, 917504
    s_lshl_b32 s45, s43, 1
    v_and_b32 v1, 63, v0
    v_lshrrev_b32 v2, 6, v0
    s_nop 0
    v_readfirstlane_b32 s46, v2
    v_lshrrev_b32 v3, 3, v1
    v_and_b32 v4, 7, v1
    v_xor_b32 v4, v4, v3
    v_lshlrev_b32 v4, 4, v4
    s_mov_b32 s47, 7168
    v_mul_lo_u32 v3, v3, s47
    v_add_u32 v10, v3, v4
    v_lshrrev_b32 v3, 3, v1
    v_and_b32 v4, 7, v1
    v_lshrrev_b32 v5, 1, v3
    v_and_b32 v5, 1, v5
    v_lshlrev_b32 v5, 2, v5
    v_xor_b32 v4, v4, v5
    v_lshlrev_b32 v4, 4, v4
    s_mov_b32 s47, 2048
    v_mul_lo_u32 v3, v3, s47
    v_add_u32 v11, v3, v4
    s_mul_i32 s48, s46, 229376
    s_add_u32 s44, s44, s48
    s_mul_i32 s48, s46, 32768
    s_add_u32 s45, s45, s48
    s_mul_i32 s49, s46, 4096
    s_mul_i32 s50, s46, 2048
    s_add_u32 s50, s50, 16384
    v_lshrrev_b32 v3, 1, v2
    v_and_b32 v4, 1, v2
    v_and_b32 v5, 31, v1
    v_lshrrev_b32 v6, 5, v1
    v_mul_u32_u24 v7, 64, v3
    v_add_u32 v7, v7, v5
    v_lshlrev_b32 v7, 7, v7
    v_and_b32 v8, 7, v1
    v_xor_b32 v8, v8, v6
    v_lshlrev_b32 v8, 4, v8
    v_add_u32 v12, v7, v8
    v_xor_b32 v13, 32, v12
    v_xor_b32 v14, 64, v12
    v_xor_b32 v15, 96, v12
    v_lshrrev_b32 v7, 4, v1
    v_and_b32 v7, 1, v7
    v_lshrrev_b32 v8, 2, v1
    v_and_b32 v8, 3, v8
    v_and_b32 v9, 3, v1
    v_mul_u32_u24 v16, 4, v4
    v_lshl_add_u32 v16, v7, 1, v16
    v_lshrrev_b32 v17, 1, v9
    v_add_u32 v16, v16, v17
    v_lshrrev_b32 v17, 1, v8
    v_lshlrev_b32 v17, 2, v17
    v_lshl_add_u32 v18, v6, 3, v8
    v_mul_u32_u24 v18, 128, v18
    v_and_b32 v19, 1, v9
    v_lshl_add_u32 v18, v19, 3, v18
    v_add_u32 v18, 16384, v18
    v_add_u32 v19, 0, v16
    v_xor_b32 v19, v19, v17
    v_lshl_add_u32 v20, v19, 4, v18
    v_mov_b32 v128, 0
    v_mov_b32 v129, 0
    v_mov_b32 v130, 0
    v_mov_b32 v131, 0
    v_mov_b32 v132, 0
    v_mov_b32 v133, 0
    v_mov_b32 v134, 0
    v_mov_b32 v135, 0
    v_mov_b32 v136, 0
    v_mov_b32 v137, 0
    v_mov_b32 v138, 0
    v_mov_b32 v139, 0
    v_mov_b32 v140, 0
    v_mov_b32 v141, 0
    v_mov_b32 v142, 0
    v_mov_b32 v143, 0
    v_mov_b32 v144, 0
    v_mov_b32 v145, 0
    v_mov_b32 v146, 0
    v_mov_b32 v147, 0
    v_mov_b32 v148, 0
    v_mov_b32 v149, 0
    v_mov_b32 v150, 0
    v_mov_b32 v151, 0
    v_mov_b32 v152, 0
    v_mov_b32 v153, 0
    v_mov_b32 v154, 0
    v_mov_b32 v155, 0
    v_mov_b32 v156, 0
    v_mov_b32 v157, 0
    v_mov_b32 v158, 0
    v_mov_b32 v159, 0
    s_mov_b32 s51, 0
    s_add_u32 s52, s51, s49
    s_mov_b32 m0, s52
    s_add_u32 s53, s44, 0
    buffer_load_dwordx4 v10, s[8:11], s53 offen lds
    s_add_u32 s52, s51, s49
    s_add_u32 s52, s52, 1024
    s_mov_b32 m0, s52
    s_add_u32 s53, s44, 57344
    buffer_load_dwordx4 v10, s[8:11], s53 offen lds
    s_add_u32 s52, s51, s49
    s_add_u32 s52, s52, 2048
    s_mov_b32 m0, s52
    s_add_u32 s53, s44, 114688
    buffer_load_dwordx4 v10, s[8:11], s53 offen lds
    s_add_u32 s52, s51, s49
    s_add_u32 s52, s52, 3072
    s_mov_b32 m0, s52
    s_add_u32 s53, s44, 172032
    buffer_load_dwordx4 v10, s[8:11], s53 offen lds
    s_add_u32 s52, s51, s50
    s_mov_b32 m0, s52
    s_add_u32 s53, s45, 0
    buffer_load_dwordx4 v11, s[12:15], s53 offen lds
    s_add_u32 s52, s51, s50
    s_add_u32 s52, s52, 1024
    s_mov_b32 m0, s52
    s_add_u32 s53, s45, 16384
    buffer_load_dwordx4 v11, s[12:15], s53 offen lds
    s_add_u32 s44, s44, 128
    s_add_u32 s45, s45, 131072
    s_add_u32 s51, s51, 24576
    s_cmp_eq_u32 s51, 73728
    s_cselect_b32 s51, 0, s51
    s_add_u32 s52, s51, s49
    s_mov_b32 m0, s52
    s_add_u32 s53, s44, 0
    buffer_load_dwordx4 v10, s[8:11], s53 offen lds
    s_add_u32 s52, s51, s49
    s_add_u32 s52, s52, 1024
    s_mov_b32 m0, s52
    s_add_u32 s53, s44, 57344
    buffer_load_dwordx4 v10, s[8:11], s53 offen lds
    s_add_u32 s52, s51, s49
    s_add_u32 s52, s52, 2048
    s_mov_b32 m0, s52
    s_add_u32 s53, s44, 114688
    buffer_load_dwordx4 v10, s[8:11], s53 offen lds
    s_add_u32 s52, s51, s49
    s_add_u32 s52, s52, 3072
    s_mov_b32 m0, s52
    s_add_u32 s53, s44, 172032
    buffer_load_dwordx4 v10, s[8:11], s53 offen lds
    s_add_u32 s52, s51, s50
    s_mov_b32 m0, s52
    s_add_u32 s53, s45, 0
    buffer_load_dwordx4 v11, s[12:15], s53 offen lds
    s_add_u32 s52, s51, s50
    s_add_u32 s52, s52, 1024
    s_mov_b32 m0, s52
    s_add_u32 s53, s45, 16384
    buffer_load_dwordx4 v11, s[12:15], s53 offen lds
    s_add_u32 s44, s44, 128
    s_add_u32 s45, s45, 131072
    s_add_u32 s51, s51, 24576
    s_cmp_eq_u32 s51, 73728
    s_cselect_b32 s51, 0, s51
    s_mov_b32 s54, 0
    s_mov_b32 s55, 0
.gemm_w2a_kernel_loop:
    s_waitcnt vmcnt(6)
    s_barrier
    v_add_u32 v24, s54, v12
    v_add_u32 v25, s54, v13
    v_add_u32 v26, s54, v14
    v_add_u32 v27, s54, v15
    v_add_u32 v28, s54, v20
    ds_read_b128 v[32:35], v24 offset:0
    ds_read_b128 v[36:39], v24 offset:4096
    ds_read_b64_tr_b16 v[48:49], v28 offset:0
    ds_read_b64_tr_b16 v[50:51], v28 offset:512
    ds_read_b128 v[56:59], v25 offset:0
    ds_read_b128 v[60:63], v25 offset:4096
    ds_read_b64_tr_b16 v[72:73], v28 offset:2048
    ds_read_b64_tr_b16 v[74:75], v28 offset:2560
    s_waitcnt lgkmcnt(4)
    v_mfma_f32_32x32x16_bf16 v[128:143], v[48:51], v[32:35], v[128:143]
    s_add_u32 s52, s51, s49
    s_mov_b32 m0, s52
    s_add_u32 s53, s44, 0
    buffer_load_dwordx4 v10, s[8:11], s53 offen lds
    v_mfma_f32_32x32x16_bf16 v[144:159], v[48:51], v[36:39], v[144:159]
    s_add_u32 s52, s51, s49
    s_add_u32 s52, s52, 1024
    s_mov_b32 m0, s52
    s_add_u32 s53, s44, 57344
    buffer_load_dwordx4 v10, s[8:11], s53 offen lds
    ds_read_b128 v[32:35], v26 offset:0
    ds_read_b128 v[36:39], v26 offset:4096
    ds_read_b64_tr_b16 v[48:49], v28 offset:4096
    ds_read_b64_tr_b16 v[50:51], v28 offset:4608
    s_waitcnt lgkmcnt(4)
    v_mfma_f32_32x32x16_bf16 v[128:143], v[72:75], v[56:59], v[128:143]
    s_add_u32 s52, s51, s49
    s_add_u32 s52, s52, 2048
    s_mov_b32 m0, s52
    s_add_u32 s53, s44, 114688
    buffer_load_dwordx4 v10, s[8:11], s53 offen lds
    v_mfma_f32_32x32x16_bf16 v[144:159], v[72:75], v[60:63], v[144:159]
    ds_read_b128 v[56:59], v27 offset:0
    ds_read_b128 v[60:63], v27 offset:4096
    ds_read_b64_tr_b16 v[72:73], v28 offset:6144
    ds_read_b64_tr_b16 v[74:75], v28 offset:6656
    s_waitcnt lgkmcnt(4)
    v_mfma_f32_32x32x16_bf16 v[128:143], v[48:51], v[32:35], v[128:143]
    s_add_u32 s52, s51, s49
    s_add_u32 s52, s52, 3072
    s_mov_b32 m0, s52
    s_add_u32 s53, s44, 172032
    buffer_load_dwordx4 v10, s[8:11], s53 offen lds
    v_mfma_f32_32x32x16_bf16 v[144:159], v[48:51], v[36:39], v[144:159]
    s_add_u32 s52, s51, s50
    s_mov_b32 m0, s52
    s_add_u32 s53, s45, 0
    buffer_load_dwordx4 v11, s[12:15], s53 offen lds
    s_waitcnt lgkmcnt(0)
    v_mfma_f32_32x32x16_bf16 v[128:143], v[72:75], v[56:59], v[128:143]
    s_add_u32 s52, s51, s50
    s_add_u32 s52, s52, 1024
    s_mov_b32 m0, s52
    s_add_u32 s53, s45, 16384
    buffer_load_dwordx4 v11, s[12:15], s53 offen lds
    v_mfma_f32_32x32x16_bf16 v[144:159], v[72:75], v[60:63], v[144:159]
    s_add_u32 s44, s44, 128
    s_add_u32 s45, s45, 131072
    s_add_u32 s51, s51, 24576
    s_cmp_eq_u32 s51, 73728
    s_cselect_b32 s51, 0, s51
    s_add_u32 s54, s54, 24576
    s_cmp_eq_u32 s54, 73728
    s_cselect_b32 s54, 0, s54
    s_add_u32 s55, s55, 1
    s_cmp_lt_u32 s55, 56
    s_cbranch_scc1 .gemm_w2a_kernel_loop
    s_waitcnt vmcnt(0)
    s_nop 15
    s_nop 15
    s_add_u32 s4, s6, 0x800000
    s_addc_u32 s5, s7, 0
    s_mov_b32 s16, s4
    s_and_b32 s17, s5, 0xffff
    s_mov_b32 s18, 0x400000
    s_mov_b32 s19, 0x00020000
    s_add_u32 s4, s6, 0x400000
    s_addc_u32 s5, s7, 0
    s_mov_b32 s20, s4
    s_and_b32 s21, s5, 0xffff
    s_mov_b32 s22, 0x400000
    s_mov_b32 s23, 0x00020000
    s_mov_b32 s24, s38
    s_and_b32 s25, s39, 0xffff
    s_mov_b32 s26, 0x800
    s_mov_b32 s27, 0x00020000
    s_mul_i32 s4, s40, 128
    v_mul_u32_u24 v7, 64, v3
    v_add_u32 v7, v7, v5
    v_add_u32 v7, s4, v7
    s_mov_b32 s47, 2048
    v_mul_lo_u32 v7, v7, s47
    v_mul_u32_u24 v8, 32, v4
    v_lshl_add_u32 v8, v6, 2, v8
    v_add_u32 v8, s42, v8
    v_lshlrev_b32 v8, 1, v8
    v_add_u32 v7, v7, v8
    buffer_load_dwordx2 v[56:57], v8, s[24:27], 0 offen offset:0
    buffer_load_dwordx2 v[58:59], v8, s[24:27], 0 offen offset:16
    buffer_load_dwordx2 v[60:61], v8, s[24:27], 0 offen offset:32
    buffer_load_dwordx2 v[62:63], v8, s[24:27], 0 offen offset:48
    s_mov_b32 s4, 0
    buffer_load_dwordx2 v[40:41], v7, s[20:23], s4 offen offset:0
    buffer_load_dwordx2 v[42:43], v7, s[20:23], s4 offen offset:16
    buffer_load_dwordx2 v[44:45], v7, s[20:23], s4 offen offset:32
    buffer_load_dwordx2 v[46:47], v7, s[20:23], s4 offen offset:48
    s_waitcnt vmcnt(0)
    v_cvt_pk_bf16_f32 v32, v128, v129
    v_cvt_pk_bf16_f32 v33, v130, v131
    v_lshlrev_b32 v34, 16, v32
    v_and_b32 v35, 0xffff0000, v32
    v_lshlrev_b32 v36, 16, v33
    v_and_b32 v37, 0xffff0000, v33
    v_lshlrev_b32 v38, 16, v56
    v_add_f32 v34, v34, v38
    v_and_b32 v38, 0xffff0000, v56
    v_add_f32 v35, v35, v38
    v_lshlrev_b32 v38, 16, v57
    v_add_f32 v36, v36, v38
    v_and_b32 v38, 0xffff0000, v57
    v_add_f32 v37, v37, v38
    v_cvt_pk_bf16_f32 v32, v34, v35
    v_cvt_pk_bf16_f32 v33, v36, v37
    v_lshlrev_b32 v34, 16, v32
    v_and_b32 v35, 0xffff0000, v32
    v_lshlrev_b32 v36, 16, v33
    v_and_b32 v37, 0xffff0000, v33
    v_lshlrev_b32 v38, 16, v40
    v_add_f32 v34, v34, v38
    v_and_b32 v38, 0xffff0000, v40
    v_add_f32 v35, v35, v38
    v_lshlrev_b32 v38, 16, v41
    v_add_f32 v36, v36, v38
    v_and_b32 v38, 0xffff0000, v41
    v_add_f32 v37, v37, v38
    v_cvt_pk_bf16_f32 v32, v34, v35
    v_cvt_pk_bf16_f32 v33, v36, v37
    buffer_store_dwordx2 v[32:33], v7, s[16:19], s4 offen offset:0
    s_nop 1
    v_cvt_pk_bf16_f32 v32, v132, v133
    v_cvt_pk_bf16_f32 v33, v134, v135
    v_lshlrev_b32 v34, 16, v32
    v_and_b32 v35, 0xffff0000, v32
    v_lshlrev_b32 v36, 16, v33
    v_and_b32 v37, 0xffff0000, v33
    v_lshlrev_b32 v38, 16, v58
    v_add_f32 v34, v34, v38
    v_and_b32 v38, 0xffff0000, v58
    v_add_f32 v35, v35, v38
    v_lshlrev_b32 v38, 16, v59
    v_add_f32 v36, v36, v38
    v_and_b32 v38, 0xffff0000, v59
    v_add_f32 v37, v37, v38
    v_cvt_pk_bf16_f32 v32, v34, v35
    v_cvt_pk_bf16_f32 v33, v36, v37
    v_lshlrev_b32 v34, 16, v32
    v_and_b32 v35, 0xffff0000, v32
    v_lshlrev_b32 v36, 16, v33
    v_and_b32 v37, 0xffff0000, v33
    v_lshlrev_b32 v38, 16, v42
    v_add_f32 v34, v34, v38
    v_and_b32 v38, 0xffff0000, v42
    v_add_f32 v35, v35, v38
    v_lshlrev_b32 v38, 16, v43
    v_add_f32 v36, v36, v38
    v_and_b32 v38, 0xffff0000, v43
    v_add_f32 v37, v37, v38
    v_cvt_pk_bf16_f32 v32, v34, v35
    v_cvt_pk_bf16_f32 v33, v36, v37
    buffer_store_dwordx2 v[32:33], v7, s[16:19], s4 offen offset:16
    s_nop 1
    v_cvt_pk_bf16_f32 v32, v136, v137
    v_cvt_pk_bf16_f32 v33, v138, v139
    v_lshlrev_b32 v34, 16, v32
    v_and_b32 v35, 0xffff0000, v32
    v_lshlrev_b32 v36, 16, v33
    v_and_b32 v37, 0xffff0000, v33
    v_lshlrev_b32 v38, 16, v60
    v_add_f32 v34, v34, v38
    v_and_b32 v38, 0xffff0000, v60
    v_add_f32 v35, v35, v38
    v_lshlrev_b32 v38, 16, v61
    v_add_f32 v36, v36, v38
    v_and_b32 v38, 0xffff0000, v61
    v_add_f32 v37, v37, v38
    v_cvt_pk_bf16_f32 v32, v34, v35
    v_cvt_pk_bf16_f32 v33, v36, v37
    v_lshlrev_b32 v34, 16, v32
    v_and_b32 v35, 0xffff0000, v32
    v_lshlrev_b32 v36, 16, v33
    v_and_b32 v37, 0xffff0000, v33
    v_lshlrev_b32 v38, 16, v44
    v_add_f32 v34, v34, v38
    v_and_b32 v38, 0xffff0000, v44
    v_add_f32 v35, v35, v38
    v_lshlrev_b32 v38, 16, v45
    v_add_f32 v36, v36, v38
    v_and_b32 v38, 0xffff0000, v45
    v_add_f32 v37, v37, v38
    v_cvt_pk_bf16_f32 v32, v34, v35
    v_cvt_pk_bf16_f32 v33, v36, v37
    buffer_store_dwordx2 v[32:33], v7, s[16:19], s4 offen offset:32
    s_nop 1
    v_cvt_pk_bf16_f32 v32, v140, v141
    v_cvt_pk_bf16_f32 v33, v142, v143
    v_lshlrev_b32 v34, 16, v32
    v_and_b32 v35, 0xffff0000, v32
    v_lshlrev_b32 v36, 16, v33
    v_and_b32 v37, 0xffff0000, v33
    v_lshlrev_b32 v38, 16, v62
    v_add_f32 v34, v34, v38
    v_and_b32 v38, 0xffff0000, v62
    v_add_f32 v35, v35, v38
    v_lshlrev_b32 v38, 16, v63
    v_add_f32 v36, v36, v38
    v_and_b32 v38, 0xffff0000, v63
    v_add_f32 v37, v37, v38
    v_cvt_pk_bf16_f32 v32, v34, v35
    v_cvt_pk_bf16_f32 v33, v36, v37
    v_lshlrev_b32 v34, 16, v32
    v_and_b32 v35, 0xffff0000, v32
    v_lshlrev_b32 v36, 16, v33
    v_and_b32 v37, 0xffff0000, v33
    v_lshlrev_b32 v38, 16, v46
    v_add_f32 v34, v34, v38
    v_and_b32 v38, 0xffff0000, v46
    v_add_f32 v35, v35, v38
    v_lshlrev_b32 v38, 16, v47
    v_add_f32 v36, v36, v38
    v_and_b32 v38, 0xffff0000, v47
    v_add_f32 v37, v37, v38
    v_cvt_pk_bf16_f32 v32, v34, v35
    v_cvt_pk_bf16_f32 v33, v36, v37
    buffer_store_dwordx2 v[32:33], v7, s[16:19], s4 offen offset:48
    s_nop 1
    s_mov_b32 s4, 65536
    buffer_load_dwordx2 v[40:41], v7, s[20:23], s4 offen offset:0
    buffer_load_dwordx2 v[42:43], v7, s[20:23], s4 offen offset:16
    buffer_load_dwordx2 v[44:45], v7, s[20:23], s4 offen offset:32
    buffer_load_dwordx2 v[46:47], v7, s[20:23], s4 offen offset:48
    s_waitcnt vmcnt(0)
    v_cvt_pk_bf16_f32 v32, v144, v145
    v_cvt_pk_bf16_f32 v33, v146, v147
    v_lshlrev_b32 v34, 16, v32
    v_and_b32 v35, 0xffff0000, v32
    v_lshlrev_b32 v36, 16, v33
    v_and_b32 v37, 0xffff0000, v33
    v_lshlrev_b32 v38, 16, v56
    v_add_f32 v34, v34, v38
    v_and_b32 v38, 0xffff0000, v56
    v_add_f32 v35, v35, v38
    v_lshlrev_b32 v38, 16, v57
    v_add_f32 v36, v36, v38
    v_and_b32 v38, 0xffff0000, v57
    v_add_f32 v37, v37, v38
    v_cvt_pk_bf16_f32 v32, v34, v35
    v_cvt_pk_bf16_f32 v33, v36, v37
    v_lshlrev_b32 v34, 16, v32
    v_and_b32 v35, 0xffff0000, v32
    v_lshlrev_b32 v36, 16, v33
    v_and_b32 v37, 0xffff0000, v33
    v_lshlrev_b32 v38, 16, v40
    v_add_f32 v34, v34, v38
    v_and_b32 v38, 0xffff0000, v40
    v_add_f32 v35, v35, v38
    v_lshlrev_b32 v38, 16, v41
    v_add_f32 v36, v36, v38
    v_and_b32 v38, 0xffff0000, v41
    v_add_f32 v37, v37, v38
    v_cvt_pk_bf16_f32 v32, v34, v35
    v_cvt_pk_bf16_f32 v33, v36, v37
    buffer_store_dwordx2 v[32:33], v7, s[16:19], s4 offen offset:0
    s_nop 1
    v_cvt_pk_bf16_f32 v32, v148, v149
    v_cvt_pk_bf16_f32 v33, v150, v151
    v_lshlrev_b32 v34, 16, v32
    v_and_b32 v35, 0xffff0000, v32
    v_lshlrev_b32 v36, 16, v33
    v_and_b32 v37, 0xffff0000, v33
    v_lshlrev_b32 v38, 16, v58
    v_add_f32 v34, v34, v38
    v_and_b32 v38, 0xffff0000, v58
    v_add_f32 v35, v35, v38
    v_lshlrev_b32 v38, 16, v59
    v_add_f32 v36, v36, v38
    v_and_b32 v38, 0xffff0000, v59
    v_add_f32 v37, v37, v38
    v_cvt_pk_bf16_f32 v32, v34, v35
    v_cvt_pk_bf16_f32 v33, v36, v37
    v_lshlrev_b32 v34, 16, v32
    v_and_b32 v35, 0xffff0000, v32
    v_lshlrev_b32 v36, 16, v33
    v_and_b32 v37, 0xffff0000, v33
    v_lshlrev_b32 v38, 16, v42
    v_add_f32 v34, v34, v38
    v_and_b32 v38, 0xffff0000, v42
    v_add_f32 v35, v35, v38
    v_lshlrev_b32 v38, 16, v43
    v_add_f32 v36, v36, v38
    v_and_b32 v38, 0xffff0000, v43
    v_add_f32 v37, v37, v38
    v_cvt_pk_bf16_f32 v32, v34, v35
    v_cvt_pk_bf16_f32 v33, v36, v37
    buffer_store_dwordx2 v[32:33], v7, s[16:19], s4 offen offset:16
    s_nop 1
    v_cvt_pk_bf16_f32 v32, v152, v153
    v_cvt_pk_bf16_f32 v33, v154, v155
    v_lshlrev_b32 v34, 16, v32
    v_and_b32 v35, 0xffff0000, v32
    v_lshlrev_b32 v36, 16, v33
    v_and_b32 v37, 0xffff0000, v33
    v_lshlrev_b32 v38, 16, v60
    v_add_f32 v34, v34, v38
    v_and_b32 v38, 0xffff0000, v60
    v_add_f32 v35, v35, v38
    v_lshlrev_b32 v38, 16, v61
    v_add_f32 v36, v36, v38
    v_and_b32 v38, 0xffff0000, v61
    v_add_f32 v37, v37, v38
    v_cvt_pk_bf16_f32 v32, v34, v35
    v_cvt_pk_bf16_f32 v33, v36, v37
    v_lshlrev_b32 v34, 16, v32
    v_and_b32 v35, 0xffff0000, v32
    v_lshlrev_b32 v36, 16, v33
    v_and_b32 v37, 0xffff0000, v33
    v_lshlrev_b32 v38, 16, v44
    v_add_f32 v34, v34, v38
    v_and_b32 v38, 0xffff0000, v44
    v_add_f32 v35, v35, v38
    v_lshlrev_b32 v38, 16, v45
    v_add_f32 v36, v36, v38
    v_and_b32 v38, 0xffff0000, v45
    v_add_f32 v37, v37, v38
    v_cvt_pk_bf16_f32 v32, v34, v35
    v_cvt_pk_bf16_f32 v33, v36, v37
    buffer_store_dwordx2 v[32:33], v7, s[16:19], s4 offen offset:32
    s_nop 1
    v_cvt_pk_bf16_f32 v32, v156, v157
    v_cvt_pk_bf16_f32 v33, v158, v159
    v_lshlrev_b32 v34, 16, v32
    v_and_b32 v35, 0xffff0000, v32
    v_lshlrev_b32 v36, 16, v33
    v_and_b32 v37, 0xffff0000, v33
    v_lshlrev_b32 v38, 16, v62
    v_add_f32 v34, v34, v38
    v_and_b32 v38, 0xffff0000, v62
    v_add_f32 v35, v35, v38
    v_lshlrev_b32 v38, 16, v63
    v_add_f32 v36, v36, v38
    v_and_b32 v38, 0xffff0000, v63
    v_add_f32 v37, v37, v38
    v_cvt_pk_bf16_f32 v32, v34, v35
    v_cvt_pk_bf16_f32 v33, v36, v37
    v_lshlrev_b32 v34, 16, v32
    v_and_b32 v35, 0xffff0000, v32
    v_lshlrev_b32 v36, 16, v33
    v_and_b32 v37, 0xffff0000, v33
    v_lshlrev_b32 v38, 16, v46
    v_add_f32 v34, v34, v38
    v_and_b32 v38, 0xffff0000, v46
    v_add_f32 v35, v35, v38
    v_lshlrev_b32 v38, 16, v47
    v_add_f32 v36, v36, v38
    v_and_b32 v38, 0xffff0000, v47
    v_add_f32 v37, v37, v38
    v_cvt_pk_bf16_f32 v32, v34, v35
    v_cvt_pk_bf16_f32 v33, v36, v37
    buffer_store_dwordx2 v[32:33], v7, s[16:19], s4 offen offset:48
    s_nop 1
.gemm_w2a_kernel_done:
    s_endpgm
.section .rodata,"a"
.p2align 6
.amdhsa_kernel gemm_w2a_kernel
  .amdhsa_next_free_vgpr 256
  .amdhsa_next_free_sgpr 64
  .amdhsa_accum_offset 256
  .amdhsa_group_segment_fixed_size 0
  .amdhsa_kernarg_size 120
  .amdhsa_user_sgpr_count 2
  .amdhsa_user_sgpr_kernarg_segment_ptr 1
  .amdhsa_system_sgpr_workgroup_id_x 1
.end_amdhsa_kernel
.text
.globl gemm_w2b_kernel
.p2align 8
.type gemm_w2b_kernel,@function
gemm_w2b_kernel:
    s_cmp_ge_u32 s2, 256
    s_cbranch_scc1 .gemm_w2b_kernel_done
    s_load_dwordx2 s[6:7], s[0:1], 112
    s_load_dwordx2 s[28:29], s[0:1], 80
    s_load_dwordx2 s[34:35], s[0:1], 96
    s_load_dwordx2 s[38:39], s[0:1], 88
    s_and_b32 s40, s2, 15
    s_lshr_b32 s41, s2, 4
    s_waitcnt lgkmcnt(0)
    s_add_u32 s4, s6, 0x5000000
    s_addc_u32 s5, s7, 0
    s_mov_b32 s8, s4
    s_and_b32 s9, s5, 0xffff
    s_mov_b32 s10, 0xe00000
    s_mov_b32 s11, 0x00020000
    s_mul_i32 s42, s41, 64
    s_mov_b32 s4, s28
    s_mov_b32 s5, s29
    s_mov_b32 s43, s42
    s_mov_b32 s12, s4
    s_and_b32 s13, s5, 0xffff
    s_mov_b32 s14, 0x700000
    s_mov_b32 s15, 0x00020000
    s_mul_i32 s44, s40, 917504
    s_lshl_b32 s45, s43, 1
    v_and_b32 v1, 63, v0
    v_lshrrev_b32 v2, 6, v0
    s_nop 0
    v_readfirstlane_b32 s46, v2
    v_lshrrev_b32 v3, 3, v1
    v_and_b32 v4, 7, v1
    v_xor_b32 v4, v4, v3
    v_lshlrev_b32 v4, 4, v4
    s_mov_b32 s47, 7168
    v_mul_lo_u32 v3, v3, s47
    v_add_u32 v10, v3, v4
    v_lshrrev_b32 v3, 3, v1
    v_and_b32 v4, 7, v1
    v_lshrrev_b32 v5, 1, v3
    v_and_b32 v5, 1, v5
    v_lshlrev_b32 v5, 2, v5
    v_xor_b32 v4, v4, v5
    v_lshlrev_b32 v4, 4, v4
    s_mov_b32 s47, 2048
    v_mul_lo_u32 v3, v3, s47
    v_add_u32 v11, v3, v4
    s_mul_i32 s48, s46, 229376
    s_add_u32 s44, s44, s48
    s_mul_i32 s48, s46, 32768
    s_add_u32 s45, s45, s48
    s_mul_i32 s49, s46, 4096
    s_mul_i32 s50, s46, 2048
    s_add_u32 s50, s50, 16384
    v_lshrrev_b32 v3, 1, v2
    v_and_b32 v4, 1, v2
    v_and_b32 v5, 31, v1
    v_lshrrev_b32 v6, 5, v1
    v_mul_u32_u24 v7, 64, v3
    v_add_u32 v7, v7, v5
    v_lshlrev_b32 v7, 7, v7
    v_and_b32 v8, 7, v1
    v_xor_b32 v8, v8, v6
    v_lshlrev_b32 v8, 4, v8
    v_add_u32 v12, v7, v8
    v_xor_b32 v13, 32, v12
    v_xor_b32 v14, 64, v12
    v_xor_b32 v15, 96, v12
    v_lshrrev_b32 v7, 4, v1
    v_and_b32 v7, 1, v7
    v_lshrrev_b32 v8, 2, v1
    v_and_b32 v8, 3, v8
    v_and_b32 v9, 3, v1
    v_mul_u32_u24 v16, 4, v4
    v_lshl_add_u32 v16, v7, 1, v16
    v_lshrrev_b32 v17, 1, v9
    v_add_u32 v16, v16, v17
    v_lshrrev_b32 v17, 1, v8
    v_lshlrev_b32 v17, 2, v17
    v_lshl_add_u32 v18, v6, 3, v8
    v_mul_u32_u24 v18, 128, v18
    v_and_b32 v19, 1, v9
    v_lshl_add_u32 v18, v19, 3, v18
    v_add_u32 v18, 16384, v18
    v_add_u32 v19, 0, v16
    v_xor_b32 v19, v19, v17
    v_lshl_add_u32 v20, v19, 4, v18
    v_mov_b32 v128, 0
    v_mov_b32 v129, 0
    v_mov_b32 v130, 0
    v_mov_b32 v131, 0
    v_mov_b32 v132, 0
    v_mov_b32 v133, 0
    v_mov_b32 v134, 0
    v_mov_b32 v135, 0
    v_mov_b32 v136, 0
    v_mov_b32 v137, 0
    v_mov_b32 v138, 0
    v_mov_b32 v139, 0
    v_mov_b32 v140, 0
    v_mov_b32 v141, 0
    v_mov_b32 v142, 0
    v_mov_b32 v143, 0
    v_mov_b32 v144, 0
    v_mov_b32 v145, 0
    v_mov_b32 v146, 0
    v_mov_b32 v147, 0
    v_mov_b32 v148, 0
    v_mov_b32 v149, 0
    v_mov_b32 v150, 0
    v_mov_b32 v151, 0
    v_mov_b32 v152, 0
    v_mov_b32 v153, 0
    v_mov_b32 v154, 0
    v_mov_b32 v155, 0
    v_mov_b32 v156, 0
    v_mov_b32 v157, 0
    v_mov_b32 v158, 0
    v_mov_b32 v159, 0
    s_mov_b32 s51, 0
    s_add_u32 s52, s51, s49
    s_mov_b32 m0, s52
    s_add_u32 s53, s44, 0
    buffer_load_dwordx4 v10, s[8:11], s53 offen lds
    s_add_u32 s52, s51, s49
    s_add_u32 s52, s52, 1024
    s_mov_b32 m0, s52
    s_add_u32 s53, s44, 57344
    buffer_load_dwordx4 v10, s[8:11], s53 offen lds
    s_add_u32 s52, s51, s49
    s_add_u32 s52, s52, 2048
    s_mov_b32 m0, s52
    s_add_u32 s53, s44, 114688
    buffer_load_dwordx4 v10, s[8:11], s53 offen lds
    s_add_u32 s52, s51, s49
    s_add_u32 s52, s52, 3072
    s_mov_b32 m0, s52
    s_add_u32 s53, s44, 172032
    buffer_load_dwordx4 v10, s[8:11], s53 offen lds
    s_add_u32 s52, s51, s50
    s_mov_b32 m0, s52
    s_add_u32 s53, s45, 0
    buffer_load_dwordx4 v11, s[12:15], s53 offen lds
    s_add_u32 s52, s51, s50
    s_add_u32 s52, s52, 1024
    s_mov_b32 m0, s52
    s_add_u32 s53, s45, 16384
    buffer_load_dwordx4 v11, s[12:15], s53 offen lds
    s_add_u32 s44, s44, 128
    s_add_u32 s45, s45, 131072
    s_add_u32 s51, s51, 24576
    s_cmp_eq_u32 s51, 73728
    s_cselect_b32 s51, 0, s51
    s_add_u32 s52, s51, s49
    s_mov_b32 m0, s52
    s_add_u32 s53, s44, 0
    buffer_load_dwordx4 v10, s[8:11], s53 offen lds
    s_add_u32 s52, s51, s49
    s_add_u32 s52, s52, 1024
    s_mov_b32 m0, s52
    s_add_u32 s53, s44, 57344
    buffer_load_dwordx4 v10, s[8:11], s53 offen lds
    s_add_u32 s52, s51, s49
    s_add_u32 s52, s52, 2048
    s_mov_b32 m0, s52
    s_add_u32 s53, s44, 114688
    buffer_load_dwordx4 v10, s[8:11], s53 offen lds
    s_add_u32 s52, s51, s49
    s_add_u32 s52, s52, 3072
    s_mov_b32 m0, s52
    s_add_u32 s53, s44, 172032
    buffer_load_dwordx4 v10, s[8:11], s53 offen lds
    s_add_u32 s52, s51, s50
    s_mov_b32 m0, s52
    s_add_u32 s53, s45, 0
    buffer_load_dwordx4 v11, s[12:15], s53 offen lds
    s_add_u32 s52, s51, s50
    s_add_u32 s52, s52, 1024
    s_mov_b32 m0, s52
    s_add_u32 s53, s45, 16384
    buffer_load_dwordx4 v11, s[12:15], s53 offen lds
    s_add_u32 s44, s44, 128
    s_add_u32 s45, s45, 131072
    s_add_u32 s51, s51, 24576
    s_cmp_eq_u32 s51, 73728
    s_cselect_b32 s51, 0, s51
    s_mov_b32 s54, 0
    s_mov_b32 s55, 0
.gemm_w2b_kernel_loop:
    s_waitcnt vmcnt(6)
    s_barrier
    v_add_u32 v24, s54, v12
    v_add_u32 v25, s54, v13
    v_add_u32 v26, s54, v14
    v_add_u32 v27, s54, v15
    v_add_u32 v28, s54, v20
    ds_read_b128 v[32:35], v24 offset:0
    ds_read_b128 v[36:39], v24 offset:4096
    ds_read_b64_tr_b16 v[48:49], v28 offset:0
    ds_read_b64_tr_b16 v[50:51], v28 offset:512
    ds_read_b128 v[56:59], v25 offset:0
    ds_read_b128 v[60:63], v25 offset:4096
    ds_read_b64_tr_b16 v[72:73], v28 offset:2048
    ds_read_b64_tr_b16 v[74:75], v28 offset:2560
    s_waitcnt lgkmcnt(4)
    v_mfma_f32_32x32x16_bf16 v[128:143], v[48:51], v[32:35], v[128:143]
    s_add_u32 s52, s51, s49
    s_mov_b32 m0, s52
    s_add_u32 s53, s44, 0
    buffer_load_dwordx4 v10, s[8:11], s53 offen lds
    v_mfma_f32_32x32x16_bf16 v[144:159], v[48:51], v[36:39], v[144:159]
    s_add_u32 s52, s51, s49
    s_add_u32 s52, s52, 1024
    s_mov_b32 m0, s52
    s_add_u32 s53, s44, 57344
    buffer_load_dwordx4 v10, s[8:11], s53 offen lds
    ds_read_b128 v[32:35], v26 offset:0
    ds_read_b128 v[36:39], v26 offset:4096
    ds_read_b64_tr_b16 v[48:49], v28 offset:4096
    ds_read_b64_tr_b16 v[50:51], v28 offset:4608
    s_waitcnt lgkmcnt(4)
    v_mfma_f32_32x32x16_bf16 v[128:143], v[72:75], v[56:59], v[128:143]
    s_add_u32 s52, s51, s49
    s_add_u32 s52, s52, 2048
    s_mov_b32 m0, s52
    s_add_u32 s53, s44, 114688
    buffer_load_dwordx4 v10, s[8:11], s53 offen lds
    v_mfma_f32_32x32x16_bf16 v[144:159], v[72:75], v[60:63], v[144:159]
    ds_read_b128 v[56:59], v27 offset:0
    ds_read_b128 v[60:63], v27 offset:4096
    ds_read_b64_tr_b16 v[72:73], v28 offset:6144
    ds_read_b64_tr_b16 v[74:75], v28 offset:6656
    s_waitcnt lgkmcnt(4)
    v_mfma_f32_32x32x16_bf16 v[128:143], v[48:51], v[32:35], v[128:143]
    s_add_u32 s52, s51, s49
    s_add_u32 s52, s52, 3072
    s_mov_b32 m0, s52
    s_add_u32 s53, s44, 172032
    buffer_load_dwordx4 v10, s[8:11], s53 offen lds
    v_mfma_f32_32x32x16_bf16 v[144:159], v[48:51], v[36:39], v[144:159]
    s_add_u32 s52, s51, s50
    s_mov_b32 m0, s52
    s_add_u32 s53, s45, 0
    buffer_load_dwordx4 v11, s[12:15], s53 offen lds
    s_waitcnt lgkmcnt(0)
    v_mfma_f32_32x32x16_bf16 v[128:143], v[72:75], v[56:59], v[128:143]
    s_add_u32 s52, s51, s50
    s_add_u32 s52, s52, 1024
    s_mov_b32 m0, s52
    s_add_u32 s53, s45, 16384
    buffer_load_dwordx4 v11, s[12:15], s53 offen lds
    v_mfma_f32_32x32x16_bf16 v[144:159], v[72:75], v[60:63], v[144:159]
    s_add_u32 s44, s44, 128
    s_add_u32 s45, s45, 131072
    s_add_u32 s51, s51, 24576
    s_cmp_eq_u32 s51, 73728
    s_cselect_b32 s51, 0, s51
    s_add_u32 s54, s54, 24576
    s_cmp_eq_u32 s54, 73728
    s_cselect_b32 s54, 0, s54
    s_add_u32 s55, s55, 1
    s_cmp_lt_u32 s55, 56
    s_cbranch_scc1 .gemm_w2b_kernel_loop
    s_waitcnt vmcnt(0)
    s_nop 15
    s_nop 15
    s_mov_b32 s4, s34
    s_mov_b32 s5, s35
    s_mov_b32 s16, s4
    s_and_b32 s17, s5, 0xffff
    s_mov_b32 s18, 0x400000
    s_mov_b32 s19, 0x00020000
    s_add_u32 s4, s6, 0x400000
    s_addc_u32 s5, s7, 0
    s_mov_b32 s20, s4
    s_and_b32 s21, s5, 0xffff
    s_mov_b32 s22, 0x400000
    s_mov_b32 s23, 0x00020000
    s_mov_b32 s24, s38
    s_and_b32 s25, s39, 0xffff
    s_mov_b32 s26, 0x800
    s_mov_b32 s27, 0x00020000
    s_mul_i32 s4, s40, 128
    v_mul_u32_u24 v7, 64, v3
    v_add_u32 v7, v7, v5
    v_add_u32 v7, s4, v7
    s_mov_b32 s47, 2048
    v_mul_lo_u32 v7, v7, s47
    v_mul_u32_u24 v8, 32, v4
    v_lshl_add_u32 v8, v6, 2, v8
    v_add_u32 v8, s42, v8
    v_lshlrev_b32 v8, 1, v8
    v_add_u32 v7, v7, v8
    buffer_load_dwordx2 v[56:57], v8, s[24:27], 0 offen offset:0
    buffer_load_dwordx2 v[58:59], v8, s[24:27], 0 offen offset:16
    buffer_load_dwordx2 v[60:61], v8, s[24:27], 0 offen offset:32
    buffer_load_dwordx2 v[62:63], v8, s[24:27], 0 offen offset:48
    s_mov_b32 s4, 0
    buffer_load_dwordx2 v[40:41], v7, s[20:23], s4 offen offset:0
    buffer_load_dwordx2 v[42:43], v7, s[20:23], s4 offen offset:16
    buffer_load_dwordx2 v[44:45], v7, s[20:23], s4 offen offset:32
    buffer_load_dwordx2 v[46:47], v7, s[20:23], s4 offen offset:48
    s_waitcnt vmcnt(0)
    v_cvt_pk_bf16_f32 v32, v128, v129
    v_cvt_pk_bf16_f32 v33, v130, v131
    v_lshlrev_b32 v34, 16, v32
    v_and_b32 v35, 0xffff0000, v32
    v_lshlrev_b32 v36, 16, v33
    v_and_b32 v37, 0xffff0000, v33
    v_lshlrev_b32 v38, 16, v56
    v_add_f32 v34, v34, v38
    v_and_b32 v38, 0xffff0000, v56
    v_add_f32 v35, v35, v38
    v_lshlrev_b32 v38, 16, v57
    v_add_f32 v36, v36, v38
    v_and_b32 v38, 0xffff0000, v57
    v_add_f32 v37, v37, v38
    v_cvt_pk_bf16_f32 v32, v34, v35
    v_cvt_pk_bf16_f32 v33, v36, v37
    v_lshlrev_b32 v34, 16, v32
    v_and_b32 v35, 0xffff0000, v32
    v_lshlrev_b32 v36, 16, v33
    v_and_b32 v37, 0xffff0000, v33
    v_lshlrev_b32 v38, 16, v40
    v_add_f32 v34, v34, v38
    v_and_b32 v38, 0xffff0000, v40
    v_add_f32 v35, v35, v38
    v_lshlrev_b32 v38, 16, v41
    v_add_f32 v36, v36, v38
    v_and_b32 v38, 0xffff0000, v41
    v_add_f32 v37, v37, v38
    v_cvt_pk_bf16_f32 v32, v34, v35
    v_cvt_pk_bf16_f32 v33, v36, v37
    buffer_store_dwordx2 v[32:33], v7, s[16:19], s4 offen offset:0
    s_nop 1
    v_cvt_pk_bf16_f32 v32, v132, v133
    v_cvt_pk_bf16_f32 v33, v134, v135
    v_lshlrev_b32 v34, 16, v32
    v_and_b32 v35, 0xffff0000, v32
    v_lshlrev_b32 v36, 16, v33
    v_and_b32 v37, 0xffff0000, v33
    v_lshlrev_b32 v38, 16, v58
    v_add_f32 v34, v34, v38
    v_and_b32 v38, 0xffff0000, v58
    v_add_f32 v35, v35, v38
    v_lshlrev_b32 v38, 16, v59
    v_add_f32 v36, v36, v38
    v_and_b32 v38, 0xffff0000, v59
    v_add_f32 v37, v37, v38
    v_cvt_pk_bf16_f32 v32, v34, v35
    v_cvt_pk_bf16_f32 v33, v36, v37
    v_lshlrev_b32 v34, 16, v32
    v_and_b32 v35, 0xffff0000, v32
    v_lshlrev_b32 v36, 16, v33
    v_and_b32 v37, 0xffff0000, v33
    v_lshlrev_b32 v38, 16, v42
    v_add_f32 v34, v34, v38
    v_and_b32 v38, 0xffff0000, v42
    v_add_f32 v35, v35, v38
    v_lshlrev_b32 v38, 16, v43
    v_add_f32 v36, v36, v38
    v_and_b32 v38, 0xffff0000, v43
    v_add_f32 v37, v37, v38
    v_cvt_pk_bf16_f32 v32, v34, v35
    v_cvt_pk_bf16_f32 v33, v36, v37
    buffer_store_dwordx2 v[32:33], v7, s[16:19], s4 offen offset:16
    s_nop 1
    v_cvt_pk_bf16_f32 v32, v136, v137
    v_cvt_pk_bf16_f32 v33, v138, v139
    v_lshlrev_b32 v34, 16, v32
    v_and_b32 v35, 0xffff0000, v32
    v_lshlrev_b32 v36, 16, v33
    v_and_b32 v37, 0xffff0000, v33
    v_lshlrev_b32 v38, 16, v60
    v_add_f32 v34, v34, v38
    v_and_b32 v38, 0xffff0000, v60
    v_add_f32 v35, v35, v38
    v_lshlrev_b32 v38, 16, v61
    v_add_f32 v36, v36, v38
    v_and_b32 v38, 0xffff0000, v61
    v_add_f32 v37, v37, v38
    v_cvt_pk_bf16_f32 v32, v34, v35
    v_cvt_pk_bf16_f32 v33, v36, v37
    v_lshlrev_b32 v34, 16, v32
    v_and_b32 v35, 0xffff0000, v32
    v_lshlrev_b32 v36, 16, v33
    v_and_b32 v37, 0xffff0000, v33
    v_lshlrev_b32 v38, 16, v44
    v_add_f32 v34, v34, v38
    v_and_b32 v38, 0xffff0000, v44
    v_add_f32 v35, v35, v38
    v_lshlrev_b32 v38, 16, v45
    v_add_f32 v36, v36, v38
    v_and_b32 v38, 0xffff0000, v45
    v_add_f32 v37, v37, v38
    v_cvt_pk_bf16_f32 v32, v34, v35
    v_cvt_pk_bf16_f32 v33, v36, v37
    buffer_store_dwordx2 v[32:33], v7, s[16:19], s4 offen offset:32
    s_nop 1
    v_cvt_pk_bf16_f32 v32, v140, v141
    v_cvt_pk_bf16_f32 v33, v142, v143
    v_lshlrev_b32 v34, 16, v32
    v_and_b32 v35, 0xffff0000, v32
    v_lshlrev_b32 v36, 16, v33
    v_and_b32 v37, 0xffff0000, v33
    v_lshlrev_b32 v38, 16, v62
    v_add_f32 v34, v34, v38
    v_and_b32 v38, 0xffff0000, v62
    v_add_f32 v35, v35, v38
    v_lshlrev_b32 v38, 16, v63
    v_add_f32 v36, v36, v38
    v_and_b32 v38, 0xffff0000, v63
    v_add_f32 v37, v37, v38
    v_cvt_pk_bf16_f32 v32, v34, v35
    v_cvt_pk_bf16_f32 v33, v36, v37
    v_lshlrev_b32 v34, 16, v32
    v_and_b32 v35, 0xffff0000, v32
    v_lshlrev_b32 v36, 16, v33
    v_and_b32 v37, 0xffff0000, v33
    v_lshlrev_b32 v38, 16, v46
    v_add_f32 v34, v34, v38
    v_and_b32 v38, 0xffff0000, v46
    v_add_f32 v35, v35, v38
    v_lshlrev_b32 v38, 16, v47
    v_add_f32 v36, v36, v38
    v_and_b32 v38, 0xffff0000, v47
    v_add_f32 v37, v37, v38
    v_cvt_pk_bf16_f32 v32, v34, v35
    v_cvt_pk_bf16_f32 v33, v36, v37
    buffer_store_dwordx2 v[32:33], v7, s[16:19], s4 offen offset:48
    s_nop 1
    s_mov_b32 s4, 65536
    buffer_load_dwordx2 v[40:41], v7, s[20:23], s4 offen offset:0
    buffer_load_dwordx2 v[42:43], v7, s[20:23], s4 offen offset:16
    buffer_load_dwordx2 v[44:45], v7, s[20:23], s4 offen offset:32
    buffer_load_dwordx2 v[46:47], v7, s[20:23], s4 offen offset:48
    s_waitcnt vmcnt(0)
    v_cvt_pk_bf16_f32 v32, v144, v145
    v_cvt_pk_bf16_f32 v33, v146, v147
    v_lshlrev_b32 v34, 16, v32
    v_and_b32 v35, 0xffff0000, v32
    v_lshlrev_b32 v36, 16, v33
    v_and_b32 v37, 0xffff0000, v33
    v_lshlrev_b32 v38, 16, v56
    v_add_f32 v34, v34, v38
    v_and_b32 v38, 0xffff0000, v56
    v_add_f32 v35, v35, v38
    v_lshlrev_b32 v38, 16, v57
    v_add_f32 v36, v36, v38
    v_and_b32 v38, 0xffff0000, v57
    v_add_f32 v37, v37, v38
    v_cvt_pk_bf16_f32 v32, v34, v35
    v_cvt_pk_bf16_f32 v33, v36, v37
    v_lshlrev_b32 v34, 16, v32
    v_and_b32 v35, 0xffff0000, v32
    v_lshlrev_b32 v36, 16, v33
    v_and_b32 v37, 0xffff0000, v33
    v_lshlrev_b32 v38, 16, v40
    v_add_f32 v34, v34, v38
    v_and_b32 v38, 0xffff0000, v40
    v_add_f32 v35, v35, v38
    v_lshlrev_b32 v38, 16, v41
    v_add_f32 v36, v36, v38
    v_and_b32 v38, 0xffff0000, v41
    v_add_f32 v37, v37, v38
    v_cvt_pk_bf16_f32 v32, v34, v35
    v_cvt_pk_bf16_f32 v33, v36, v37
    buffer_store_dwordx2 v[32:33], v7, s[16:19], s4 offen offset:0
    s_nop 1
    v_cvt_pk_bf16_f32 v32, v148, v149
    v_cvt_pk_bf16_f32 v33, v150, v151
    v_lshlrev_b32 v34, 16, v32
    v_and_b32 v35, 0xffff0000, v32
    v_lshlrev_b32 v36, 16, v33
    v_and_b32 v37, 0xffff0000, v33
    v_lshlrev_b32 v38, 16, v58
    v_add_f32 v34, v34, v38
    v_and_b32 v38, 0xffff0000, v58
    v_add_f32 v35, v35, v38
    v_lshlrev_b32 v38, 16, v59
    v_add_f32 v36, v36, v38
    v_and_b32 v38, 0xffff0000, v59
    v_add_f32 v37, v37, v38
    v_cvt_pk_bf16_f32 v32, v34, v35
    v_cvt_pk_bf16_f32 v33, v36, v37
    v_lshlrev_b32 v34, 16, v32
    v_and_b32 v35, 0xffff0000, v32
    v_lshlrev_b32 v36, 16, v33
    v_and_b32 v37, 0xffff0000, v33
    v_lshlrev_b32 v38, 16, v42
    v_add_f32 v34, v34, v38
    v_and_b32 v38, 0xffff0000, v42
    v_add_f32 v35, v35, v38
    v_lshlrev_b32 v38, 16, v43
    v_add_f32 v36, v36, v38
    v_and_b32 v38, 0xffff0000, v43
    v_add_f32 v37, v37, v38
    v_cvt_pk_bf16_f32 v32, v34, v35
    v_cvt_pk_bf16_f32 v33, v36, v37
    buffer_store_dwordx2 v[32:33], v7, s[16:19], s4 offen offset:16
    s_nop 1
    v_cvt_pk_bf16_f32 v32, v152, v153
    v_cvt_pk_bf16_f32 v33, v154, v155
    v_lshlrev_b32 v34, 16, v32
    v_and_b32 v35, 0xffff0000, v32
    v_lshlrev_b32 v36, 16, v33
    v_and_b32 v37, 0xffff0000, v33
    v_lshlrev_b32 v38, 16, v60
    v_add_f32 v34, v34, v38
    v_and_b32 v38, 0xffff0000, v60
    v_add_f32 v35, v35, v38
    v_lshlrev_b32 v38, 16, v61
    v_add_f32 v36, v36, v38
    v_and_b32 v38, 0xffff0000, v61
    v_add_f32 v37, v37, v38
    v_cvt_pk_bf16_f32 v32, v34, v35
    v_cvt_pk_bf16_f32 v33, v36, v37
    v_lshlrev_b32 v34, 16, v32
    v_and_b32 v35, 0xffff0000, v32
    v_lshlrev_b32 v36, 16, v33
    v_and_b32 v37, 0xffff0000, v33
    v_lshlrev_b32 v38, 16, v44
    v_add_f32 v34, v34, v38
    v_and_b32 v38, 0xffff0000, v44
    v_add_f32 v35, v35, v38
    v_lshlrev_b32 v38, 16, v45
    v_add_f32 v36, v36, v38
    v_and_b32 v38, 0xffff0000, v45
    v_add_f32 v37, v37, v38
    v_cvt_pk_bf16_f32 v32, v34, v35
    v_cvt_pk_bf16_f32 v33, v36, v37
    buffer_store_dwordx2 v[32:33], v7, s[16:19], s4 offen offset:32
    s_nop 1
    v_cvt_pk_bf16_f32 v32, v156, v157
    v_cvt_pk_bf16_f32 v33, v158, v159
    v_lshlrev_b32 v34, 16, v32
    v_and_b32 v35, 0xffff0000, v32
    v_lshlrev_b32 v36, 16, v33
    v_and_b32 v37, 0xffff0000, v33
    v_lshlrev_b32 v38, 16, v62
    v_add_f32 v34, v34, v38
    v_and_b32 v38, 0xffff0000, v62
    v_add_f32 v35, v35, v38
    v_lshlrev_b32 v38, 16, v63
    v_add_f32 v36, v36, v38
    v_and_b32 v38, 0xffff0000, v63
    v_add_f32 v37, v37, v38
    v_cvt_pk_bf16_f32 v32, v34, v35
    v_cvt_pk_bf16_f32 v33, v36, v37
    v_lshlrev_b32 v34, 16, v32
    v_and_b32 v35, 0xffff0000, v32
    v_lshlrev_b32 v36, 16, v33
    v_and_b32 v37, 0xffff0000, v33
    v_lshlrev_b32 v38, 16, v46
    v_add_f32 v34, v34, v38
    v_and_b32 v38, 0xffff0000, v46
    v_add_f32 v35, v35, v38
    v_lshlrev_b32 v38, 16, v47
    v_add_f32 v36, v36, v38
    v_and_b32 v38, 0xffff0000, v47
    v_add_f32 v37, v37, v38
    v_cvt_pk_bf16_f32 v32, v34, v35
    v_cvt_pk_bf16_f32 v33, v36, v37
    buffer_store_dwordx2 v[32:33], v7, s[16:19], s4 offen offset:48
    s_nop 1
.gemm_w2b_kernel_done:
    s_endpgm
.section .rodata,"a"
.p2align 6
.amdhsa_kernel gemm_w2b_kernel
  .amdhsa_next_free_vgpr 256
  .amdhsa_next_free_sgpr 64
  .amdhsa_accum_offset 256
  .amdhsa_group_segment_fixed_size 0
  .amdhsa_kernarg_size 120
  .amdhsa_user_sgpr_count 2
  .amdhsa_user_sgpr_kernarg_segment_ptr 1
  .amdhsa_system_sgpr_workgroup_id_x 1
.end_amdhsa_kernel
.text
.globl chain0_kernel
.p2align 8
.type chain0_kernel,@function
chain0_kernel:
    s_cmp_ge_u32 s2, 256
    s_cbranch_scc1 .chain0_kernel_done
    s_load_dwordx2 s[4:5], s[0:1], 112
    s_load_dwordx4 s[48:51], s[0:1], 16
    s_load_dwordx4 s[52:55], s[0:1], 32
    s_load_dwordx2 s[56:57], s[0:1], 8
    s_load_dwordx2 s[26:27], s[0:1], 104
    v_and_b32 v1, 63, v0
    v_lshrrev_b32 v2, 6, v0
    v_and_b32 v3, 15, v1
    v_lshrrev_b32 v4, 4, v1
    s_nop 0
    v_readfirstlane_b32 s69, v2
    s_waitcnt lgkmcnt(0)
    s_mov_b32 s8, s26
    s_and_b32 s9, s27, 0xffff
    s_mov_b32 s10, 0x100
    s_mov_b32 s11, 0x00020000
    s_getreg_b32 s28, hwreg(HW_REG_XCC_ID)
    s_and_b32 s28, s28, 7
    v_mov_b32 v8, 0
    s_cmp_eq_u32 s69, 0
    s_cbranch_scc0 .r1_2
    v_mov_b32 v9, 1
    s_lshl_b32 s29, s28, 2
    v_mov_b32 v10, s29
    v_cmp_eq_u32 vcc, 0, v1
    s_and_saveexec_b64 s[42:43], vcc
    buffer_atomic_add v9, v10, s[8:11], 0 offen sc0 sc1
    s_waitcnt vmcnt(0)
    s_mov_b64 exec, s[42:43]
    v_mov_b32 v11, 0
    v_cmp_eq_u32 vcc, 0, v1
    s_and_saveexec_b64 s[42:43], vcc
    ds_write_b32 v11, v9 offset:16512
    s_mov_b64 exec, s[42:43]
    s_waitcnt lgkmcnt(0)
.r1_2:
    s_barrier
    v_mov_b32 v11, 0
    ds_read_b32 v9, v11 offset:16512
    s_waitcnt lgkmcnt(0)
    v_readfirstlane_b32 s29, v9
    v_and_b32 v10, 7, v1
    v_lshlrev_b32 v10, 2, v10
    s_mov_b32 s30, 0
.rw_3:
    buffer_load_dword v9, v10, s[8:11], 0 offen sc0 sc1
    s_waitcnt vmcnt(0)
    v_mov_b32 v12, v9
    ds_swizzle_b32 v13, v12 offset:0x41f
    s_waitcnt lgkmcnt(0)
    v_add_u32 v12, v12, v13
    ds_swizzle_b32 v13, v12 offset:0x81f
    s_waitcnt lgkmcnt(0)
    v_add_u32 v12, v12, v13
    ds_swizzle_b32 v13, v12 offset:0x101f
    s_waitcnt lgkmcnt(0)
    v_add_u32 v12, v12, v13
    s_nop 0
    v_readfirstlane_b32 s31, v12
    s_cmp_eq_u32 s31, 256
    s_cbranch_scc1 .rwo_4
    s_add_u32 s30, s30, 1
    s_cmp_lt_u32 s30, 0x40000
    s_cbranch_scc1 .rw_3
.rwo_4:
    v_cmp_eq_u32 vcc, 32, v9
    s_cmp_eq_u64 vcc, exec
    s_cselect_b32 s68, 1, 0
    s_lshl_b32 s31, s28, 5
    s_add_u32 s31, s31, s29
    s_cmp_eq_u32 s68, 1
    s_cselect_b32 s25, s31, s2
    s_and_b32 s25, s25, 255
    s_lshr_b32 s24, s25, 5
    s_and_b32 s23, s25, 31
    s_lshr_b32 s58, s25, 3
    s_and_b32 s59, s25, 7
    s_lshl_b32 s22, s24, 2
    s_add_u32 s22, s22, s69
    s_barrier
    s_lshl_b32 s60, s58, 7
    s_lshl_b32 s61, s59, 4
    s_add_u32 s60, s60, s61
    v_add_u32 v5, s60, v3
    v_lshlrev_b32 v5, 1, v5
    v_lshlrev_b32 v6, 8, v2
    v_lshl_add_u32 v6, v4, 3, v6
    v_lshlrev_b32 v6, 13, v6
    v_add_u32 v5, v5, v6
    s_mov_b32 s8, s48
    s_and_b32 s9, s49, 0xffff
    s_mov_b32 s10, 0x800000
    s_mov_b32 s11, 0x00020000
    s_mov_b32 s3, 0
    buffer_load_ushort v16, v5, s[8:11], s3 offen
    s_mov_b32 s3, 8192
    buffer_load_ushort v17, v5, s[8:11], s3 offen
    s_mov_b32 s3, 16384
    buffer_load_ushort v18, v5, s[8:11], s3 offen
    s_mov_b32 s3, 24576
    buffer_load_ushort v19, v5, s[8:11], s3 offen
    s_mov_b32 s3, 32768
    buffer_load_ushort v20, v5, s[8:11], s3 offen
    s_mov_b32 s3, 40960
    buffer_load_ushort v21, v5, s[8:11], s3 offen
    s_mov_b32 s3, 49152
    buffer_load_ushort v22, v5, s[8:11], s3 offen
    s_mov_b32 s3, 57344
    buffer_load_ushort v23, v5, s[8:11], s3 offen
    s_mov_b32 s3, 262144
    buffer_load_ushort v24, v5, s[8:11], s3 offen
    s_mov_b32 s3, 270336
    buffer_load_ushort v25, v5, s[8:11], s3 offen
    s_mov_b32 s3, 278528
    buffer_load_ushort v26, v5, s[8:11], s3 offen
    s_mov_b32 s3, 286720
    buffer_load_ushort v27, v5, s[8:11], s3 offen
    s_mov_b32 s3, 294912
    buffer_load_ushort v28, v5, s[8:11], s3 offen
    s_mov_b32 s3, 303104
    buffer_load_ushort v29, v5, s[8:11], s3 offen
    s_mov_b32 s3, 311296
    buffer_load_ushort v30, v5, s[8:11], s3 offen
    s_mov_b32 s3, 319488
    buffer_load_ushort v31, v5, s[8:11], s3 offen
    s_mov_b32 s3, 524288
    buffer_load_ushort v32, v5, s[8:11], s3 offen
    s_mov_b32 s3, 532480
    buffer_load_ushort v33, v5, s[8:11], s3 offen
    s_mov_b32 s3, 540672
    buffer_load_ushort v34, v5, s[8:11], s3 offen
    s_mov_b32 s3, 548864
    buffer_load_ushort v35, v5, s[8:11], s3 offen
    s_mov_b32 s3, 557056
    buffer_load_ushort v36, v5, s[8:11], s3 offen
    s_mov_b32 s3, 565248
    buffer_load_ushort v37, v5, s[8:11], s3 offen
    s_mov_b32 s3, 573440
    buffer_load_ushort v38, v5, s[8:11], s3 offen
    s_mov_b32 s3, 581632
    buffer_load_ushort v39, v5, s[8:11], s3 offen
    s_mov_b32 s3, 786432
    buffer_load_ushort v40, v5, s[8:11], s3 offen
    s_mov_b32 s3, 794624
    buffer_load_ushort v41, v5, s[8:11], s3 offen
    s_mov_b32 s3, 802816
    buffer_load_ushort v42, v5, s[8:11], s3 offen
    s_mov_b32 s3, 811008
    buffer_load_ushort v43, v5, s[8:11], s3 offen
    s_mov_b32 s3, 819200
    buffer_load_ushort v44, v5, s[8:11], s3 offen
    s_mov_b32 s3, 827392
    buffer_load_ushort v45, v5, s[8:11], s3 offen
    s_mov_b32 s3, 835584
    buffer_load_ushort v46, v5, s[8:11], s3 offen
    s_mov_b32 s3, 843776
    buffer_load_ushort v47, v5, s[8:11], s3 offen
    s_mov_b32 s3, 1048576
    buffer_load_ushort v48, v5, s[8:11], s3 offen
    s_mov_b32 s3, 1056768
    buffer_load_ushort v49, v5, s[8:11], s3 offen
    s_mov_b32 s3, 1064960
    buffer_load_ushort v50, v5, s[8:11], s3 offen
    s_mov_b32 s3, 1073152
    buffer_load_ushort v51, v5, s[8:11], s3 offen
    s_mov_b32 s3, 1081344
    buffer_load_ushort v52, v5, s[8:11], s3 offen
    s_mov_b32 s3, 1089536
    buffer_load_ushort v53, v5, s[8:11], s3 offen
    s_mov_b32 s3, 1097728
    buffer_load_ushort v54, v5, s[8:11], s3 offen
    s_mov_b32 s3, 1105920
    buffer_load_ushort v55, v5, s[8:11], s3 offen
    s_mov_b32 s3, 1310720
    buffer_load_ushort v56, v5, s[8:11], s3 offen
    s_mov_b32 s3, 1318912
    buffer_load_ushort v57, v5, s[8:11], s3 offen
    s_mov_b32 s3, 1327104
    buffer_load_ushort v58, v5, s[8:11], s3 offen
    s_mov_b32 s3, 1335296
    buffer_load_ushort v59, v5, s[8:11], s3 offen
    s_mov_b32 s3, 1343488
    buffer_load_ushort v60, v5, s[8:11], s3 offen
    s_mov_b32 s3, 1351680
    buffer_load_ushort v61, v5, s[8:11], s3 offen
    s_mov_b32 s3, 1359872
    buffer_load_ushort v62, v5, s[8:11], s3 offen
    s_mov_b32 s3, 1368064
    buffer_load_ushort v63, v5, s[8:11], s3 offen
    s_mov_b32 s3, 1572864
    buffer_load_ushort v64, v5, s[8:11], s3 offen
    s_mov_b32 s3, 1581056
    buffer_load_ushort v65, v5, s[8:11], s3 offen
    s_mov_b32 s3, 1589248
    buffer_load_ushort v66, v5, s[8:11], s3 offen
    s_mov_b32 s3, 1597440
    buffer_load_ushort v67, v5, s[8:11], s3 offen
    s_mov_b32 s3, 1605632
    buffer_load_ushort v68, v5, s[8:11], s3 offen
    s_mov_b32 s3, 1613824
    buffer_load_ushort v69, v5, s[8:11], s3 offen
    s_mov_b32 s3, 1622016
    buffer_load_ushort v70, v5, s[8:11], s3 offen
    s_mov_b32 s3, 1630208
    buffer_load_ushort v71, v5, s[8:11], s3 offen
    s_mov_b32 s3, 1835008
    buffer_load_ushort v72, v5, s[8:11], s3 offen
    s_mov_b32 s3, 1843200
    buffer_load_ushort v73, v5, s[8:11], s3 offen
    s_mov_b32 s3, 1851392
    buffer_load_ushort v74, v5, s[8:11], s3 offen
    s_mov_b32 s3, 1859584
    buffer_load_ushort v75, v5, s[8:11], s3 offen
    s_mov_b32 s3, 1867776
    buffer_load_ushort v76, v5, s[8:11], s3 offen
    s_mov_b32 s3, 1875968
    buffer_load_ushort v77, v5, s[8:11], s3 offen
    s_mov_b32 s3, 1884160
    buffer_load_ushort v78, v5, s[8:11], s3 offen
    s_mov_b32 s3, 1892352
    buffer_load_ushort v79, v5, s[8:11], s3 offen
    s_waitcnt vmcnt(0)
    v_lshl_or_b32 v128, v17, 16, v16
    v_lshl_or_b32 v129, v19, 16, v18
    v_lshl_or_b32 v130, v21, 16, v20
    v_lshl_or_b32 v131, v23, 16, v22
    v_lshl_or_b32 v132, v25, 16, v24
    v_lshl_or_b32 v133, v27, 16, v26
    v_lshl_or_b32 v134, v29, 16, v28
    v_lshl_or_b32 v135, v31, 16, v30
    v_lshl_or_b32 v136, v33, 16, v32
    v_lshl_or_b32 v137, v35, 16, v34
    v_lshl_or_b32 v138, v37, 16, v36
    v_lshl_or_b32 v139, v39, 16, v38
    v_lshl_or_b32 v140, v41, 16, v40
    v_lshl_or_b32 v141, v43, 16, v42
    v_lshl_or_b32 v142, v45, 16, v44
    v_lshl_or_b32 v143, v47, 16, v46
    v_lshl_or_b32 v144, v49, 16, v48
    v_lshl_or_b32 v145, v51, 16, v50
    v_lshl_or_b32 v146, v53, 16, v52
    v_lshl_or_b32 v147, v55, 16, v54
    v_lshl_or_b32 v148, v57, 16, v56
    v_lshl_or_b32 v149, v59, 16, v58
    v_lshl_or_b32 v150, v61, 16, v60
    v_lshl_or_b32 v151, v63, 16, v62
    v_lshl_or_b32 v152, v65, 16, v64
    v_lshl_or_b32 v153, v67, 16, v66
    v_lshl_or_b32 v154, v69, 16, v68
    v_lshl_or_b32 v155, v71, 16, v70
    v_lshl_or_b32 v156, v73, 16, v72
    v_lshl_or_b32 v157, v75, 16, v74
    v_lshl_or_b32 v158, v77, 16, v76
    v_lshl_or_b32 v159, v79, 16, v78
    s_mov_b32 s8, s50
    s_and_b32 s9, s51, 0xffff
    s_mov_b32 s10, 0x800000
    s_mov_b32 s11, 0x00020000
    s_mov_b32 s3, 0
    buffer_load_ushort v16, v5, s[8:11], s3 offen
    s_mov_b32 s3, 8192
    buffer_load_ushort v17, v5, s[8:11], s3 offen
    s_mov_b32 s3, 16384
    buffer_load_ushort v18, v5, s[8:11], s3 offen
    s_mov_b32 s3, 24576
    buffer_load_ushort v19, v5, s[8:11], s3 offen
    s_mov_b32 s3, 32768
    buffer_load_ushort v20, v5, s[8:11], s3 offen
    s_mov_b32 s3, 40960
    buffer_load_ushort v21, v5, s[8:11], s3 offen
    s_mov_b32 s3, 49152
    buffer_load_ushort v22, v5, s[8:11], s3 offen
    s_mov_b32 s3, 57344
    buffer_load_ushort v23, v5, s[8:11], s3 offen
    s_mov_b32 s3, 262144
    buffer_load_ushort v24, v5, s[8:11], s3 offen
    s_mov_b32 s3, 270336
    buffer_load_ushort v25, v5, s[8:11], s3 offen
    s_mov_b32 s3, 278528
    buffer_load_ushort v26, v5, s[8:11], s3 offen
    s_mov_b32 s3, 286720
    buffer_load_ushort v27, v5, s[8:11], s3 offen
    s_mov_b32 s3, 294912
    buffer_load_ushort v28, v5, s[8:11], s3 offen
    s_mov_b32 s3, 303104
    buffer_load_ushort v29, v5, s[8:11], s3 offen
    s_mov_b32 s3, 311296
    buffer_load_ushort v30, v5, s[8:11], s3 offen
    s_mov_b32 s3, 319488
    buffer_load_ushort v31, v5, s[8:11], s3 offen
    s_mov_b32 s3, 524288
    buffer_load_ushort v32, v5, s[8:11], s3 offen
    s_mov_b32 s3, 532480
    buffer_load_ushort v33, v5, s[8:11], s3 offen
    s_mov_b32 s3, 540672
    buffer_load_ushort v34, v5, s[8:11], s3 offen
    s_mov_b32 s3, 548864
    buffer_load_ushort v35, v5, s[8:11], s3 offen
    s_mov_b32 s3, 557056
    buffer_load_ushort v36, v5, s[8:11], s3 offen
    s_mov_b32 s3, 565248
    buffer_load_ushort v37, v5, s[8:11], s3 offen
    s_mov_b32 s3, 573440
    buffer_load_ushort v38, v5, s[8:11], s3 offen
    s_mov_b32 s3, 581632
    buffer_load_ushort v39, v5, s[8:11], s3 offen
    s_mov_b32 s3, 786432
    buffer_load_ushort v40, v5, s[8:11], s3 offen
    s_mov_b32 s3, 794624
    buffer_load_ushort v41, v5, s[8:11], s3 offen
    s_mov_b32 s3, 802816
    buffer_load_ushort v42, v5, s[8:11], s3 offen
    s_mov_b32 s3, 811008
    buffer_load_ushort v43, v5, s[8:11], s3 offen
    s_mov_b32 s3, 819200
    buffer_load_ushort v44, v5, s[8:11], s3 offen
    s_mov_b32 s3, 827392
    buffer_load_ushort v45, v5, s[8:11], s3 offen
    s_mov_b32 s3, 835584
    buffer_load_ushort v46, v5, s[8:11], s3 offen
    s_mov_b32 s3, 843776
    buffer_load_ushort v47, v5, s[8:11], s3 offen
    s_mov_b32 s3, 1048576
    buffer_load_ushort v48, v5, s[8:11], s3 offen
    s_mov_b32 s3, 1056768
    buffer_load_ushort v49, v5, s[8:11], s3 offen
    s_mov_b32 s3, 1064960
    buffer_load_ushort v50, v5, s[8:11], s3 offen
    s_mov_b32 s3, 1073152
    buffer_load_ushort v51, v5, s[8:11], s3 offen
    s_mov_b32 s3, 1081344
    buffer_load_ushort v52, v5, s[8:11], s3 offen
    s_mov_b32 s3, 1089536
    buffer_load_ushort v53, v5, s[8:11], s3 offen
    s_mov_b32 s3, 1097728
    buffer_load_ushort v54, v5, s[8:11], s3 offen
    s_mov_b32 s3, 1105920
    buffer_load_ushort v55, v5, s[8:11], s3 offen
    s_mov_b32 s3, 1310720
    buffer_load_ushort v56, v5, s[8:11], s3 offen
    s_mov_b32 s3, 1318912
    buffer_load_ushort v57, v5, s[8:11], s3 offen
    s_mov_b32 s3, 1327104
    buffer_load_ushort v58, v5, s[8:11], s3 offen
    s_mov_b32 s3, 1335296
    buffer_load_ushort v59, v5, s[8:11], s3 offen
    s_mov_b32 s3, 1343488
    buffer_load_ushort v60, v5, s[8:11], s3 offen
    s_mov_b32 s3, 1351680
    buffer_load_ushort v61, v5, s[8:11], s3 offen
    s_mov_b32 s3, 1359872
    buffer_load_ushort v62, v5, s[8:11], s3 offen
    s_mov_b32 s3, 1368064
    buffer_load_ushort v63, v5, s[8:11], s3 offen
    s_mov_b32 s3, 1572864
    buffer_load_ushort v64, v5, s[8:11], s3 offen
    s_mov_b32 s3, 1581056
    buffer_load_ushort v65, v5, s[8:11], s3 offen
    s_mov_b32 s3, 1589248
    buffer_load_ushort v66, v5, s[8:11], s3 offen
    s_mov_b32 s3, 1597440
    buffer_load_ushort v67, v5, s[8:11], s3 offen
    s_mov_b32 s3, 1605632
    buffer_load_ushort v68, v5, s[8:11], s3 offen
    s_mov_b32 s3, 1613824
    buffer_load_ushort v69, v5, s[8:11], s3 offen
    s_mov_b32 s3, 1622016
    buffer_load_ushort v70, v5, s[8:11], s3 offen
    s_mov_b32 s3, 1630208
    buffer_load_ushort v71, v5, s[8:11], s3 offen
    s_mov_b32 s3, 1835008
    buffer_load_ushort v72, v5, s[8:11], s3 offen
    s_mov_b32 s3, 1843200
    buffer_load_ushort v73, v5, s[8:11], s3 offen
    s_mov_b32 s3, 1851392
    buffer_load_ushort v74, v5, s[8:11], s3 offen
    s_mov_b32 s3, 1859584
    buffer_load_ushort v75, v5, s[8:11], s3 offen
    s_mov_b32 s3, 1867776
    buffer_load_ushort v76, v5, s[8:11], s3 offen
    s_mov_b32 s3, 1875968
    buffer_load_ushort v77, v5, s[8:11], s3 offen
    s_mov_b32 s3, 1884160
    buffer_load_ushort v78, v5, s[8:11], s3 offen
    s_mov_b32 s3, 1892352
    buffer_load_ushort v79, v5, s[8:11], s3 offen
    s_waitcnt vmcnt(0)
    v_lshl_or_b32 v160, v17, 16, v16
    v_lshl_or_b32 v161, v19, 16, v18
    v_lshl_or_b32 v162, v21, 16, v20
    v_lshl_or_b32 v163, v23, 16, v22
    v_lshl_or_b32 v164, v25, 16, v24
    v_lshl_or_b32 v165, v27, 16, v26
    v_lshl_or_b32 v166, v29, 16, v28
    v_lshl_or_b32 v167, v31, 16, v30
    v_lshl_or_b32 v168, v33, 16, v32
    v_lshl_or_b32 v169, v35, 16, v34
    v_lshl_or_b32 v170, v37, 16, v36
    v_lshl_or_b32 v171, v39, 16, v38
    v_lshl_or_b32 v172, v41, 16, v40
    v_lshl_or_b32 v173, v43, 16, v42
    v_lshl_or_b32 v174, v45, 16, v44
    v_lshl_or_b32 v175, v47, 16, v46
    v_lshl_or_b32 v176, v49, 16, v48
    v_lshl_or_b32 v177, v51, 16, v50
    v_lshl_or_b32 v178, v53, 16, v52
    v_lshl_or_b32 v179, v55, 16, v54
    v_lshl_or_b32 v180, v57, 16, v56
    v_lshl_or_b32 v181, v59, 16, v58
    v_lshl_or_b32 v182, v61, 16, v60
    v_lshl_or_b32 v183, v63, 16, v62
    v_lshl_or_b32 v184, v65, 16, v64
    v_lshl_or_b32 v185, v67, 16, v66
    v_lshl_or_b32 v186, v69, 16, v68
    v_lshl_or_b32 v187, v71, 16, v70
    v_lshl_or_b32 v188, v73, 16, v72
    v_lshl_or_b32 v189, v75, 16, v74
    v_lshl_or_b32 v190, v77, 16, v76
    v_lshl_or_b32 v191, v79, 16, v78
    s_mov_b32 s8, s52
    s_and_b32 s9, s53, 0xffff
    s_mov_b32 s10, 0x800000
    s_mov_b32 s11, 0x00020000
    s_mov_b32 s3, 0
    buffer_load_ushort v16, v5, s[8:11], s3 offen
    s_mov_b32 s3, 8192
    buffer_load_ushort v17, v5, s[8:11], s3 offen
    s_mov_b32 s3, 16384
    buffer_load_ushort v18, v5, s[8:11], s3 offen
    s_mov_b32 s3, 24576
    buffer_load_ushort v19, v5, s[8:11], s3 offen
    s_mov_b32 s3, 32768
    buffer_load_ushort v20, v5, s[8:11], s3 offen
    s_mov_b32 s3, 40960
    buffer_load_ushort v21, v5, s[8:11], s3 offen
    s_mov_b32 s3, 49152
    buffer_load_ushort v22, v5, s[8:11], s3 offen
    s_mov_b32 s3, 57344
    buffer_load_ushort v23, v5, s[8:11], s3 offen
    s_mov_b32 s3, 262144
    buffer_load_ushort v24, v5, s[8:11], s3 offen
    s_mov_b32 s3, 270336
    buffer_load_ushort v25, v5, s[8:11], s3 offen
    s_mov_b32 s3, 278528
    buffer_load_ushort v26, v5, s[8:11], s3 offen
    s_mov_b32 s3, 286720
    buffer_load_ushort v27, v5, s[8:11], s3 offen
    s_mov_b32 s3, 294912
    buffer_load_ushort v28, v5, s[8:11], s3 offen
    s_mov_b32 s3, 303104
    buffer_load_ushort v29, v5, s[8:11], s3 offen
    s_mov_b32 s3, 311296
    buffer_load_ushort v30, v5, s[8:11], s3 offen
    s_mov_b32 s3, 319488
    buffer_load_ushort v31, v5, s[8:11], s3 offen
    s_mov_b32 s3, 524288
    buffer_load_ushort v32, v5, s[8:11], s3 offen
    s_mov_b32 s3, 532480
    buffer_load_ushort v33, v5, s[8:11], s3 offen
    s_mov_b32 s3, 540672
    buffer_load_ushort v34, v5, s[8:11], s3 offen
    s_mov_b32 s3, 548864
    buffer_load_ushort v35, v5, s[8:11], s3 offen
    s_mov_b32 s3, 557056
    buffer_load_ushort v36, v5, s[8:11], s3 offen
    s_mov_b32 s3, 565248
    buffer_load_ushort v37, v5, s[8:11], s3 offen
    s_mov_b32 s3, 573440
    buffer_load_ushort v38, v5, s[8:11], s3 offen
    s_mov_b32 s3, 581632
    buffer_load_ushort v39, v5, s[8:11], s3 offen
    s_mov_b32 s3, 786432
    buffer_load_ushort v40, v5, s[8:11], s3 offen
    s_mov_b32 s3, 794624
    buffer_load_ushort v41, v5, s[8:11], s3 offen
    s_mov_b32 s3, 802816
    buffer_load_ushort v42, v5, s[8:11], s3 offen
    s_mov_b32 s3, 811008
    buffer_load_ushort v43, v5, s[8:11], s3 offen
    s_mov_b32 s3, 819200
    buffer_load_ushort v44, v5, s[8:11], s3 offen
    s_mov_b32 s3, 827392
    buffer_load_ushort v45, v5, s[8:11], s3 offen
    s_mov_b32 s3, 835584
    buffer_load_ushort v46, v5, s[8:11], s3 offen
    s_mov_b32 s3, 843776
    buffer_load_ushort v47, v5, s[8:11], s3 offen
    s_mov_b32 s3, 1048576
    buffer_load_ushort v48, v5, s[8:11], s3 offen
    s_mov_b32 s3, 1056768
    buffer_load_ushort v49, v5, s[8:11], s3 offen
    s_mov_b32 s3, 1064960
    buffer_load_ushort v50, v5, s[8:11], s3 offen
    s_mov_b32 s3, 1073152
    buffer_load_ushort v51, v5, s[8:11], s3 offen
    s_mov_b32 s3, 1081344
    buffer_load_ushort v52, v5, s[8:11], s3 offen
    s_mov_b32 s3, 1089536
    buffer_load_ushort v53, v5, s[8:11], s3 offen
    s_mov_b32 s3, 1097728
    buffer_load_ushort v54, v5, s[8:11], s3 offen
    s_mov_b32 s3, 1105920
    buffer_load_ushort v55, v5, s[8:11], s3 offen
    s_mov_b32 s3, 1310720
    buffer_load_ushort v56, v5, s[8:11], s3 offen
    s_mov_b32 s3, 1318912
    buffer_load_ushort v57, v5, s[8:11], s3 offen
    s_mov_b32 s3, 1327104
    buffer_load_ushort v58, v5, s[8:11], s3 offen
    s_mov_b32 s3, 1335296
    buffer_load_ushort v59, v5, s[8:11], s3 offen
    s_mov_b32 s3, 1343488
    buffer_load_ushort v60, v5, s[8:11], s3 offen
    s_mov_b32 s3, 1351680
    buffer_load_ushort v61, v5, s[8:11], s3 offen
    s_mov_b32 s3, 1359872
    buffer_load_ushort v62, v5, s[8:11], s3 offen
    s_mov_b32 s3, 1368064
    buffer_load_ushort v63, v5, s[8:11], s3 offen
    s_mov_b32 s3, 1572864
    buffer_load_ushort v64, v5, s[8:11], s3 offen
    s_mov_b32 s3, 1581056
    buffer_load_ushort v65, v5, s[8:11], s3 offen
    s_mov_b32 s3, 1589248
    buffer_load_ushort v66, v5, s[8:11], s3 offen
    s_mov_b32 s3, 1597440
    buffer_load_ushort v67, v5, s[8:11], s3 offen
    s_mov_b32 s3, 1605632
    buffer_load_ushort v68, v5, s[8:11], s3 offen
    s_mov_b32 s3, 1613824
    buffer_load_ushort v69, v5, s[8:11], s3 offen
    s_mov_b32 s3, 1622016
    buffer_load_ushort v70, v5, s[8:11], s3 offen
    s_mov_b32 s3, 1630208
    buffer_load_ushort v71, v5, s[8:11], s3 offen
    s_mov_b32 s3, 1835008
    buffer_load_ushort v72, v5, s[8:11], s3 offen
    s_mov_b32 s3, 1843200
    buffer_load_ushort v73, v5, s[8:11], s3 offen
    s_mov_b32 s3, 1851392
    buffer_load_ushort v74, v5, s[8:11], s3 offen
    s_mov_b32 s3, 1859584
    buffer_load_ushort v75, v5, s[8:11], s3 offen
    s_mov_b32 s3, 1867776
    buffer_load_ushort v76, v5, s[8:11], s3 offen
    s_mov_b32 s3, 1875968
    buffer_load_ushort v77, v5, s[8:11], s3 offen
    s_mov_b32 s3, 1884160
    buffer_load_ushort v78, v5, s[8:11], s3 offen
    s_mov_b32 s3, 1892352
    buffer_load_ushort v79, v5, s[8:11], s3 offen
    s_waitcnt vmcnt(0)
    v_lshl_or_b32 v192, v17, 16, v16
    v_lshl_or_b32 v193, v19, 16, v18
    v_lshl_or_b32 v194, v21, 16, v20
    v_lshl_or_b32 v195, v23, 16, v22
    v_lshl_or_b32 v196, v25, 16, v24
    v_lshl_or_b32 v197, v27, 16, v26
    v_lshl_or_b32 v198, v29, 16, v28
    v_lshl_or_b32 v199, v31, 16, v30
    v_lshl_or_b32 v200, v33, 16, v32
    v_lshl_or_b32 v201, v35, 16, v34
    v_lshl_or_b32 v202, v37, 16, v36
    v_lshl_or_b32 v203, v39, 16, v38
    v_lshl_or_b32 v204, v41, 16, v40
    v_lshl_or_b32 v205, v43, 16, v42
    v_lshl_or_b32 v206, v45, 16, v44
    v_lshl_or_b32 v207, v47, 16, v46
    v_lshl_or_b32 v208, v49, 16, v48
    v_lshl_or_b32 v209, v51, 16, v50
    v_lshl_or_b32 v210, v53, 16, v52
    v_lshl_or_b32 v211, v55, 16, v54
    v_lshl_or_b32 v212, v57, 16, v56
    v_lshl_or_b32 v213, v59, 16, v58
    v_lshl_or_b32 v214, v61, 16, v60
    v_lshl_or_b32 v215, v63, 16, v62
    v_lshl_or_b32 v216, v65, 16, v64
    v_lshl_or_b32 v217, v67, 16, v66
    v_lshl_or_b32 v218, v69, 16, v68
    v_lshl_or_b32 v219, v71, 16, v70
    v_lshl_or_b32 v220, v73, 16, v72
    v_lshl_or_b32 v221, v75, 16, v74
    v_lshl_or_b32 v222, v77, 16, v76
    v_lshl_or_b32 v223, v79, 16, v78
    s_mov_b32 s8, s54
    s_and_b32 s9, s55, 0xffff
    s_mov_b32 s10, 0x800000
    s_mov_b32 s11, 0x00020000
    s_lshl_b32 s60, s23, 5
    v_add_u32 v5, s60, v3
    v_lshlrev_b32 v5, 1, v5
    s_lshl_b32 s60, s22, 7
    v_lshlrev_b32 v6, 2, v4
    v_add_u32 v6, s60, v6
    v_lshlrev_b32 v6, 11, v6
    v_add_u32 v5, v5, v6
    s_mov_b32 s3, 0
    buffer_load_ushort v16, v5, s[8:11], s3 offen
    s_mov_b32 s3, 2048
    buffer_load_ushort v17, v5, s[8:11], s3 offen
    s_mov_b32 s3, 4096
    buffer_load_ushort v18, v5, s[8:11], s3 offen
    s_mov_b32 s3, 6144
    buffer_load_ushort v19, v5, s[8:11], s3 offen
    s_mov_b32 s3, 32768
    buffer_load_ushort v20, v5, s[8:11], s3 offen
    s_mov_b32 s3, 34816
    buffer_load_ushort v21, v5, s[8:11], s3 offen
    s_mov_b32 s3, 36864
    buffer_load_ushort v22, v5, s[8:11], s3 offen
    s_mov_b32 s3, 38912
    buffer_load_ushort v23, v5, s[8:11], s3 offen
    s_mov_b32 s3, 65536
    buffer_load_ushort v24, v5, s[8:11], s3 offen
    s_mov_b32 s3, 67584
    buffer_load_ushort v25, v5, s[8:11], s3 offen
    s_mov_b32 s3, 69632
    buffer_load_ushort v26, v5, s[8:11], s3 offen
    s_mov_b32 s3, 71680
    buffer_load_ushort v27, v5, s[8:11], s3 offen
    s_mov_b32 s3, 98304
    buffer_load_ushort v28, v5, s[8:11], s3 offen
    s_mov_b32 s3, 100352
    buffer_load_ushort v29, v5, s[8:11], s3 offen
    s_mov_b32 s3, 102400
    buffer_load_ushort v30, v5, s[8:11], s3 offen
    s_mov_b32 s3, 104448
    buffer_load_ushort v31, v5, s[8:11], s3 offen
    s_mov_b32 s3, 131072
    buffer_load_ushort v32, v5, s[8:11], s3 offen
    s_mov_b32 s3, 133120
    buffer_load_ushort v33, v5, s[8:11], s3 offen
    s_mov_b32 s3, 135168
    buffer_load_ushort v34, v5, s[8:11], s3 offen
    s_mov_b32 s3, 137216
    buffer_load_ushort v35, v5, s[8:11], s3 offen
    s_mov_b32 s3, 163840
    buffer_load_ushort v36, v5, s[8:11], s3 offen
    s_mov_b32 s3, 165888
    buffer_load_ushort v37, v5, s[8:11], s3 offen
    s_mov_b32 s3, 167936
    buffer_load_ushort v38, v5, s[8:11], s3 offen
    s_mov_b32 s3, 169984
    buffer_load_ushort v39, v5, s[8:11], s3 offen
    s_mov_b32 s3, 196608
    buffer_load_ushort v40, v5, s[8:11], s3 offen
    s_mov_b32 s3, 198656
    buffer_load_ushort v41, v5, s[8:11], s3 offen
    s_mov_b32 s3, 200704
    buffer_load_ushort v42, v5, s[8:11], s3 offen
    s_mov_b32 s3, 202752
    buffer_load_ushort v43, v5, s[8:11], s3 offen
    s_mov_b32 s3, 229376
    buffer_load_ushort v44, v5, s[8:11], s3 offen
    s_mov_b32 s3, 231424
    buffer_load_ushort v45, v5, s[8:11], s3 offen
    s_mov_b32 s3, 233472
    buffer_load_ushort v46, v5, s[8:11], s3 offen
    s_mov_b32 s3, 235520
    buffer_load_ushort v47, v5, s[8:11], s3 offen
    s_mov_b32 s3, 32
    buffer_load_ushort v48, v5, s[8:11], s3 offen
    s_mov_b32 s3, 2080
    buffer_load_ushort v49, v5, s[8:11], s3 offen
    s_mov_b32 s3, 4128
    buffer_load_ushort v50, v5, s[8:11], s3 offen
    s_mov_b32 s3, 6176
    buffer_load_ushort v51, v5, s[8:11], s3 offen
    s_mov_b32 s3, 32800
    buffer_load_ushort v52, v5, s[8:11], s3 offen
    s_mov_b32 s3, 34848
    buffer_load_ushort v53, v5, s[8:11], s3 offen
    s_mov_b32 s3, 36896
    buffer_load_ushort v54, v5, s[8:11], s3 offen
    s_mov_b32 s3, 38944
    buffer_load_ushort v55, v5, s[8:11], s3 offen
    s_mov_b32 s3, 65568
    buffer_load_ushort v56, v5, s[8:11], s3 offen
    s_mov_b32 s3, 67616
    buffer_load_ushort v57, v5, s[8:11], s3 offen
    s_mov_b32 s3, 69664
    buffer_load_ushort v58, v5, s[8:11], s3 offen
    s_mov_b32 s3, 71712
    buffer_load_ushort v59, v5, s[8:11], s3 offen
    s_mov_b32 s3, 98336
    buffer_load_ushort v60, v5, s[8:11], s3 offen
    s_mov_b32 s3, 100384
    buffer_load_ushort v61, v5, s[8:11], s3 offen
    s_mov_b32 s3, 102432
    buffer_load_ushort v62, v5, s[8:11], s3 offen
    s_mov_b32 s3, 104480
    buffer_load_ushort v63, v5, s[8:11], s3 offen
    s_mov_b32 s3, 131104
    buffer_load_ushort v64, v5, s[8:11], s3 offen
    s_mov_b32 s3, 133152
    buffer_load_ushort v65, v5, s[8:11], s3 offen
    s_mov_b32 s3, 135200
    buffer_load_ushort v66, v5, s[8:11], s3 offen
    s_mov_b32 s3, 137248
    buffer_load_ushort v67, v5, s[8:11], s3 offen
    s_mov_b32 s3, 163872
    buffer_load_ushort v68, v5, s[8:11], s3 offen
    s_mov_b32 s3, 165920
    buffer_load_ushort v69, v5, s[8:11], s3 offen
    s_mov_b32 s3, 167968
    buffer_load_ushort v70, v5, s[8:11], s3 offen
    s_mov_b32 s3, 170016
    buffer_load_ushort v71, v5, s[8:11], s3 offen
    s_mov_b32 s3, 196640
    buffer_load_ushort v72, v5, s[8:11], s3 offen
    s_mov_b32 s3, 198688
    buffer_load_ushort v73, v5, s[8:11], s3 offen
    s_mov_b32 s3, 200736
    buffer_load_ushort v74, v5, s[8:11], s3 offen
    s_mov_b32 s3, 202784
    buffer_load_ushort v75, v5, s[8:11], s3 offen
    s_mov_b32 s3, 229408
    buffer_load_ushort v76, v5, s[8:11], s3 offen
    s_mov_b32 s3, 231456
    buffer_load_ushort v77, v5, s[8:11], s3 offen
    s_mov_b32 s3, 233504
    buffer_load_ushort v78, v5, s[8:11], s3 offen
    s_mov_b32 s3, 235552
    buffer_load_ushort v79, v5, s[8:11], s3 offen
    s_waitcnt vmcnt(0)
    v_lshl_or_b32 v224, v17, 16, v16
    v_lshl_or_b32 v225, v19, 16, v18
    v_lshl_or_b32 v226, v21, 16, v20
    v_lshl_or_b32 v227, v23, 16, v22
    v_lshl_or_b32 v228, v25, 16, v24
    v_lshl_or_b32 v229, v27, 16, v26
    v_lshl_or_b32 v230, v29, 16, v28
    v_lshl_or_b32 v231, v31, 16, v30
    v_lshl_or_b32 v232, v33, 16, v32
    v_lshl_or_b32 v233, v35, 16, v34
    v_lshl_or_b32 v234, v37, 16, v36
    v_lshl_or_b32 v235, v39, 16, v38
    v_lshl_or_b32 v236, v41, 16, v40
    v_lshl_or_b32 v237, v43, 16, v42
    v_lshl_or_b32 v238, v45, 16, v44
    v_lshl_or_b32 v239, v47, 16, v46
    v_lshl_or_b32 v240, v49, 16, v48
    v_lshl_or_b32 v241, v51, 16, v50
    v_lshl_or_b32 v242, v53, 16, v52
    v_lshl_or_b32 v243, v55, 16, v54
    v_lshl_or_b32 v244, v57, 16, v56
    v_lshl_or_b32 v245, v59, 16, v58
    v_lshl_or_b32 v246, v61, 16, v60
    v_lshl_or_b32 v247, v63, 16, v62
    v_lshl_or_b32 v248, v65, 16, v64
    v_lshl_or_b32 v249, v67, 16, v66
    v_lshl_or_b32 v250, v69, 16, v68
    v_lshl_or_b32 v251, v71, 16, v70
    v_lshl_or_b32 v252, v73, 16, v72
    v_lshl_or_b32 v253, v75, 16, v74
    v_lshl_or_b32 v254, v77, 16, v76
    v_lshl_or_b32 v255, v79, 16, v78
    s_add_u32 s60, s4, 0x7000000
    s_addc_u32 s61, s5, 0
    s_mov_b32 s8, s60
    s_and_b32 s9, s61, 0xffff
    s_mov_b32 s10, 0x240000
    s_mov_b32 s11, 0x00020000
    s_add_u32 s60, s4, 0x1000000
    s_addc_u32 s61, s5, 0
    s_mov_b32 s12, s60
    s_and_b32 s13, s61, 0xffff
    s_mov_b32 s14, 0x3000000
    s_mov_b32 s15, 0x00020000
    s_add_u32 s60, s4, 0x6000000
    s_addc_u32 s61, s5, 0
    s_mov_b32 s16, s60
    s_and_b32 s17, s61, 0xffff
    s_mov_b32 s18, 0x800000
    s_mov_b32 s19, 0x00020000
    s_mov_b32 s60, s56
    s_mov_b32 s61, s57
    s_mov_b32 s52, s60
    s_and_b32 s53, s61, 0xffff
    s_mov_b32 s54, 0x4000
    s_mov_b32 s55, 0x00020000
    s_mul_i32 s21, s69, 26624
    s_add_u32 s21, s21, 28928
    v_mov_b32 v8, 0
    v_mov_b32 v9, 0
    v_mov_b32 v10, 0
    v_mov_b32 v11, 0
    v_lshlrev_b32 v12, 4, v1
    v_add_u32 v12, s21, v12
    ds_write_b128 v12, v[8:11] offset:12288
    ds_write_b128 v12, v[8:11] offset:13312
    ds_write_b128 v12, v[8:11] offset:24576
    ds_write_b128 v12, v[8:11] offset:25600
    v_lshlrev_b32 v124, 3, v0
    s_mov_b32 s3, 0
    buffer_load_dwordx2 v[16:17], v124, s[52:55], s3 offen
    s_mov_b32 s3, 2048
    buffer_load_dwordx2 v[18:19], v124, s[52:55], s3 offen
    s_mov_b32 s3, 4096
    buffer_load_dwordx2 v[20:21], v124, s[52:55], s3 offen
    s_mov_b32 s3, 6144
    buffer_load_dwordx2 v[22:23], v124, s[52:55], s3 offen
    s_mov_b32 s3, 8192
    buffer_load_dwordx2 v[24:25], v124, s[52:55], s3 offen
    s_mov_b32 s3, 10240
    buffer_load_dwordx2 v[26:27], v124, s[52:55], s3 offen
    s_mov_b32 s3, 12288
    buffer_load_dwordx2 v[28:29], v124, s[52:55], s3 offen
    s_mov_b32 s3, 14336
    buffer_load_dwordx2 v[30:31], v124, s[52:55], s3 offen
    s_waitcnt vmcnt(0)
    ds_write_b64 v124, v[16:17] offset:0
    ds_write_b64 v124, v[18:19] offset:2064
    ds_write_b64 v124, v[20:21] offset:4128
    ds_write_b64 v124, v[22:23] offset:6192
    ds_write_b64 v124, v[24:25] offset:8256
    ds_write_b64 v124, v[26:27] offset:10320
    ds_write_b64 v124, v[28:29] offset:12384
    ds_write_b64 v124, v[30:31] offset:14448
    v_lshlrev_b32 v110, 4, v0
    v_lshlrev_b32 v109, 4, v1
    v_and_b32 v8, 7, v1
    v_mul_u32_u24 v111, 2064, v8
    v_lshl_add_u32 v111, v2, 9, v111
    v_lshl_add_u32 v111, v4, 4, v111
    v_mul_u32_u24 v112, 3072, v2
    v_lshl_add_u32 v112, v1, 4, v112
    v_add_u32 v112, 16512, v112
    v_lshrrev_b32 v8, 6, v0
    v_bfe_u32 v9, v0, 3, 3
    v_and_b32 v10, 7, v0
    v_lshrrev_b32 v11, 1, v10
    v_lshl_add_u32 v11, v11, 4, v9
    v_lshlrev_b32 v11, 4, v11
    v_and_b32 v12, 1, v10
    v_lshl_add_u32 v11, v12, 3, v11
    v_lshl_add_u32 v113, v8, 10, v11
    v_add_u32 v113, 16512, v113
    s_mul_i32 s60, s58, 3
    v_add_u32 v11, s60, v8
    v_lshl_add_u32 v11, v11, 3, v9
    v_lshlrev_b32 v11, 6, v11
    s_lshl_b32 s60, s59, 3
    v_add_u32 v11, s60, v11
    v_add_u32 v11, v11, v10
    v_lshlrev_b32 v114, 3, v11
    v_subrev_u32 v11, 1, v8
    v_lshl_add_u32 v11, v11, 3, v9
    v_lshlrev_b32 v11, 13, v11
    s_lshl_b32 s60, s58, 8
    s_lshl_b32 s61, s59, 5
    s_add_u32 s60, s60, s61
    v_add_u32 v11, s60, v11
    v_lshl_add_u32 v115, v10, 2, v11
    v_lshrrev_b32 v8, 5, v1
    v_bfe_u32 v9, v1, 1, 4
    v_and_b32 v10, 1, v1
    v_add_u32 v11, 0, v8
    v_xor_b32 v12, v9, v11
    v_lshlrev_b32 v12, 4, v12
    v_lshl_add_u32 v12, v11, 8, v12
    v_lshl_add_u32 v12, v10, 3, v12
    v_add_u32 v100, s21, v12
    v_add_u32 v11, 2, v8
    v_xor_b32 v12, v9, v11
    v_lshlrev_b32 v12, 4, v12
    v_lshl_add_u32 v12, v11, 8, v12
    v_lshl_add_u32 v12, v10, 3, v12
    v_add_u32 v101, s21, v12
    v_add_u32 v11, 4, v8
    v_xor_b32 v12, v9, v11
    v_lshlrev_b32 v12, 4, v12
    v_lshl_add_u32 v12, v11, 8, v12
    v_lshl_add_u32 v12, v10, 3, v12
    v_add_u32 v102, s21, v12
    v_add_u32 v11, 6, v8
    v_xor_b32 v12, v9, v11
    v_lshlrev_b32 v12, 4, v12
    v_lshl_add_u32 v12, v11, 8, v12
    v_lshl_add_u32 v12, v10, 3, v12
    v_add_u32 v103, s21, v12
    s_mov_b32 s60, 24576
    v_mul_lo_u32 v8, v4, s60
    v_xor_b32 v9, v3, v4
    v_lshl_add_u32 v104, v9, 4, v8
    v_xor_b32 v105, 64, v104
    v_xor_b32 v106, 128, v104
    v_xor_b32 v107, 192, v104
    v_add_u32 v8, 0, v4
    v_xor_b32 v8, v8, v3
    v_lshlrev_b32 v8, 4, v8
    v_lshl_add_u32 v8, v3, 8, v8
    v_add_u32 v116, s21, v8
    v_add_u32 v8, 4, v4
    v_xor_b32 v8, v8, v3
    v_lshlrev_b32 v8, 4, v8
    v_lshl_add_u32 v8, v3, 8, v8
    v_add_u32 v117, s21, v8
    v_add_u32 v8, 8, v4
    v_xor_b32 v8, v8, v3
    v_lshlrev_b32 v8, 4, v8
    v_lshl_add_u32 v8, v3, 8, v8
    v_add_u32 v118, s21, v8
    v_add_u32 v8, 12, v4
    v_xor_b32 v8, v8, v3
    v_lshlrev_b32 v8, 4, v8
    v_lshl_add_u32 v8, v3, 8, v8
    v_add_u32 v119, s21, v8
    v_and_b32 v9, 7, v1
    v_add_u32 v8, 0, v4
    v_xor_b32 v8, v8, v9
    v_lshlrev_b32 v8, 4, v8
    v_lshl_add_u32 v8, v9, 8, v8
    v_add_u32 v120, s21, v8
    v_add_u32 v8, 4, v4
    v_xor_b32 v8, v8, v9
    v_lshlrev_b32 v8, 4, v8
    v_lshl_add_u32 v8, v9, 8, v8
    v_add_u32 v121, s21, v8
    v_add_u32 v8, 8, v4
    v_xor_b32 v8, v8, v9
    v_lshlrev_b32 v8, 4, v8
    v_lshl_add_u32 v8, v9, 8, v8
    v_add_u32 v122, s21, v8
    v_add_u32 v8, 12, v4
    v_xor_b32 v8, v8, v9
    v_lshlrev_b32 v8, 4, v8
    v_lshl_add_u32 v8, v9, 8, v8
    v_add_u32 v123, s21, v8
    v_bfe_u32 v8, v1, 2, 2
    v_lshl_add_u32 v8, v4, 2, v8
    v_bfe_u32 v9, v1, 1, 1
    v_xor_b32 v9, v9, v8
    v_lshlrev_b32 v9, 4, v9
    v_lshl_add_u32 v9, v8, 8, v9
    v_and_b32 v10, 1, v1
    v_lshl_add_u32 v9, v10, 3, v9
    v_add_u32 v108, s21, v9
    v_lshlrev_b32 v97, 11, v2
    v_lshl_add_u32 v97, v1, 4, v97
    v_add_u32 v97, 16512, v97
    v_lshrrev_b32 v8, 5, v0
    v_bfe_u32 v9, v0, 4, 1
    v_bfe_u32 v10, v0, 2, 2
    v_and_b32 v11, 3, v0
    v_lshl_add_u32 v10, v10, 4, v8
    v_lshlrev_b32 v10, 4, v10
    v_lshl_add_u32 v10, v9, 10, v10
    v_lshl_add_u32 v10, v11, 2, v10
    v_add_u32 v98, 16512, v10
    s_lshl_b32 s60, s25, 11
    v_lshl_add_u32 v99, v0, 3, s60
    s_lshl_b32 s60, s23, 11
    v_lshl_add_u32 v96, v0, 3, s60
    v_lshrrev_b32 v8, 5, v0
    v_lshlrev_b32 v8, 9, v8
    v_bfe_u32 v9, v0, 1, 4
    v_add_u32 v8, v8, v9
    s_lshl_b32 s60, s24, 12
    s_lshl_b32 s61, s23, 4
    s_add_u32 s60, s60, s61
    v_add_u32 v8, s60, v8
    v_lshlrev_b32 v95, 3, v8
    s_mov_b32 s62, 0
    s_mul_i32 s3, s62, 786432
    s_lshl_b32 s60, s22, 8
    s_add_u32 s3, s3, s60
    s_add_u32 s60, s21, 4096
    s_mov_b32 m0, s60
    s_add_u32 s61, s3, 8192
    buffer_load_dwordx4 v106, s[12:15], s61 offen lds
    s_add_u32 s60, s21, 5120
    s_mov_b32 m0, s60
    s_add_u32 s61, s3, 106496
    buffer_load_dwordx4 v107, s[12:15], s61 offen lds
    s_add_u32 s60, s21, 6144
    s_mov_b32 m0, s60
    s_add_u32 s61, s3, 204800
    buffer_load_dwordx4 v104, s[12:15], s61 offen lds
    s_add_u32 s60, s21, 7168
    s_mov_b32 m0, s60
    s_add_u32 s61, s3, 303104
    buffer_load_dwordx4 v105, s[12:15], s61 offen lds
    s_add_u32 s60, s21, 8192
    s_mov_b32 m0, s60
    s_add_u32 s61, s3, 401408
    buffer_load_dwordx4 v106, s[12:15], s61 offen lds
    s_add_u32 s60, s21, 9216
    s_mov_b32 m0, s60
    s_add_u32 s61, s3, 499712
    buffer_load_dwordx4 v107, s[12:15], s61 offen lds
    s_add_u32 s60, s21, 10240
    s_mov_b32 m0, s60
    s_add_u32 s61, s3, 598016
    buffer_load_dwordx4 v104, s[12:15], s61 offen lds
    s_add_u32 s60, s21, 11264
    s_mov_b32 m0, s60
    s_add_u32 s61, s3, 696320
    buffer_load_dwordx4 v105, s[12:15], s61 offen lds
    s_add_u32 s60, s21, 16384
    s_mov_b32 m0, s60
    s_add_u32 s61, s3, 16384
    buffer_load_dwordx4 v106, s[12:15], s61 offen lds
    s_add_u32 s60, s21, 17408
    s_mov_b32 m0, s60
    s_add_u32 s61, s3, 114688
    buffer_load_dwordx4 v107, s[12:15], s61 offen lds
    s_add_u32 s60, s21, 18432
    s_mov_b32 m0, s60
    s_add_u32 s61, s3, 212992
    buffer_load_dwordx4 v104, s[12:15], s61 offen lds
    s_add_u32 s60, s21, 19456
    s_mov_b32 m0, s60
    s_add_u32 s61, s3, 311296
    buffer_load_dwordx4 v105, s[12:15], s61 offen lds
    s_add_u32 s60, s21, 20480
    s_mov_b32 m0, s60
    s_add_u32 s61, s3, 409600
    buffer_load_dwordx4 v106, s[12:15], s61 offen lds
    s_add_u32 s60, s21, 21504
    s_mov_b32 m0, s60
    s_add_u32 s61, s3, 507904
    buffer_load_dwordx4 v107, s[12:15], s61 offen lds
    s_add_u32 s60, s21, 22528
    s_mov_b32 m0, s60
    s_add_u32 s61, s3, 606208
    buffer_load_dwordx4 v104, s[12:15], s61 offen lds
    s_add_u32 s60, s21, 23552
    s_mov_b32 m0, s60
    s_add_u32 s61, s3, 704512
    buffer_load_dwordx4 v105, s[12:15], s61 offen lds
    s_mov_b32 s70, 0
    s_mov_b32 s71, 0
    s_mov_b32 s72, 0
    s_mov_b32 s73, 0
    s_mov_b32 s74, 0
    s_mov_b32 s75, 0
    s_mov_b32 s76, 0
    s_mov_b32 s77, 0
    s_mov_b32 s78, 0
    s_mov_b32 s79, 0
    s_mov_b32 s80, 0
    s_mov_b32 s81, 0
    s_waitcnt vmcnt(0) lgkmcnt(0)
    s_barrier
.chain0_kernel_step:
    s_add_u32 s63, s62, 1
    v_mov_b32 v125, s63
    s_and_b32 s64, s62, 1
    s_mul_i32 s65, s64, 393216
    s_mul_i32 s66, s64, 524288
    s_add_u32 s66, s66, 786432
    s_mul_i32 s67, s64, 262144
    s_add_u32 s67, s67, 1835008
    ds_read_b128 v[16:19], v111 offset:0
    ds_read_b128 v[20:23], v111 offset:64
    ds_read_b128 v[24:27], v111 offset:128
    ds_read_b128 v[28:31], v111 offset:192
    ds_read_b128 v[32:35], v111 offset:256
    ds_read_b128 v[36:39], v111 offset:320
    ds_read_b128 v[40:43], v111 offset:384
    ds_read_b128 v[44:47], v111 offset:448
    v_mov_b32 v48, 0
    v_mov_b32 v49, 0
    v_mov_b32 v50, 0
    v_mov_b32 v51, 0
    v_mov_b32 v52, 0
    v_mov_b32 v53, 0
    v_mov_b32 v54, 0
    v_mov_b32 v55, 0
    v_mov_b32 v56, 0
    v_mov_b32 v57, 0
    v_mov_b32 v58, 0
    v_mov_b32 v59, 0
    s_waitcnt lgkmcnt(7)
    v_mfma_f32_16x16x32_bf16 v[48:51], v[128:131], v[16:19], v[48:51]
    v_mfma_f32_16x16x32_bf16 v[52:55], v[160:163], v[16:19], v[52:55]
    v_mfma_f32_16x16x32_bf16 v[56:59], v[192:195], v[16:19], v[56:59]
    s_waitcnt lgkmcnt(6)
    v_mfma_f32_16x16x32_bf16 v[48:51], v[132:135], v[20:23], v[48:51]
    v_mfma_f32_16x16x32_bf16 v[52:55], v[164:167], v[20:23], v[52:55]
    v_mfma_f32_16x16x32_bf16 v[56:59], v[196:199], v[20:23], v[56:59]
    s_waitcnt lgkmcnt(5)
    v_mfma_f32_16x16x32_bf16 v[48:51], v[136:139], v[24:27], v[48:51]
    v_mfma_f32_16x16x32_bf16 v[52:55], v[168:171], v[24:27], v[52:55]
    v_mfma_f32_16x16x32_bf16 v[56:59], v[200:203], v[24:27], v[56:59]
    s_waitcnt lgkmcnt(4)
    v_mfma_f32_16x16x32_bf16 v[48:51], v[140:143], v[28:31], v[48:51]
    v_mfma_f32_16x16x32_bf16 v[52:55], v[172:175], v[28:31], v[52:55]
    v_mfma_f32_16x16x32_bf16 v[56:59], v[204:207], v[28:31], v[56:59]
    s_waitcnt lgkmcnt(3)
    v_mfma_f32_16x16x32_bf16 v[48:51], v[144:147], v[32:35], v[48:51]
    v_mfma_f32_16x16x32_bf16 v[52:55], v[176:179], v[32:35], v[52:55]
    v_mfma_f32_16x16x32_bf16 v[56:59], v[208:211], v[32:35], v[56:59]
    s_waitcnt lgkmcnt(2)
    v_mfma_f32_16x16x32_bf16 v[48:51], v[148:151], v[36:39], v[48:51]
    v_mfma_f32_16x16x32_bf16 v[52:55], v[180:183], v[36:39], v[52:55]
    v_mfma_f32_16x16x32_bf16 v[56:59], v[212:215], v[36:39], v[56:59]
    s_waitcnt lgkmcnt(1)
    v_mfma_f32_16x16x32_bf16 v[48:51], v[152:155], v[40:43], v[48:51]
    v_mfma_f32_16x16x32_bf16 v[52:55], v[184:187], v[40:43], v[52:55]
    v_mfma_f32_16x16x32_bf16 v[56:59], v[216:219], v[40:43], v[56:59]
    s_waitcnt lgkmcnt(0)
    v_mfma_f32_16x16x32_bf16 v[48:51], v[156:159], v[44:47], v[48:51]
    v_mfma_f32_16x16x32_bf16 v[52:55], v[188:191], v[44:47], v[52:55]
    v_mfma_f32_16x16x32_bf16 v[56:59], v[220:223], v[44:47], v[56:59]
    s_nop 7
    s_nop 1
    ds_write_b128 v112, v[48:51] offset:0
    ds_write_b128 v112, v[52:55] offset:1024
    ds_write_b128 v112, v[56:59] offset:2048
    s_waitcnt lgkmcnt(0)
    s_barrier
    v_cmp_gt_u32 vcc, 192, v0
    s_and_saveexec_b64 s[42:43], vcc
    s_cbranch_execz .sk_5
    ds_read_b64 v[16:17], v113 offset:0
    ds_read_b64 v[18:19], v113 offset:3072
    ds_read_b64 v[20:21], v113 offset:6144
    ds_read_b64 v[22:23], v113 offset:9216
    s_waitcnt lgkmcnt(0)
    v_add_f32 v16, v16, v18
    v_add_f32 v17, v17, v19
    v_add_f32 v20, v20, v22
    v_add_f32 v21, v21, v23
    v_add_f32 v16, v16, v20
    v_add_f32 v17, v17, v21
    v_cvt_pk_bf16_f32 v16, v16, v17
    v_mov_b32 v17, v125
    s_cmp_eq_u32 s68, 1
    s_cbranch_scc0 .ls_6
    buffer_store_dwordx2 v[16:17], v114, s[8:11], s65 offen
    s_branch .le_7
.ls_6:
    buffer_store_dwordx2 v[16:17], v114, s[8:11], s65 offen sc1
.le_7:
    v_cmp_le_u32 vcc, 64, v0
    s_and_b64 exec, exec, vcc
    s_mul_i32 s3, s62, 131072
    buffer_store_dword v16, v115, s[16:19], s3 offen
.sk_5:
    s_mov_b64 exec, s[42:43]
    s_mul_i32 s31, s22, 12288
    s_add_u32 s31, s31, s65
    s_add_u32 s32, s31, 4096
    s_add_u32 s33, s31, 8192
    s_mov_b32 s30, 0
.poll_8:
    buffer_load_dwordx4 v[16:19], v109, s[8:11], s31 offen offset:0 sc1
    buffer_load_dwordx4 v[20:23], v109, s[8:11], s31 offen offset:1024 sc1
    buffer_load_dwordx4 v[24:27], v109, s[8:11], s31 offen offset:2048 sc1
    buffer_load_dwordx4 v[28:31], v109, s[8:11], s31 offen offset:3072 sc1
    buffer_load_dwordx4 v[32:35], v109, s[8:11], s32 offen offset:0 sc1
    buffer_load_dwordx4 v[36:39], v109, s[8:11], s32 offen offset:1024 sc1
    buffer_load_dwordx4 v[40:43], v109, s[8:11], s32 offen offset:2048 sc1
    buffer_load_dwordx4 v[44:47], v109, s[8:11], s32 offen offset:3072 sc1
    buffer_load_dwordx4 v[48:51], v109, s[8:11], s33 offen offset:0 sc1
    buffer_load_dwordx4 v[52:55], v109, s[8:11], s33 offen offset:1024 sc1
    buffer_load_dwordx4 v[56:59], v109, s[8:11], s33 offen offset:2048 sc1
    buffer_load_dwordx4 v[60:63], v109, s[8:11], s33 offen offset:3072 sc1
    s_waitcnt vmcnt(0)
    v_cmp_eq_u32 vcc, v17, v125
    v_cmp_eq_u32 s[40:41], v19, v125
    s_and_b64 vcc, vcc, s[40:41]
    v_cmp_eq_u32 s[40:41], v21, v125
    s_and_b64 vcc, vcc, s[40:41]
    v_cmp_eq_u32 s[40:41], v23, v125
    s_and_b64 vcc, vcc, s[40:41]
    v_cmp_eq_u32 s[40:41], v25, v125
    s_and_b64 vcc, vcc, s[40:41]
    v_cmp_eq_u32 s[40:41], v27, v125
    s_and_b64 vcc, vcc, s[40:41]
    v_cmp_eq_u32 s[40:41], v29, v125
    s_and_b64 vcc, vcc, s[40:41]
    v_cmp_eq_u32 s[40:41], v31, v125
    s_and_b64 vcc, vcc, s[40:41]
    v_cmp_eq_u32 s[40:41], v33, v125
    s_and_b64 vcc, vcc, s[40:41]
    v_cmp_eq_u32 s[40:41], v35, v125
    s_and_b64 vcc, vcc, s[40:41]
    v_cmp_eq_u32 s[40:41], v37, v125
    s_and_b64 vcc, vcc, s[40:41]
    v_cmp_eq_u32 s[40:41], v39, v125
    s_and_b64 vcc, vcc, s[40:41]
    v_cmp_eq_u32 s[40:41], v41, v125
    s_and_b64 vcc, vcc, s[40:41]
    v_cmp_eq_u32 s[40:41], v43, v125
    s_and_b64 vcc, vcc, s[40:41]
    v_cmp_eq_u32 s[40:41], v45, v125
    s_and_b64 vcc, vcc, s[40:41]
    v_cmp_eq_u32 s[40:41], v47, v125
    s_and_b64 vcc, vcc, s[40:41]
    v_cmp_eq_u32 s[40:41], v49, v125
    s_and_b64 vcc, vcc, s[40:41]
    v_cmp_eq_u32 s[40:41], v51, v125
    s_and_b64 vcc, vcc, s[40:41]
    v_cmp_eq_u32 s[40:41], v53, v125
    s_and_b64 vcc, vcc, s[40:41]
    v_cmp_eq_u32 s[40:41], v55, v125
    s_and_b64 vcc, vcc, s[40:41]
    v_cmp_eq_u32 s[40:41], v57, v125
    s_and_b64 vcc, vcc, s[40:41]
    v_cmp_eq_u32 s[40:41], v59, v125
    s_and_b64 vcc, vcc, s[40:41]
    v_cmp_eq_u32 s[40:41], v61, v125
    s_and_b64 vcc, vcc, s[40:41]
    v_cmp_eq_u32 s[40:41], v63, v125
    s_and_b64 vcc, vcc, s[40:41]
    s_cmp_eq_u64 vcc, exec
    s_cbranch_scc1 .pok_9
    s_add_u32 s30, s30, 1
    s_cmp_lt_u32 s30, 0x40000
    s_cbranch_scc1 .poll_8
.pok_9:
    v_mov_b32 v17, v18
    ds_write_b64 v100, v[16:17] offset:0
    v_mov_b32 v21, v22
    ds_write_b64 v101, v[20:21] offset:0
    v_mov_b32 v25, v26
    ds_write_b64 v102, v[24:25] offset:0
    v_mov_b32 v29, v30
    ds_write_b64 v103, v[28:29] offset:0
    v_mov_b32 v33, v34
    ds_write_b64 v100, v[32:33] offset:2048
    v_mov_b32 v37, v38
    ds_write_b64 v101, v[36:37] offset:2048
    v_mov_b32 v41, v42
    ds_write_b64 v102, v[40:41] offset:2048
    v_mov_b32 v45, v46
    ds_write_b64 v103, v[44:45] offset:2048
    v_mov_b32 v49, v50
    ds_write_b64 v100, v[48:49] offset:14336
    v_mov_b32 v53, v54
    ds_write_b64 v101, v[52:53] offset:14336
    v_mov_b32 v57, v58
    ds_write_b64 v102, v[56:57] offset:14336
    v_mov_b32 v61, v62
    ds_write_b64 v103, v[60:61] offset:14336
    s_waitcnt lgkmcnt(0)
    ds_read_b128 v[16:19], v120 offset:0
    ds_read_b128 v[20:23], v121 offset:0
    ds_read_b128 v[24:27], v122 offset:0
    ds_read_b128 v[28:31], v123 offset:0
    ds_read_b128 v[44:47], v116 offset:2048
    ds_read_b128 v[48:51], v117 offset:2048
    ds_read_b128 v[52:55], v118 offset:2048
    ds_read_b128 v[56:59], v119 offset:2048
    ds_read_b128 v[60:63], v116 offset:6144
    ds_read_b128 v[64:67], v117 offset:6144
    ds_read_b128 v[68:71], v118 offset:6144
    ds_read_b128 v[72:75], v119 offset:6144
    ds_read_b128 v[76:79], v116 offset:10240
    ds_read_b128 v[80:83], v117 offset:10240
    ds_read_b128 v[84:87], v118 offset:10240
    ds_read_b128 v[88:91], v119 offset:10240
    v_mov_b32 v32, 0
    v_mov_b32 v33, 0
    v_mov_b32 v34, 0
    v_mov_b32 v35, 0
    v_mov_b32 v36, 0
    v_mov_b32 v37, 0
    v_mov_b32 v38, 0
    v_mov_b32 v39, 0
    v_mov_b32 v40, 0
    v_mov_b32 v41, 0
    v_mov_b32 v42, 0
    v_mov_b32 v43, 0
    s_waitcnt lgkmcnt(0)
    v_mfma_f32_16x16x32_bf16 v[32:35], v[44:47], v[16:19], v[32:35]
    v_mfma_f32_16x16x32_bf16 v[36:39], v[60:63], v[16:19], v[36:39]
    v_mfma_f32_16x16x32_bf16 v[40:43], v[76:79], v[16:19], v[40:43]
    v_mfma_f32_16x16x32_bf16 v[32:35], v[48:51], v[20:23], v[32:35]
    v_mfma_f32_16x16x32_bf16 v[36:39], v[64:67], v[20:23], v[36:39]
    v_mfma_f32_16x16x32_bf16 v[40:43], v[80:83], v[20:23], v[40:43]
    v_mfma_f32_16x16x32_bf16 v[32:35], v[52:55], v[24:27], v[32:35]
    v_mfma_f32_16x16x32_bf16 v[36:39], v[68:71], v[24:27], v[36:39]
    v_mfma_f32_16x16x32_bf16 v[40:43], v[84:87], v[24:27], v[40:43]
    v_mfma_f32_16x16x32_bf16 v[32:35], v[56:59], v[28:31], v[32:35]
    v_mfma_f32_16x16x32_bf16 v[36:39], v[72:75], v[28:31], v[36:39]
    v_mfma_f32_16x16x32_bf16 v[40:43], v[88:91], v[28:31], v[40:43]
    s_nop 7
    s_nop 1
    v_xor_b32 v24, 0, v108
    ds_read_b64_tr_b16 v[44:45], v24 offset:14336
    ds_read_b64_tr_b16 v[46:47], v24 offset:18432
    ds_read_b64_tr_b16 v[48:49], v24 offset:22528
    v_xor_b32 v24, 32, v108
    ds_read_b64_tr_b16 v[50:51], v24 offset:14336
    ds_read_b64_tr_b16 v[52:53], v24 offset:18432
    ds_read_b64_tr_b16 v[54:55], v24 offset:22528
    v_xor_b32 v24, 64, v108
    ds_read_b64_tr_b16 v[56:57], v24 offset:14336
    ds_read_b64_tr_b16 v[58:59], v24 offset:18432
    ds_read_b64_tr_b16 v[60:61], v24 offset:22528
    v_xor_b32 v24, 96, v108
    ds_read_b64_tr_b16 v[62:63], v24 offset:14336
    ds_read_b64_tr_b16 v[64:65], v24 offset:18432
    ds_read_b64_tr_b16 v[66:67], v24 offset:22528
    v_xor_b32 v24, 128, v108
    ds_read_b64_tr_b16 v[68:69], v24 offset:14336
    ds_read_b64_tr_b16 v[70:71], v24 offset:18432
    ds_read_b64_tr_b16 v[72:73], v24 offset:22528
    v_xor_b32 v24, 160, v108
    ds_read_b64_tr_b16 v[74:75], v24 offset:14336
    ds_read_b64_tr_b16 v[76:77], v24 offset:18432
    ds_read_b64_tr_b16 v[78:79], v24 offset:22528
    v_xor_b32 v24, 192, v108
    ds_read_b64_tr_b16 v[80:81], v24 offset:14336
    ds_read_b64_tr_b16 v[82:83], v24 offset:18432
    ds_read_b64_tr_b16 v[84:85], v24 offset:22528
    v_xor_b32 v24, 224, v108
    ds_read_b64_tr_b16 v[86:87], v24 offset:14336
    ds_read_b64_tr_b16 v[88:89], v24 offset:18432
    ds_read_b64_tr_b16 v[90:91], v24 offset:22528
    v_cmp_le_u32 vcc, 2, v4
    v_mov_b32 v30, 0xff800000
    s_nop 0
    v_cndmask_b32 v40, v40, v30, vcc
    v_cndmask_b32 v41, v41, v30, vcc
    v_cndmask_b32 v42, v42, v30, vcc
    v_cndmask_b32 v43, v43, v30, vcc
    v_max_f32 v30, v32, v33
    v_max_f32 v30, v30, v34
    v_max_f32 v30, v30, v35
    v_max_f32 v30, v30, v36
    v_max_f32 v30, v30, v37
    v_max_f32 v30, v30, v38
    v_max_f32 v30, v30, v39
    v_max_f32 v30, v30, v40
    v_max_f32 v30, v30, v41
    v_max_f32 v30, v30, v42
    v_max_f32 v30, v30, v43
    ds_swizzle_b32 v31, v30 offset:0x401f
    s_waitcnt lgkmcnt(0)
    v_max_f32 v30, v30, v31
    v_mov_b32 v31, v30
    s_nop 1
    v_permlane32_swap_b32 v30, v31
    s_nop 1
    v_max_f32 v30, v30, v31
    v_mul_f32 v31, 0xbe0293ee, v30
    s_mov_b32 s3, 0x3e0293ee
    v_fma_f32 v32, v32, s3, v31
    v_exp_f32 v32, v32
    v_fma_f32 v33, v33, s3, v31
    v_exp_f32 v33, v33
    v_fma_f32 v34, v34, s3, v31
    v_exp_f32 v34, v34
    v_fma_f32 v35, v35, s3, v31
    v_exp_f32 v35, v35
    v_fma_f32 v36, v36, s3, v31
    v_exp_f32 v36, v36
    v_fma_f32 v37, v37, s3, v31
    v_exp_f32 v37, v37
    v_fma_f32 v38, v38, s3, v31
    v_exp_f32 v38, v38
    v_fma_f32 v39, v39, s3, v31
    v_exp_f32 v39, v39
    v_fma_f32 v40, v40, s3, v31
    v_exp_f32 v40, v40
    v_fma_f32 v41, v41, s3, v31
    v_exp_f32 v41, v41
    v_fma_f32 v42, v42, s3, v31
    v_exp_f32 v42, v42
    v_fma_f32 v43, v43, s3, v31
    v_exp_f32 v43, v43
    s_nop 0
    v_add_f32 v30, v32, v33
    v_add_f32 v30, v30, v34
    v_add_f32 v30, v30, v35
    v_add_f32 v30, v30, v36
    v_add_f32 v30, v30, v37
    v_add_f32 v30, v30, v38
    v_add_f32 v30, v30, v39
    v_add_f32 v30, v30, v40
    v_add_f32 v30, v30, v41
    v_add_f32 v30, v30, v42
    v_add_f32 v30, v30, v43
    ds_swizzle_b32 v31, v30 offset:0x401f
    s_waitcnt lgkmcnt(0)
    v_add_f32 v30, v30, v31
    v_mov_b32 v31, v30
    s_nop 1
    v_permlane32_swap_b32 v30, v31
    s_nop 1
    v_add_f32 v30, v30, v31
    v_rcp_f32 v30, v30
    s_nop 0
    v_mul_f32 v32, v32, v30
    v_mul_f32 v33, v33, v30
    v_mul_f32 v34, v34, v30
    v_mul_f32 v35, v35, v30
    v_mul_f32 v36, v36, v30
    v_mul_f32 v37, v37, v30
    v_mul_f32 v38, v38, v30
    v_mul_f32 v39, v39, v30
    v_mul_f32 v40, v40, v30
    v_mul_f32 v41, v41, v30
    v_mul_f32 v42, v42, v30
    v_mul_f32 v43, v43, v30
    v_cvt_pk_bf16_f32 v16, v32, v33
    v_cvt_pk_bf16_f32 v17, v34, v35
    v_cvt_pk_bf16_f32 v18, v36, v37
    v_cvt_pk_bf16_f32 v19, v38, v39
    v_cvt_pk_bf16_f32 v20, v40, v41
    v_cvt_pk_bf16_f32 v21, v42, v43
    s_waitcnt lgkmcnt(0)
    v_mfma_f32_16x16x32_bf16 v[24:27], v[44:47], v[16:19], 0
    v_mfma_f32_16x16x32_bf16 v[28:31], v[50:53], v[16:19], 0
    v_mfma_f32_16x16x32_bf16 v[32:35], v[56:59], v[16:19], 0
    v_mfma_f32_16x16x32_bf16 v[36:39], v[62:65], v[16:19], 0
    v_mfma_f32_16x16x16_bf16 v[24:27], v[48:49], v[20:21], v[24:27]
    v_mfma_f32_16x16x16_bf16 v[28:31], v[54:55], v[20:21], v[28:31]
    v_mfma_f32_16x16x16_bf16 v[32:35], v[60:61], v[20:21], v[32:35]
    v_mfma_f32_16x16x16_bf16 v[36:39], v[66:67], v[20:21], v[36:39]
    s_nop 7
    s_nop 1
    v_cvt_pk_bf16_f32 v44, v24, v25
    v_cvt_pk_bf16_f32 v45, v26, v27
    v_cvt_pk_bf16_f32 v50, v28, v29
    v_cvt_pk_bf16_f32 v51, v30, v31
    v_cvt_pk_bf16_f32 v56, v32, v33
    v_cvt_pk_bf16_f32 v57, v34, v35
    v_cvt_pk_bf16_f32 v62, v36, v37
    v_cvt_pk_bf16_f32 v63, v38, v39
    v_mfma_f32_16x16x32_bf16 v[24:27], v[68:71], v[16:19], 0
    v_mfma_f32_16x16x32_bf16 v[28:31], v[74:77], v[16:19], 0
    v_mfma_f32_16x16x32_bf16 v[32:35], v[80:83], v[16:19], 0
    v_mfma_f32_16x16x32_bf16 v[36:39], v[86:89], v[16:19], 0
    v_mfma_f32_16x16x16_bf16 v[24:27], v[72:73], v[20:21], v[24:27]
    v_mfma_f32_16x16x16_bf16 v[28:31], v[78:79], v[20:21], v[28:31]
    v_mfma_f32_16x16x16_bf16 v[32:35], v[84:85], v[20:21], v[32:35]
    v_mfma_f32_16x16x16_bf16 v[36:39], v[90:91], v[20:21], v[36:39]
    s_nop 7
    s_nop 1
    v_cvt_pk_bf16_f32 v68, v24, v25
    v_cvt_pk_bf16_f32 v69, v26, v27
    v_cvt_pk_bf16_f32 v74, v28, v29
    v_cvt_pk_bf16_f32 v75, v30, v31
    v_cvt_pk_bf16_f32 v80, v32, v33
    v_cvt_pk_bf16_f32 v81, v34, v35
    v_cvt_pk_bf16_f32 v86, v36, v37
    v_cvt_pk_bf16_f32 v87, v38, v39
    v_mov_b32 v24, v44
    v_mov_b32 v25, v45
    v_mov_b32 v26, v50
    v_mov_b32 v27, v51
    v_mov_b32 v28, v56
    v_mov_b32 v29, v57
    v_mov_b32 v30, v62
    v_mov_b32 v31, v63
    v_mov_b32 v32, v68
    v_mov_b32 v33, v69
    v_mov_b32 v34, v74
    v_mov_b32 v35, v75
    v_mov_b32 v36, v80
    v_mov_b32 v37, v81
    v_mov_b32 v38, v86
    v_mov_b32 v39, v87
    s_nop 1
    v_mfma_f32_16x16x32_bf16 v[16:19], v[224:227], v[24:27], 0
    v_mfma_f32_16x16x32_bf16 v[20:23], v[240:243], v[24:27], 0
    v_mfma_f32_16x16x32_bf16 v[16:19], v[228:231], v[28:31], v[16:19]
    v_mfma_f32_16x16x32_bf16 v[20:23], v[244:247], v[28:31], v[20:23]
    v_mfma_f32_16x16x32_bf16 v[16:19], v[232:235], v[32:35], v[16:19]
    v_mfma_f32_16x16x32_bf16 v[20:23], v[248:251], v[32:35], v[20:23]
    v_mfma_f32_16x16x32_bf16 v[16:19], v[236:239], v[36:39], v[16:19]
    v_mfma_f32_16x16x32_bf16 v[20:23], v[252:255], v[36:39], v[20:23]
    s_nop 7
    s_nop 1
    ds_write_b128 v97, v[16:19] offset:0
    ds_write_b128 v97, v[20:23] offset:1024
    s_waitcnt lgkmcnt(0)
    s_barrier
    ds_read_b32 v16, v98 offset:0
    ds_read_b32 v17, v98 offset:2048
    ds_read_b32 v18, v98 offset:4096
    ds_read_b32 v19, v98 offset:6144
    s_waitcnt lgkmcnt(0)
    v_add_f32 v16, v16, v17
    v_add_f32 v18, v18, v19
    v_add_f32 v16, v16, v18
    v_mov_b32 v17, v125
    buffer_store_dwordx2 v[16:17], v99, s[8:11], s66 offen sc1
    s_cmp_eq_u32 s62, 63
    s_cbranch_scc1 .np_10
    s_add_u32 s62, s62, 1
    s_mul_i32 s3, s62, 786432
    s_lshl_b32 s60, s22, 8
    s_add_u32 s3, s3, s60
    s_add_u32 s60, s21, 4096
    s_mov_b32 m0, s60
    s_add_u32 s61, s3, 8192
    buffer_load_dwordx4 v106, s[12:15], s61 offen lds
    s_add_u32 s60, s21, 5120
    s_mov_b32 m0, s60
    s_add_u32 s61, s3, 106496
    buffer_load_dwordx4 v107, s[12:15], s61 offen lds
    s_add_u32 s60, s21, 6144
    s_mov_b32 m0, s60
    s_add_u32 s61, s3, 204800
    buffer_load_dwordx4 v104, s[12:15], s61 offen lds
    s_add_u32 s60, s21, 7168
    s_mov_b32 m0, s60
    s_add_u32 s61, s3, 303104
    buffer_load_dwordx4 v105, s[12:15], s61 offen lds
    s_add_u32 s60, s21, 8192
    s_mov_b32 m0, s60
    s_add_u32 s61, s3, 401408
    buffer_load_dwordx4 v106, s[12:15], s61 offen lds
    s_add_u32 s60, s21, 9216
    s_mov_b32 m0, s60
    s_add_u32 s61, s3, 499712
    buffer_load_dwordx4 v107, s[12:15], s61 offen lds
    s_add_u32 s60, s21, 10240
    s_mov_b32 m0, s60
    s_add_u32 s61, s3, 598016
    buffer_load_dwordx4 v104, s[12:15], s61 offen lds
    s_add_u32 s60, s21, 11264
    s_mov_b32 m0, s60
    s_add_u32 s61, s3, 696320
    buffer_load_dwordx4 v105, s[12:15], s61 offen lds
    s_add_u32 s60, s21, 16384
    s_mov_b32 m0, s60
    s_add_u32 s61, s3, 16384
    buffer_load_dwordx4 v106, s[12:15], s61 offen lds
    s_add_u32 s60, s21, 17408
    s_mov_b32 m0, s60
    s_add_u32 s61, s3, 114688
    buffer_load_dwordx4 v107, s[12:15], s61 offen lds
    s_add_u32 s60, s21, 18432
    s_mov_b32 m0, s60
    s_add_u32 s61, s3, 212992
    buffer_load_dwordx4 v104, s[12:15], s61 offen lds
    s_add_u32 s60, s21, 19456
    s_mov_b32 m0, s60
    s_add_u32 s61, s3, 311296
    buffer_load_dwordx4 v105, s[12:15], s61 offen lds
    s_add_u32 s60, s21, 20480
    s_mov_b32 m0, s60
    s_add_u32 s61, s3, 409600
    buffer_load_dwordx4 v106, s[12:15], s61 offen lds
    s_add_u32 s60, s21, 21504
    s_mov_b32 m0, s60
    s_add_u32 s61, s3, 507904
    buffer_load_dwordx4 v107, s[12:15], s61 offen lds
    s_add_u32 s60, s21, 22528
    s_mov_b32 m0, s60
    s_add_u32 s61, s3, 606208
    buffer_load_dwordx4 v104, s[12:15], s61 offen lds
    s_add_u32 s60, s21, 23552
    s_mov_b32 m0, s60
    s_add_u32 s61, s3, 704512
    buffer_load_dwordx4 v105, s[12:15], s61 offen lds
    s_sub_u32 s62, s62, 1
.np_10:
    s_add_u32 s31, s66, 0
    s_add_u32 s32, s66, 65536
    s_add_u32 s33, s66, 131072
    s_add_u32 s34, s66, 196608
    s_add_u32 s35, s66, 262144
    s_add_u32 s36, s66, 327680
    s_add_u32 s37, s66, 393216
    s_add_u32 s38, s66, 458752
    s_mov_b32 s30, 0
.poll_11:
    buffer_load_dwordx2 v[16:17], v96, s[8:11], s31 offen sc1
    buffer_load_dwordx2 v[18:19], v96, s[8:11], s32 offen sc1
    buffer_load_dwordx2 v[20:21], v96, s[8:11], s33 offen sc1
    buffer_load_dwordx2 v[22:23], v96, s[8:11], s34 offen sc1
    buffer_load_dwordx2 v[24:25], v96, s[8:11], s35 offen sc1
    buffer_load_dwordx2 v[26:27], v96, s[8:11], s36 offen sc1
    buffer_load_dwordx2 v[28:29], v96, s[8:11], s37 offen sc1
    buffer_load_dwordx2 v[30:31], v96, s[8:11], s38 offen sc1
    s_waitcnt vmcnt(0)
    v_cmp_eq_u32 vcc, v17, v125
    v_cmp_eq_u32 s[40:41], v19, v125
    s_and_b64 vcc, vcc, s[40:41]
    v_cmp_eq_u32 s[40:41], v21, v125
    s_and_b64 vcc, vcc, s[40:41]
    v_cmp_eq_u32 s[40:41], v23, v125
    s_and_b64 vcc, vcc, s[40:41]
    v_cmp_eq_u32 s[40:41], v25, v125
    s_and_b64 vcc, vcc, s[40:41]
    v_cmp_eq_u32 s[40:41], v27, v125
    s_and_b64 vcc, vcc, s[40:41]
    v_cmp_eq_u32 s[40:41], v29, v125
    s_and_b64 vcc, vcc, s[40:41]
    v_cmp_eq_u32 s[40:41], v31, v125
    s_and_b64 vcc, vcc, s[40:41]
    s_cmp_eq_u64 vcc, exec
    s_cbranch_scc1 .pok_12
    s_add_u32 s30, s30, 1
    s_cmp_lt_u32 s30, 0x40000
    s_cbranch_scc1 .poll_11
.pok_12:
    v_add_f32 v16, v16, v18
    v_add_f32 v20, v20, v22
    v_add_f32 v24, v24, v26
    v_add_f32 v28, v28, v30
    v_add_f32 v16, v16, v20
    v_add_f32 v24, v24, v28
    v_add_f32 v16, v16, v24
    ds_swizzle_b32 v17, v16 offset:0x041f
    s_waitcnt lgkmcnt(0)
    v_cvt_pk_bf16_f32 v16, v16, v17
    v_mov_b32 v17, v125
    v_and_b32 v18, 1, v0
    v_cmp_eq_u32 vcc, 0, v18
    s_and_saveexec_b64 s[42:43], vcc
    s_cmp_eq_u32 s68, 1
    s_cbranch_scc0 .ls_13
    buffer_store_dwordx2 v[16:17], v95, s[8:11], s67 offen
    s_branch .le_14
.ls_13:
    buffer_store_dwordx2 v[16:17], v95, s[8:11], s67 offen sc1
.le_14:
    s_mov_b64 exec, s[42:43]
    s_cmp_eq_u32 s62, 63
    s_cbranch_scc1 .chain0_kernel_fin
    s_lshl_b32 s60, s24, 15
    s_add_u32 s60, s60, s67
    s_add_u32 s31, s60, 0
    s_add_u32 s32, s60, 4096
    s_add_u32 s33, s60, 8192
    s_add_u32 s34, s60, 12288
    s_add_u32 s35, s60, 16384
    s_add_u32 s36, s60, 20480
    s_add_u32 s37, s60, 24576
    s_add_u32 s38, s60, 28672
    s_mov_b32 s30, 0
.poll_15:
    buffer_load_dwordx4 v[16:19], v110, s[8:11], s31 offen sc1
    buffer_load_dwordx4 v[20:23], v110, s[8:11], s32 offen sc1
    buffer_load_dwordx4 v[24:27], v110, s[8:11], s33 offen sc1
    buffer_load_dwordx4 v[28:31], v110, s[8:11], s34 offen sc1
    buffer_load_dwordx4 v[32:35], v110, s[8:11], s35 offen sc1
    buffer_load_dwordx4 v[36:39], v110, s[8:11], s36 offen sc1
    buffer_load_dwordx4 v[40:43], v110, s[8:11], s37 offen sc1
    buffer_load_dwordx4 v[44:47], v110, s[8:11], s38 offen sc1
    s_waitcnt vmcnt(0)
    v_cmp_eq_u32 vcc, v17, v125
    v_cmp_eq_u32 s[40:41], v19, v125
    s_and_b64 vcc, vcc, s[40:41]
    v_cmp_eq_u32 s[40:41], v21, v125
    s_and_b64 vcc, vcc, s[40:41]
    v_cmp_eq_u32 s[40:41], v23, v125
    s_and_b64 vcc, vcc, s[40:41]
    v_cmp_eq_u32 s[40:41], v25, v125
    s_and_b64 vcc, vcc, s[40:41]
    v_cmp_eq_u32 s[40:41], v27, v125
    s_and_b64 vcc, vcc, s[40:41]
    v_cmp_eq_u32 s[40:41], v29, v125
    s_and_b64 vcc, vcc, s[40:41]
    v_cmp_eq_u32 s[40:41], v31, v125
    s_and_b64 vcc, vcc, s[40:41]
    v_cmp_eq_u32 s[40:41], v33, v125
    s_and_b64 vcc, vcc, s[40:41]
    v_cmp_eq_u32 s[40:41], v35, v125
    s_and_b64 vcc, vcc, s[40:41]
    v_cmp_eq_u32 s[40:41], v37, v125
    s_and_b64 vcc, vcc, s[40:41]
    v_cmp_eq_u32 s[40:41], v39, v125
    s_and_b64 vcc, vcc, s[40:41]
    v_cmp_eq_u32 s[40:41], v41, v125
    s_and_b64 vcc, vcc, s[40:41]
    v_cmp_eq_u32 s[40:41], v43, v125
    s_and_b64 vcc, vcc, s[40:41]
    v_cmp_eq_u32 s[40:41], v45, v125
    s_and_b64 vcc, vcc, s[40:41]
    v_cmp_eq_u32 s[40:41], v47, v125
    s_and_b64 vcc, vcc, s[40:41]
    s_cmp_eq_u64 vcc, exec
    s_cbranch_scc1 .pok_16
    s_add_u32 s30, s30, 1
    s_cmp_lt_u32 s30, 0x40000
    s_cbranch_scc1 .poll_15
.pok_16:
    v_mov_b32 v17, v18
    ds_write_b64 v124, v[16:17] offset:0
    v_mov_b32 v21, v22
    ds_write_b64 v124, v[20:21] offset:2064
    v_mov_b32 v25, v26
    ds_write_b64 v124, v[24:25] offset:4128
    v_mov_b32 v29, v30
    ds_write_b64 v124, v[28:29] offset:6192
    v_mov_b32 v33, v34
    ds_write_b64 v124, v[32:33] offset:8256
    v_mov_b32 v37, v38
    ds_write_b64 v124, v[36:37] offset:10320
    v_mov_b32 v41, v42
    ds_write_b64 v124, v[40:41] offset:12384
    v_mov_b32 v45, v46
    ds_write_b64 v124, v[44:45] offset:14448
    s_waitcnt lgkmcnt(0)
    s_barrier
    s_add_u32 s62, s62, 1
    s_branch .chain0_kernel_step
.chain0_kernel_fin:
.chain0_kernel_done:
    s_endpgm
.section .rodata,"a"
.p2align 6
.amdhsa_kernel chain0_kernel
  .amdhsa_next_free_vgpr 256
  .amdhsa_next_free_sgpr 96
  .amdhsa_accum_offset 256
  .amdhsa_group_segment_fixed_size 0
  .amdhsa_kernarg_size 120
  .amdhsa_user_sgpr_count 2
  .amdhsa_user_sgpr_kernarg_segment_ptr 1
  .amdhsa_system_sgpr_workgroup_id_x 1
.end_amdhsa_kernel
.text
.globl chain1_kernel
.p2align 8
.type chain1_kernel,@function
chain1_kernel:
    s_cmp_ge_u32 s2, 256
    s_cbranch_scc1 .chain1_kernel_done
    s_load_dwordx2 s[4:5], s[0:1], 112
    s_load_dwordx4 s[48:51], s[0:1], 16
    s_load_dwordx4 s[52:55], s[0:1], 32
    s_load_dwordx2 s[56:57], s[0:1], 8
    s_load_dwordx2 s[26:27], s[0:1], 104
    v_and_b32 v1, 63, v0
    v_lshrrev_b32 v2, 6, v0
    v_and_b32 v3, 15, v1
    v_lshrrev_b32 v4, 4, v1
    s_nop 0
    v_readfirstlane_b32 s69, v2
    s_waitcnt lgkmcnt(0)
    s_mov_b32 s8, s26
    s_and_b32 s9, s27, 0xffff
    s_mov_b32 s10, 0x100
    s_mov_b32 s11, 0x00020000
    s_getreg_b32 s28, hwreg(HW_REG_XCC_ID)
    s_and_b32 s28, s28, 7
    v_mov_b32 v8, 0
    s_cmp_eq_u32 s69, 0
    s_cbranch_scc0 .r1_17
    v_mov_b32 v9, 1
    s_lshl_b32 s29, s28, 2
    v_mov_b32 v10, s29
    v_cmp_eq_u32 vcc, 0, v1
    s_and_saveexec_b64 s[42:43], vcc
    buffer_atomic_add v9, v10, s[8:11], 0 offen sc0 sc1
    s_waitcnt vmcnt(0)
    s_mov_b64 exec, s[42:43]
    v_mov_b32 v11, 0
    v_cmp_eq_u32 vcc, 0, v1
    s_and_saveexec_b64 s[42:43], vcc
    ds_write_b32 v11, v9 offset:16512
    s_mov_b64 exec, s[42:43]
    s_waitcnt lgkmcnt(0)
.r1_17:
    s_barrier
    v_mov_b32 v11, 0
    ds_read_b32 v9, v11 offset:16512
    s_waitcnt lgkmcnt(0)
    v_readfirstlane_b32 s29, v9
    v_and_b32 v10, 7, v1
    v_lshlrev_b32 v10, 2, v10
    s_mov_b32 s30, 0
.rw_18:
    buffer_load_dword v9, v10, s[8:11], 0 offen sc0 sc1
    s_waitcnt vmcnt(0)
    v_mov_b32 v12, v9
    ds_swizzle_b32 v13, v12 offset:0x41f
    s_waitcnt lgkmcnt(0)
    v_add_u32 v12, v12, v13
    ds_swizzle_b32 v13, v12 offset:0x81f
    s_waitcnt lgkmcnt(0)
    v_add_u32 v12, v12, v13
    ds_swizzle_b32 v13, v12 offset:0x101f
    s_waitcnt lgkmcnt(0)
    v_add_u32 v12, v12, v13
    s_nop 0
    v_readfirstlane_b32 s31, v12
    s_cmp_eq_u32 s31, 256
    s_cbranch_scc1 .rwo_19
    s_add_u32 s30, s30, 1
    s_cmp_lt_u32 s30, 0x40000
    s_cbranch_scc1 .rw_18
.rwo_19:
    v_cmp_eq_u32 vcc, 32, v9
    s_cmp_eq_u64 vcc, exec
    s_cselect_b32 s68, 1, 0
    s_lshl_b32 s31, s28, 5
    s_add_u32 s31, s31, s29
    s_cmp_eq_u32 s68, 1
    s_cselect_b32 s25, s31, s2
    s_and_b32 s25, s25, 255
    s_lshr_b32 s24, s25, 5
    s_and_b32 s23, s25, 31
    s_lshr_b32 s58, s25, 3
    s_and_b32 s59, s25, 7
    s_lshl_b32 s22, s24, 2
    s_add_u32 s22, s22, s69
    s_barrier
    s_lshl_b32 s60, s58, 7
    s_lshl_b32 s61, s59, 4
    s_add_u32 s60, s60, s61
    v_add_u32 v5, s60, v3
    v_lshlrev_b32 v5, 1, v5
    v_lshlrev_b32 v6, 8, v2
    v_lshl_add_u32 v6, v4, 3, v6
    v_lshlrev_b32 v6, 13, v6
    v_add_u32 v5, v5, v6
    s_mov_b32 s8, s48
    s_and_b32 s9, s49, 0xffff
    s_mov_b32 s10, 0x800000
    s_mov_b32 s11, 0x00020000
    s_mov_b32 s3, 0
    buffer_load_ushort v16, v5, s[8:11], s3 offen
    s_mov_b32 s3, 8192
    buffer_load_ushort v17, v5, s[8:11], s3 offen
    s_mov_b32 s3, 16384
    buffer_load_ushort v18, v5, s[8:11], s3 offen
    s_mov_b32 s3, 24576
    buffer_load_ushort v19, v5, s[8:11], s3 offen
    s_mov_b32 s3, 32768
    buffer_load_ushort v20, v5, s[8:11], s3 offen
    s_mov_b32 s3, 40960
    buffer_load_ushort v21, v5, s[8:11], s3 offen
    s_mov_b32 s3, 49152
    buffer_load_ushort v22, v5, s[8:11], s3 offen
    s_mov_b32 s3, 57344
    buffer_load_ushort v23, v5, s[8:11], s3 offen
    s_mov_b32 s3, 262144
    buffer_load_ushort v24, v5, s[8:11], s3 offen
    s_mov_b32 s3, 270336
    buffer_load_ushort v25, v5, s[8:11], s3 offen
    s_mov_b32 s3, 278528
    buffer_load_ushort v26, v5, s[8:11], s3 offen
    s_mov_b32 s3, 286720
    buffer_load_ushort v27, v5, s[8:11], s3 offen
    s_mov_b32 s3, 294912
    buffer_load_ushort v28, v5, s[8:11], s3 offen
    s_mov_b32 s3, 303104
    buffer_load_ushort v29, v5, s[8:11], s3 offen
    s_mov_b32 s3, 311296
    buffer_load_ushort v30, v5, s[8:11], s3 offen
    s_mov_b32 s3, 319488
    buffer_load_ushort v31, v5, s[8:11], s3 offen
    s_mov_b32 s3, 524288
    buffer_load_ushort v32, v5, s[8:11], s3 offen
    s_mov_b32 s3, 532480
    buffer_load_ushort v33, v5, s[8:11], s3 offen
    s_mov_b32 s3, 540672
    buffer_load_ushort v34, v5, s[8:11], s3 offen
    s_mov_b32 s3, 548864
    buffer_load_ushort v35, v5, s[8:11], s3 offen
    s_mov_b32 s3, 557056
    buffer_load_ushort v36, v5, s[8:11], s3 offen
    s_mov_b32 s3, 565248
    buffer_load_ushort v37, v5, s[8:11], s3 offen
    s_mov_b32 s3, 573440
    buffer_load_ushort v38, v5, s[8:11], s3 offen
    s_mov_b32 s3, 581632
    buffer_load_ushort v39, v5, s[8:11], s3 offen
    s_mov_b32 s3, 786432
    buffer_load_ushort v40, v5, s[8:11], s3 offen
    s_mov_b32 s3, 794624
    buffer_load_ushort v41, v5, s[8:11], s3 offen
    s_mov_b32 s3, 802816
    buffer_load_ushort v42, v5, s[8:11], s3 offen
    s_mov_b32 s3, 811008
    buffer_load_ushort v43, v5, s[8:11], s3 offen
    s_mov_b32 s3, 819200
    buffer_load_ushort v44, v5, s[8:11], s3 offen
    s_mov_b32 s3, 827392
    buffer_load_ushort v45, v5, s[8:11], s3 offen
    s_mov_b32 s3, 835584
    buffer_load_ushort v46, v5, s[8:11], s3 offen
    s_mov_b32 s3, 843776
    buffer_load_ushort v47, v5, s[8:11], s3 offen
    s_mov_b32 s3, 1048576
    buffer_load_ushort v48, v5, s[8:11], s3 offen
    s_mov_b32 s3, 1056768
    buffer_load_ushort v49, v5, s[8:11], s3 offen
    s_mov_b32 s3, 1064960
    buffer_load_ushort v50, v5, s[8:11], s3 offen
    s_mov_b32 s3, 1073152
    buffer_load_ushort v51, v5, s[8:11], s3 offen
    s_mov_b32 s3, 1081344
    buffer_load_ushort v52, v5, s[8:11], s3 offen
    s_mov_b32 s3, 1089536
    buffer_load_ushort v53, v5, s[8:11], s3 offen
    s_mov_b32 s3, 1097728
    buffer_load_ushort v54, v5, s[8:11], s3 offen
    s_mov_b32 s3, 1105920
    buffer_load_ushort v55, v5, s[8:11], s3 offen
    s_mov_b32 s3, 1310720
    buffer_load_ushort v56, v5, s[8:11], s3 offen
    s_mov_b32 s3, 1318912
    buffer_load_ushort v57, v5, s[8:11], s3 offen
    s_mov_b32 s3, 1327104
    buffer_load_ushort v58, v5, s[8:11], s3 offen
    s_mov_b32 s3, 1335296
    buffer_load_ushort v59, v5, s[8:11], s3 offen
    s_mov_b32 s3, 1343488
    buffer_load_ushort v60, v5, s[8:11], s3 offen
    s_mov_b32 s3, 1351680
    buffer_load_ushort v61, v5, s[8:11], s3 offen
    s_mov_b32 s3, 1359872
    buffer_load_ushort v62, v5, s[8:11], s3 offen
    s_mov_b32 s3, 1368064
    buffer_load_ushort v63, v5, s[8:11], s3 offen
    s_mov_b32 s3, 1572864
    buffer_load_ushort v64, v5, s[8:11], s3 offen
    s_mov_b32 s3, 1581056
    buffer_load_ushort v65, v5, s[8:11], s3 offen
    s_mov_b32 s3, 1589248
    buffer_load_ushort v66, v5, s[8:11], s3 offen
    s_mov_b32 s3, 1597440
    buffer_load_ushort v67, v5, s[8:11], s3 offen
    s_mov_b32 s3, 1605632
    buffer_load_ushort v68, v5, s[8:11], s3 offen
    s_mov_b32 s3, 1613824
    buffer_load_ushort v69, v5, s[8:11], s3 offen
    s_mov_b32 s3, 1622016
    buffer_load_ushort v70, v5, s[8:11], s3 offen
    s_mov_b32 s3, 1630208
    buffer_load_ushort v71, v5, s[8:11], s3 offen
    s_mov_b32 s3, 1835008
    buffer_load_ushort v72, v5, s[8:11], s3 offen
    s_mov_b32 s3, 1843200
    buffer_load_ushort v73, v5, s[8:11], s3 offen
    s_mov_b32 s3, 1851392
    buffer_load_ushort v74, v5, s[8:11], s3 offen
    s_mov_b32 s3, 1859584
    buffer_load_ushort v75, v5, s[8:11], s3 offen
    s_mov_b32 s3, 1867776
    buffer_load_ushort v76, v5, s[8:11], s3 offen
    s_mov_b32 s3, 1875968
    buffer_load_ushort v77, v5, s[8:11], s3 offen
    s_mov_b32 s3, 1884160
    buffer_load_ushort v78, v5, s[8:11], s3 offen
    s_mov_b32 s3, 1892352
    buffer_load_ushort v79, v5, s[8:11], s3 offen
    s_waitcnt vmcnt(0)
    v_lshl_or_b32 v128, v17, 16, v16
    v_lshl_or_b32 v129, v19, 16, v18
    v_lshl_or_b32 v130, v21, 16, v20
    v_lshl_or_b32 v131, v23, 16, v22
    v_lshl_or_b32 v132, v25, 16, v24
    v_lshl_or_b32 v133, v27, 16, v26
    v_lshl_or_b32 v134, v29, 16, v28
    v_lshl_or_b32 v135, v31, 16, v30
    v_lshl_or_b32 v136, v33, 16, v32
    v_lshl_or_b32 v137, v35, 16, v34
    v_lshl_or_b32 v138, v37, 16, v36
    v_lshl_or_b32 v139, v39, 16, v38
    v_lshl_or_b32 v140, v41, 16, v40
    v_lshl_or_b32 v141, v43, 16, v42
    v_lshl_or_b32 v142, v45, 16, v44
    v_lshl_or_b32 v143, v47, 16, v46
    v_lshl_or_b32 v144, v49, 16, v48
    v_lshl_or_b32 v145, v51, 16, v50
    v_lshl_or_b32 v146, v53, 16, v52
    v_lshl_or_b32 v147, v55, 16, v54
    v_lshl_or_b32 v148, v57, 16, v56
    v_lshl_or_b32 v149, v59, 16, v58
    v_lshl_or_b32 v150, v61, 16, v60
    v_lshl_or_b32 v151, v63, 16, v62
    v_lshl_or_b32 v152, v65, 16, v64
    v_lshl_or_b32 v153, v67, 16, v66
    v_lshl_or_b32 v154, v69, 16, v68
    v_lshl_or_b32 v155, v71, 16, v70
    v_lshl_or_b32 v156, v73, 16, v72
    v_lshl_or_b32 v157, v75, 16, v74
    v_lshl_or_b32 v158, v77, 16, v76
    v_lshl_or_b32 v159, v79, 16, v78
    s_mov_b32 s8, s50
    s_and_b32 s9, s51, 0xffff
    s_mov_b32 s10, 0x800000
    s_mov_b32 s11, 0x00020000
    s_mov_b32 s3, 0
    buffer_load_ushort v16, v5, s[8:11], s3 offen
    s_mov_b32 s3, 8192
    buffer_load_ushort v17, v5, s[8:11], s3 offen
    s_mov_b32 s3, 16384
    buffer_load_ushort v18, v5, s[8:11], s3 offen
    s_mov_b32 s3, 24576
    buffer_load_ushort v19, v5, s[8:11], s3 offen
    s_mov_b32 s3, 32768
    buffer_load_ushort v20, v5, s[8:11], s3 offen
    s_mov_b32 s3, 40960
    buffer_load_ushort v21, v5, s[8:11], s3 offen
    s_mov_b32 s3, 49152
    buffer_load_ushort v22, v5, s[8:11], s3 offen
    s_mov_b32 s3, 57344
    buffer_load_ushort v23, v5, s[8:11], s3 offen
    s_mov_b32 s3, 262144
    buffer_load_ushort v24, v5, s[8:11], s3 offen
    s_mov_b32 s3, 270336
    buffer_load_ushort v25, v5, s[8:11], s3 offen
    s_mov_b32 s3, 278528
    buffer_load_ushort v26, v5, s[8:11], s3 offen
    s_mov_b32 s3, 286720
    buffer_load_ushort v27, v5, s[8:11], s3 offen
    s_mov_b32 s3, 294912
    buffer_load_ushort v28, v5, s[8:11], s3 offen
    s_mov_b32 s3, 303104
    buffer_load_ushort v29, v5, s[8:11], s3 offen
    s_mov_b32 s3, 311296
    buffer_load_ushort v30, v5, s[8:11], s3 offen
    s_mov_b32 s3, 319488
    buffer_load_ushort v31, v5, s[8:11], s3 offen
    s_mov_b32 s3, 524288
    buffer_load_ushort v32, v5, s[8:11], s3 offen
    s_mov_b32 s3, 532480
    buffer_load_ushort v33, v5, s[8:11], s3 offen
    s_mov_b32 s3, 540672
    buffer_load_ushort v34, v5, s[8:11], s3 offen
    s_mov_b32 s3, 548864
    buffer_load_ushort v35, v5, s[8:11], s3 offen
    s_mov_b32 s3, 557056
    buffer_load_ushort v36, v5, s[8:11], s3 offen
    s_mov_b32 s3, 565248
    buffer_load_ushort v37, v5, s[8:11], s3 offen
    s_mov_b32 s3, 573440
    buffer_load_ushort v38, v5, s[8:11], s3 offen
    s_mov_b32 s3, 581632
    buffer_load_ushort v39, v5, s[8:11], s3 offen
    s_mov_b32 s3, 786432
    buffer_load_ushort v40, v5, s[8:11], s3 offen
    s_mov_b32 s3, 794624
    buffer_load_ushort v41, v5, s[8:11], s3 offen
    s_mov_b32 s3, 802816
    buffer_load_ushort v42, v5, s[8:11], s3 offen
    s_mov_b32 s3, 811008
    buffer_load_ushort v43, v5, s[8:11], s3 offen
    s_mov_b32 s3, 819200
    buffer_load_ushort v44, v5, s[8:11], s3 offen
    s_mov_b32 s3, 827392
    buffer_load_ushort v45, v5, s[8:11], s3 offen
    s_mov_b32 s3, 835584
    buffer_load_ushort v46, v5, s[8:11], s3 offen
    s_mov_b32 s3, 843776
    buffer_load_ushort v47, v5, s[8:11], s3 offen
    s_mov_b32 s3, 1048576
    buffer_load_ushort v48, v5, s[8:11], s3 offen
    s_mov_b32 s3, 1056768
    buffer_load_ushort v49, v5, s[8:11], s3 offen
    s_mov_b32 s3, 1064960
    buffer_load_ushort v50, v5, s[8:11], s3 offen
    s_mov_b32 s3, 1073152
    buffer_load_ushort v51, v5, s[8:11], s3 offen
    s_mov_b32 s3, 1081344
    buffer_load_ushort v52, v5, s[8:11], s3 offen
    s_mov_b32 s3, 1089536
    buffer_load_ushort v53, v5, s[8:11], s3 offen
    s_mov_b32 s3, 1097728
    buffer_load_ushort v54, v5, s[8:11], s3 offen
    s_mov_b32 s3, 1105920
    buffer_load_ushort v55, v5, s[8:11], s3 offen
    s_mov_b32 s3, 1310720
    buffer_load_ushort v56, v5, s[8:11], s3 offen
    s_mov_b32 s3, 1318912
    buffer_load_ushort v57, v5, s[8:11], s3 offen
    s_mov_b32 s3, 1327104
    buffer_load_ushort v58, v5, s[8:11], s3 offen
    s_mov_b32 s3, 1335296
    buffer_load_ushort v59, v5, s[8:11], s3 offen
    s_mov_b32 s3, 1343488
    buffer_load_ushort v60, v5, s[8:11], s3 offen
    s_mov_b32 s3, 1351680
    buffer_load_ushort v61, v5, s[8:11], s3 offen
    s_mov_b32 s3, 1359872
    buffer_load_ushort v62, v5, s[8:11], s3 offen
    s_mov_b32 s3, 1368064
    buffer_load_ushort v63, v5, s[8:11], s3 offen
    s_mov_b32 s3, 1572864
    buffer_load_ushort v64, v5, s[8:11], s3 offen
    s_mov_b32 s3, 1581056
    buffer_load_ushort v65, v5, s[8:11], s3 offen
    s_mov_b32 s3, 1589248
    buffer_load_ushort v66, v5, s[8:11], s3 offen
    s_mov_b32 s3, 1597440
    buffer_load_ushort v67, v5, s[8:11], s3 offen
    s_mov_b32 s3, 1605632
    buffer_load_ushort v68, v5, s[8:11], s3 offen
    s_mov_b32 s3, 1613824
    buffer_load_ushort v69, v5, s[8:11], s3 offen
    s_mov_b32 s3, 1622016
    buffer_load_ushort v70, v5, s[8:11], s3 offen
    s_mov_b32 s3, 1630208
    buffer_load_ushort v71, v5, s[8:11], s3 offen
    s_mov_b32 s3, 1835008
    buffer_load_ushort v72, v5, s[8:11], s3 offen
    s_mov_b32 s3, 1843200
    buffer_load_ushort v73, v5, s[8:11], s3 offen
    s_mov_b32 s3, 1851392
    buffer_load_ushort v74, v5, s[8:11], s3 offen
    s_mov_b32 s3, 1859584
    buffer_load_ushort v75, v5, s[8:11], s3 offen
    s_mov_b32 s3, 1867776
    buffer_load_ushort v76, v5, s[8:11], s3 offen
    s_mov_b32 s3, 1875968
    buffer_load_ushort v77, v5, s[8:11], s3 offen
    s_mov_b32 s3, 1884160
    buffer_load_ushort v78, v5, s[8:11], s3 offen
    s_mov_b32 s3, 1892352
    buffer_load_ushort v79, v5, s[8:11], s3 offen
    s_waitcnt vmcnt(0)
    v_lshl_or_b32 v160, v17, 16, v16
    v_lshl_or_b32 v161, v19, 16, v18
    v_lshl_or_b32 v162, v21, 16, v20
    v_lshl_or_b32 v163, v23, 16, v22
    v_lshl_or_b32 v164, v25, 16, v24
    v_lshl_or_b32 v165, v27, 16, v26
    v_lshl_or_b32 v166, v29, 16, v28
    v_lshl_or_b32 v167, v31, 16, v30
    v_lshl_or_b32 v168, v33, 16, v32
    v_lshl_or_b32 v169, v35, 16, v34
    v_lshl_or_b32 v170, v37, 16, v36
    v_lshl_or_b32 v171, v39, 16, v38
    v_lshl_or_b32 v172, v41, 16, v40
    v_lshl_or_b32 v173, v43, 16, v42
    v_lshl_or_b32 v174, v45, 16, v44
    v_lshl_or_b32 v175, v47, 16, v46
    v_lshl_or_b32 v176, v49, 16, v48
    v_lshl_or_b32 v177, v51, 16, v50
    v_lshl_or_b32 v178, v53, 16, v52
    v_lshl_or_b32 v179, v55, 16, v54
    v_lshl_or_b32 v180, v57, 16, v56
    v_lshl_or_b32 v181, v59, 16, v58
    v_lshl_or_b32 v182, v61, 16, v60
    v_lshl_or_b32 v183, v63, 16, v62
    v_lshl_or_b32 v184, v65, 16, v64
    v_lshl_or_b32 v185, v67, 16, v66
    v_lshl_or_b32 v186, v69, 16, v68
    v_lshl_or_b32 v187, v71, 16, v70
    v_lshl_or_b32 v188, v73, 16, v72
    v_lshl_or_b32 v189, v75, 16, v74
    v_lshl_or_b32 v190, v77, 16, v76
    v_lshl_or_b32 v191, v79, 16, v78
    s_mov_b32 s8, s52
    s_and_b32 s9, s53, 0xffff
    s_mov_b32 s10, 0x800000
    s_mov_b32 s11, 0x00020000
    s_mov_b32 s3, 0
    buffer_load_ushort v16, v5, s[8:11], s3 offen
    s_mov_b32 s3, 8192
    buffer_load_ushort v17, v5, s[8:11], s3 offen
    s_mov_b32 s3, 16384
    buffer_load_ushort v18, v5, s[8:11], s3 offen
    s_mov_b32 s3, 24576
    buffer_load_ushort v19, v5, s[8:11], s3 offen
    s_mov_b32 s3, 32768
    buffer_load_ushort v20, v5, s[8:11], s3 offen
    s_mov_b32 s3, 40960
    buffer_load_ushort v21, v5, s[8:11], s3 offen
    s_mov_b32 s3, 49152
    buffer_load_ushort v22, v5, s[8:11], s3 offen
    s_mov_b32 s3, 57344
    buffer_load_ushort v23, v5, s[8:11], s3 offen
    s_mov_b32 s3, 262144
    buffer_load_ushort v24, v5, s[8:11], s3 offen
    s_mov_b32 s3, 270336
    buffer_load_ushort v25, v5, s[8:11], s3 offen
    s_mov_b32 s3, 278528
    buffer_load_ushort v26, v5, s[8:11], s3 offen
    s_mov_b32 s3, 286720
    buffer_load_ushort v27, v5, s[8:11], s3 offen
    s_mov_b32 s3, 294912
    buffer_load_ushort v28, v5, s[8:11], s3 offen
    s_mov_b32 s3, 303104
    buffer_load_ushort v29, v5, s[8:11], s3 offen
    s_mov_b32 s3, 311296
    buffer_load_ushort v30, v5, s[8:11], s3 offen
    s_mov_b32 s3, 319488
    buffer_load_ushort v31, v5, s[8:11], s3 offen
    s_mov_b32 s3, 524288
    buffer_load_ushort v32, v5, s[8:11], s3 offen
    s_mov_b32 s3, 532480
    buffer_load_ushort v33, v5, s[8:11], s3 offen
    s_mov_b32 s3, 540672
    buffer_load_ushort v34, v5, s[8:11], s3 offen
    s_mov_b32 s3, 548864
    buffer_load_ushort v35, v5, s[8:11], s3 offen
    s_mov_b32 s3, 557056
    buffer_load_ushort v36, v5, s[8:11], s3 offen
    s_mov_b32 s3, 565248
    buffer_load_ushort v37, v5, s[8:11], s3 offen
    s_mov_b32 s3, 573440
    buffer_load_ushort v38, v5, s[8:11], s3 offen
    s_mov_b32 s3, 581632
    buffer_load_ushort v39, v5, s[8:11], s3 offen
    s_mov_b32 s3, 786432
    buffer_load_ushort v40, v5, s[8:11], s3 offen
    s_mov_b32 s3, 794624
    buffer_load_ushort v41, v5, s[8:11], s3 offen
    s_mov_b32 s3, 802816
    buffer_load_ushort v42, v5, s[8:11], s3 offen
    s_mov_b32 s3, 811008
    buffer_load_ushort v43, v5, s[8:11], s3 offen
    s_mov_b32 s3, 819200
    buffer_load_ushort v44, v5, s[8:11], s3 offen
    s_mov_b32 s3, 827392
    buffer_load_ushort v45, v5, s[8:11], s3 offen
    s_mov_b32 s3, 835584
    buffer_load_ushort v46, v5, s[8:11], s3 offen
    s_mov_b32 s3, 843776
    buffer_load_ushort v47, v5, s[8:11], s3 offen
    s_mov_b32 s3, 1048576
    buffer_load_ushort v48, v5, s[8:11], s3 offen
    s_mov_b32 s3, 1056768
    buffer_load_ushort v49, v5, s[8:11], s3 offen
    s_mov_b32 s3, 1064960
    buffer_load_ushort v50, v5, s[8:11], s3 offen
    s_mov_b32 s3, 1073152
    buffer_load_ushort v51, v5, s[8:11], s3 offen
    s_mov_b32 s3, 1081344
    buffer_load_ushort v52, v5, s[8:11], s3 offen
    s_mov_b32 s3, 1089536
    buffer_load_ushort v53, v5, s[8:11], s3 offen
    s_mov_b32 s3, 1097728
    buffer_load_ushort v54, v5, s[8:11], s3 offen
    s_mov_b32 s3, 1105920
    buffer_load_ushort v55, v5, s[8:11], s3 offen
    s_mov_b32 s3, 1310720
    buffer_load_ushort v56, v5, s[8:11], s3 offen
    s_mov_b32 s3, 1318912
    buffer_load_ushort v57, v5, s[8:11], s3 offen
    s_mov_b32 s3, 1327104
    buffer_load_ushort v58, v5, s[8:11], s3 offen
    s_mov_b32 s3, 1335296
    buffer_load_ushort v59, v5, s[8:11], s3 offen
    s_mov_b32 s3, 1343488
    buffer_load_ushort v60, v5, s[8:11], s3 offen
    s_mov_b32 s3, 1351680
    buffer_load_ushort v61, v5, s[8:11], s3 offen
    s_mov_b32 s3, 1359872
    buffer_load_ushort v62, v5, s[8:11], s3 offen
    s_mov_b32 s3, 1368064
    buffer_load_ushort v63, v5, s[8:11], s3 offen
    s_mov_b32 s3, 1572864
    buffer_load_ushort v64, v5, s[8:11], s3 offen
    s_mov_b32 s3, 1581056
    buffer_load_ushort v65, v5, s[8:11], s3 offen
    s_mov_b32 s3, 1589248
    buffer_load_ushort v66, v5, s[8:11], s3 offen
    s_mov_b32 s3, 1597440
    buffer_load_ushort v67, v5, s[8:11], s3 offen
    s_mov_b32 s3, 1605632
    buffer_load_ushort v68, v5, s[8:11], s3 offen
    s_mov_b32 s3, 1613824
    buffer_load_ushort v69, v5, s[8:11], s3 offen
    s_mov_b32 s3, 1622016
    buffer_load_ushort v70, v5, s[8:11], s3 offen
    s_mov_b32 s3, 1630208
    buffer_load_ushort v71, v5, s[8:11], s3 offen
    s_mov_b32 s3, 1835008
    buffer_load_ushort v72, v5, s[8:11], s3 offen
    s_mov_b32 s3, 1843200
    buffer_load_ushort v73, v5, s[8:11], s3 offen
    s_mov_b32 s3, 1851392
    buffer_load_ushort v74, v5, s[8:11], s3 offen
    s_mov_b32 s3, 1859584
    buffer_load_ushort v75, v5, s[8:11], s3 offen
    s_mov_b32 s3, 1867776
    buffer_load_ushort v76, v5, s[8:11], s3 offen
    s_mov_b32 s3, 1875968
    buffer_load_ushort v77, v5, s[8:11], s3 offen
    s_mov_b32 s3, 1884160
    buffer_load_ushort v78, v5, s[8:11], s3 offen
    s_mov_b32 s3, 1892352
    buffer_load_ushort v79, v5, s[8:11], s3 offen
    s_waitcnt vmcnt(0)
    v_lshl_or_b32 v192, v17, 16, v16
    v_lshl_or_b32 v193, v19, 16, v18
    v_lshl_or_b32 v194, v21, 16, v20
    v_lshl_or_b32 v195, v23, 16, v22
    v_lshl_or_b32 v196, v25, 16, v24
    v_lshl_or_b32 v197, v27, 16, v26
    v_lshl_or_b32 v198, v29, 16, v28
    v_lshl_or_b32 v199, v31, 16, v30
    v_lshl_or_b32 v200, v33, 16, v32
    v_lshl_or_b32 v201, v35, 16, v34
    v_lshl_or_b32 v202, v37, 16, v36
    v_lshl_or_b32 v203, v39, 16, v38
    v_lshl_or_b32 v204, v41, 16, v40
    v_lshl_or_b32 v205, v43, 16, v42
    v_lshl_or_b32 v206, v45, 16, v44
    v_lshl_or_b32 v207, v47, 16, v46
    v_lshl_or_b32 v208, v49, 16, v48
    v_lshl_or_b32 v209, v51, 16, v50
    v_lshl_or_b32 v210, v53, 16, v52
    v_lshl_or_b32 v211, v55, 16, v54
    v_lshl_or_b32 v212, v57, 16, v56
    v_lshl_or_b32 v213, v59, 16, v58
    v_lshl_or_b32 v214, v61, 16, v60
    v_lshl_or_b32 v215, v63, 16, v62
    v_lshl_or_b32 v216, v65, 16, v64
    v_lshl_or_b32 v217, v67, 16, v66
    v_lshl_or_b32 v218, v69, 16, v68
    v_lshl_or_b32 v219, v71, 16, v70
    v_lshl_or_b32 v220, v73, 16, v72
    v_lshl_or_b32 v221, v75, 16, v74
    v_lshl_or_b32 v222, v77, 16, v76
    v_lshl_or_b32 v223, v79, 16, v78
    s_mov_b32 s8, s54
    s_and_b32 s9, s55, 0xffff
    s_mov_b32 s10, 0x800000
    s_mov_b32 s11, 0x00020000
    s_lshl_b32 s60, s23, 5
    v_add_u32 v5, s60, v3
    v_lshlrev_b32 v5, 1, v5
    s_lshl_b32 s60, s22, 7
    v_lshlrev_b32 v6, 2, v4
    v_add_u32 v6, s60, v6
    v_lshlrev_b32 v6, 11, v6
    v_add_u32 v5, v5, v6
    s_mov_b32 s3, 0
    buffer_load_ushort v16, v5, s[8:11], s3 offen
    s_mov_b32 s3, 2048
    buffer_load_ushort v17, v5, s[8:11], s3 offen
    s_mov_b32 s3, 4096
    buffer_load_ushort v18, v5, s[8:11], s3 offen
    s_mov_b32 s3, 6144
    buffer_load_ushort v19, v5, s[8:11], s3 offen
    s_mov_b32 s3, 32768
    buffer_load_ushort v20, v5, s[8:11], s3 offen
    s_mov_b32 s3, 34816
    buffer_load_ushort v21, v5, s[8:11], s3 offen
    s_mov_b32 s3, 36864
    buffer_load_ushort v22, v5, s[8:11], s3 offen
    s_mov_b32 s3, 38912
    buffer_load_ushort v23, v5, s[8:11], s3 offen
    s_mov_b32 s3, 65536
    buffer_load_ushort v24, v5, s[8:11], s3 offen
    s_mov_b32 s3, 67584
    buffer_load_ushort v25, v5, s[8:11], s3 offen
    s_mov_b32 s3, 69632
    buffer_load_ushort v26, v5, s[8:11], s3 offen
    s_mov_b32 s3, 71680
    buffer_load_ushort v27, v5, s[8:11], s3 offen
    s_mov_b32 s3, 98304
    buffer_load_ushort v28, v5, s[8:11], s3 offen
    s_mov_b32 s3, 100352
    buffer_load_ushort v29, v5, s[8:11], s3 offen
    s_mov_b32 s3, 102400
    buffer_load_ushort v30, v5, s[8:11], s3 offen
    s_mov_b32 s3, 104448
    buffer_load_ushort v31, v5, s[8:11], s3 offen
    s_mov_b32 s3, 131072
    buffer_load_ushort v32, v5, s[8:11], s3 offen
    s_mov_b32 s3, 133120
    buffer_load_ushort v33, v5, s[8:11], s3 offen
    s_mov_b32 s3, 135168
    buffer_load_ushort v34, v5, s[8:11], s3 offen
    s_mov_b32 s3, 137216
    buffer_load_ushort v35, v5, s[8:11], s3 offen
    s_mov_b32 s3, 163840
    buffer_load_ushort v36, v5, s[8:11], s3 offen
    s_mov_b32 s3, 165888
    buffer_load_ushort v37, v5, s[8:11], s3 offen
    s_mov_b32 s3, 167936
    buffer_load_ushort v38, v5, s[8:11], s3 offen
    s_mov_b32 s3, 169984
    buffer_load_ushort v39, v5, s[8:11], s3 offen
    s_mov_b32 s3, 196608
    buffer_load_ushort v40, v5, s[8:11], s3 offen
    s_mov_b32 s3, 198656
    buffer_load_ushort v41, v5, s[8:11], s3 offen
    s_mov_b32 s3, 200704
    buffer_load_ushort v42, v5, s[8:11], s3 offen
    s_mov_b32 s3, 202752
    buffer_load_ushort v43, v5, s[8:11], s3 offen
    s_mov_b32 s3, 229376
    buffer_load_ushort v44, v5, s[8:11], s3 offen
    s_mov_b32 s3, 231424
    buffer_load_ushort v45, v5, s[8:11], s3 offen
    s_mov_b32 s3, 233472
    buffer_load_ushort v46, v5, s[8:11], s3 offen
    s_mov_b32 s3, 235520
    buffer_load_ushort v47, v5, s[8:11], s3 offen
    s_mov_b32 s3, 32
    buffer_load_ushort v48, v5, s[8:11], s3 offen
    s_mov_b32 s3, 2080
    buffer_load_ushort v49, v5, s[8:11], s3 offen
    s_mov_b32 s3, 4128
    buffer_load_ushort v50, v5, s[8:11], s3 offen
    s_mov_b32 s3, 6176
    buffer_load_ushort v51, v5, s[8:11], s3 offen
    s_mov_b32 s3, 32800
    buffer_load_ushort v52, v5, s[8:11], s3 offen
    s_mov_b32 s3, 34848
    buffer_load_ushort v53, v5, s[8:11], s3 offen
    s_mov_b32 s3, 36896
    buffer_load_ushort v54, v5, s[8:11], s3 offen
    s_mov_b32 s3, 38944
    buffer_load_ushort v55, v5, s[8:11], s3 offen
    s_mov_b32 s3, 65568
    buffer_load_ushort v56, v5, s[8:11], s3 offen
    s_mov_b32 s3, 67616
    buffer_load_ushort v57, v5, s[8:11], s3 offen
    s_mov_b32 s3, 69664
    buffer_load_ushort v58, v5, s[8:11], s3 offen
    s_mov_b32 s3, 71712
    buffer_load_ushort v59, v5, s[8:11], s3 offen
    s_mov_b32 s3, 98336
    buffer_load_ushort v60, v5, s[8:11], s3 offen
    s_mov_b32 s3, 100384
    buffer_load_ushort v61, v5, s[8:11], s3 offen
    s_mov_b32 s3, 102432
    buffer_load_ushort v62, v5, s[8:11], s3 offen
    s_mov_b32 s3, 104480
    buffer_load_ushort v63, v5, s[8:11], s3 offen
    s_mov_b32 s3, 131104
    buffer_load_ushort v64, v5, s[8:11], s3 offen
    s_mov_b32 s3, 133152
    buffer_load_ushort v65, v5, s[8:11], s3 offen
    s_mov_b32 s3, 135200
    buffer_load_ushort v66, v5, s[8:11], s3 offen
    s_mov_b32 s3, 137248
    buffer_load_ushort v67, v5, s[8:11], s3 offen
    s_mov_b32 s3, 163872
    buffer_load_ushort v68, v5, s[8:11], s3 offen
    s_mov_b32 s3, 165920
    buffer_load_ushort v69, v5, s[8:11], s3 offen
    s_mov_b32 s3, 167968
    buffer_load_ushort v70, v5, s[8:11], s3 offen
    s_mov_b32 s3, 170016
    buffer_load_ushort v71, v5, s[8:11], s3 offen
    s_mov_b32 s3, 196640
    buffer_load_ushort v72, v5, s[8:11], s3 offen
    s_mov_b32 s3, 198688
    buffer_load_ushort v73, v5, s[8:11], s3 offen
    s_mov_b32 s3, 200736
    buffer_load_ushort v74, v5, s[8:11], s3 offen
    s_mov_b32 s3, 202784
    buffer_load_ushort v75, v5, s[8:11], s3 offen
    s_mov_b32 s3, 229408
    buffer_load_ushort v76, v5, s[8:11], s3 offen
    s_mov_b32 s3, 231456
    buffer_load_ushort v77, v5, s[8:11], s3 offen
    s_mov_b32 s3, 233504
    buffer_load_ushort v78, v5, s[8:11], s3 offen
    s_mov_b32 s3, 235552
    buffer_load_ushort v79, v5, s[8:11], s3 offen
    s_waitcnt vmcnt(0)
    v_lshl_or_b32 v224, v17, 16, v16
    v_lshl_or_b32 v225, v19, 16, v18
    v_lshl_or_b32 v226, v21, 16, v20
    v_lshl_or_b32 v227, v23, 16, v22
    v_lshl_or_b32 v228, v25, 16, v24
    v_lshl_or_b32 v229, v27, 16, v26
    v_lshl_or_b32 v230, v29, 16, v28
    v_lshl_or_b32 v231, v31, 16, v30
    v_lshl_or_b32 v232, v33, 16, v32
    v_lshl_or_b32 v233, v35, 16, v34
    v_lshl_or_b32 v234, v37, 16, v36
    v_lshl_or_b32 v235, v39, 16, v38
    v_lshl_or_b32 v236, v41, 16, v40
    v_lshl_or_b32 v237, v43, 16, v42
    v_lshl_or_b32 v238, v45, 16, v44
    v_lshl_or_b32 v239, v47, 16, v46
    v_lshl_or_b32 v240, v49, 16, v48
    v_lshl_or_b32 v241, v51, 16, v50
    v_lshl_or_b32 v242, v53, 16, v52
    v_lshl_or_b32 v243, v55, 16, v54
    v_lshl_or_b32 v244, v57, 16, v56
    v_lshl_or_b32 v245, v59, 16, v58
    v_lshl_or_b32 v246, v61, 16, v60
    v_lshl_or_b32 v247, v63, 16, v62
    v_lshl_or_b32 v248, v65, 16, v64
    v_lshl_or_b32 v249, v67, 16, v66
    v_lshl_or_b32 v250, v69, 16, v68
    v_lshl_or_b32 v251, v71, 16, v70
    v_lshl_or_b32 v252, v73, 16, v72
    v_lshl_or_b32 v253, v75, 16, v74
    v_lshl_or_b32 v254, v77, 16, v76
    v_lshl_or_b32 v255, v79, 16, v78
    s_add_u32 s60, s4, 0x7000000
    s_addc_u32 s61, s5, 0
    s_mov_b32 s8, s60
    s_and_b32 s9, s61, 0xffff
    s_mov_b32 s10, 0x240000
    s_mov_b32 s11, 0x00020000
    s_add_u32 s60, s4, 0x1000000
    s_addc_u32 s61, s5, 0
    s_mov_b32 s12, s60
    s_and_b32 s13, s61, 0xffff
    s_mov_b32 s14, 0x3000000
    s_mov_b32 s15, 0x00020000
    s_add_u32 s60, s4, 0x6000000
    s_addc_u32 s61, s5, 0
    s_mov_b32 s16, s60
    s_and_b32 s17, s61, 0xffff
    s_mov_b32 s18, 0x800000
    s_mov_b32 s19, 0x00020000
    s_mov_b32 s60, s56
    s_mov_b32 s61, s57
    s_mov_b32 s52, s60
    s_and_b32 s53, s61, 0xffff
    s_mov_b32 s54, 0x4000
    s_mov_b32 s55, 0x00020000
    s_mul_i32 s21, s69, 26624
    s_add_u32 s21, s21, 28928
    v_mov_b32 v8, 0
    v_mov_b32 v9, 0
    v_mov_b32 v10, 0
    v_mov_b32 v11, 0
    v_lshlrev_b32 v12, 4, v1
    v_add_u32 v12, s21, v12
    ds_write_b128 v12, v[8:11] offset:12288
    ds_write_b128 v12, v[8:11] offset:13312
    ds_write_b128 v12, v[8:11] offset:24576
    ds_write_b128 v12, v[8:11] offset:25600
    v_lshlrev_b32 v124, 3, v0
    s_mov_b32 s3, 0
    buffer_load_dwordx2 v[16:17], v124, s[52:55], s3 offen
    s_mov_b32 s3, 2048
    buffer_load_dwordx2 v[18:19], v124, s[52:55], s3 offen
    s_mov_b32 s3, 4096
    buffer_load_dwordx2 v[20:21], v124, s[52:55], s3 offen
    s_mov_b32 s3, 6144
    buffer_load_dwordx2 v[22:23], v124, s[52:55], s3 offen
    s_mov_b32 s3, 8192
    buffer_load_dwordx2 v[24:25], v124, s[52:55], s3 offen
    s_mov_b32 s3, 10240
    buffer_load_dwordx2 v[26:27], v124, s[52:55], s3 offen
    s_mov_b32 s3, 12288
    buffer_load_dwordx2 v[28:29], v124, s[52:55], s3 offen
    s_mov_b32 s3, 14336
    buffer_load_dwordx2 v[30:31], v124, s[52:55], s3 offen
    s_waitcnt vmcnt(0)
    ds_write_b64 v124, v[16:17] offset:0
    ds_write_b64 v124, v[18:19] offset:2064
    ds_write_b64 v124, v[20:21] offset:4128
    ds_write_b64 v124, v[22:23] offset:6192
    ds_write_b64 v124, v[24:25] offset:8256
    ds_write_b64 v124, v[26:27] offset:10320
    ds_write_b64 v124, v[28:29] offset:12384
    ds_write_b64 v124, v[30:31] offset:14448
    v_lshlrev_b32 v110, 4, v0
    v_lshlrev_b32 v109, 4, v1
    v_and_b32 v8, 7, v1
    v_mul_u32_u24 v111, 2064, v8
    v_lshl_add_u32 v111, v2, 9, v111
    v_lshl_add_u32 v111, v4, 4, v111
    v_mul_u32_u24 v112, 3072, v2
    v_lshl_add_u32 v112, v1, 4, v112
    v_add_u32 v112, 16512, v112
    v_lshrrev_b32 v8, 6, v0
    v_bfe_u32 v9, v0, 3, 3
    v_and_b32 v10, 7, v0
    v_lshrrev_b32 v11, 1, v10
    v_lshl_add_u32 v11, v11, 4, v9
    v_lshlrev_b32 v11, 4, v11
    v_and_b32 v12, 1, v10
    v_lshl_add_u32 v11, v12, 3, v11
    v_lshl_add_u32 v113, v8, 10, v11
    v_add_u32 v113, 16512, v113
    s_mul_i32 s60, s58, 3
    v_add_u32 v11, s60, v8
    v_lshl_add_u32 v11, v11, 3, v9
    v_lshlrev_b32 v11, 6, v11
    s_lshl_b32 s60, s59, 3
    v_add_u32 v11, s60, v11
    v_add_u32 v11, v11, v10
    v_lshlrev_b32 v114, 3, v11
    v_subrev_u32 v11, 1, v8
    v_lshl_add_u32 v11, v11, 3, v9
    v_lshlrev_b32 v11, 13, v11
    s_lshl_b32 s60, s58, 8
    s_lshl_b32 s61, s59, 5
    s_add_u32 s60, s60, s61
    v_add_u32 v11, s60, v11
    v_lshl_add_u32 v115, v10, 2, v11
    v_lshrrev_b32 v8, 5, v1
    v_bfe_u32 v9, v1, 1, 4
    v_and_b32 v10, 1, v1
    v_add_u32 v11, 0, v8
    v_xor_b32 v12, v9, v11
    v_lshlrev_b32 v12, 4, v12
    v_lshl_add_u32 v12, v11, 8, v12
    v_lshl_add_u32 v12, v10, 3, v12
    v_add_u32 v100, s21, v12
    v_add_u32 v11, 2, v8
    v_xor_b32 v12, v9, v11
    v_lshlrev_b32 v12, 4, v12
    v_lshl_add_u32 v12, v11, 8, v12
    v_lshl_add_u32 v12, v10, 3, v12
    v_add_u32 v101, s21, v12
    v_add_u32 v11, 4, v8
    v_xor_b32 v12, v9, v11
    v_lshlrev_b32 v12, 4, v12
    v_lshl_add_u32 v12, v11, 8, v12
    v_lshl_add_u32 v12, v10, 3, v12
    v_add_u32 v102, s21, v12
    v_add_u32 v11, 6, v8
    v_xor_b32 v12, v9, v11
    v_lshlrev_b32 v12, 4, v12
    v_lshl_add_u32 v12, v11, 8, v12
    v_lshl_add_u32 v12, v10, 3, v12
    v_add_u32 v103, s21, v12
    s_mov_b32 s60, 24576
    v_mul_lo_u32 v8, v4, s60
    v_xor_b32 v9, v3, v4
    v_lshl_add_u32 v104, v9, 4, v8
    v_xor_b32 v105, 64, v104
    v_xor_b32 v106, 128, v104
    v_xor_b32 v107, 192, v104
    v_add_u32 v8, 0, v4
    v_xor_b32 v8, v8, v3
    v_lshlrev_b32 v8, 4, v8
    v_lshl_add_u32 v8, v3, 8, v8
    v_add_u32 v116, s21, v8
    v_add_u32 v8, 4, v4
    v_xor_b32 v8, v8, v3
    v_lshlrev_b32 v8, 4, v8
    v_lshl_add_u32 v8, v3, 8, v8
    v_add_u32 v117, s21, v8
    v_add_u32 v8, 8, v4
    v_xor_b32 v8, v8, v3
    v_lshlrev_b32 v8, 4, v8
    v_lshl_add_u32 v8, v3, 8, v8
    v_add_u32 v118, s21, v8
    v_add_u32 v8, 12, v4
    v_xor_b32 v8, v8, v3
    v_lshlrev_b32 v8, 4, v8
    v_lshl_add_u32 v8, v3, 8, v8
    v_add_u32 v119, s21, v8
    v_and_b32 v9, 7, v1
    v_add_u32 v8, 0, v4
    v_xor_b32 v8, v8, v9
    v_lshlrev_b32 v8, 4, v8
    v_lshl_add_u32 v8, v9, 8, v8
    v_add_u32 v120, s21, v8
    v_add_u32 v8, 4, v4
    v_xor_b32 v8, v8, v9
    v_lshlrev_b32 v8, 4, v8
    v_lshl_add_u32 v8, v9, 8, v8
    v_add_u32 v121, s21, v8
    v_add_u32 v8, 8, v4
    v_xor_b32 v8, v8, v9
    v_lshlrev_b32 v8, 4, v8
    v_lshl_add_u32 v8, v9, 8, v8
    v_add_u32 v122, s21, v8
    v_add_u32 v8, 12, v4
    v_xor_b32 v8, v8, v9
    v_lshlrev_b32 v8, 4, v8
    v_lshl_add_u32 v8, v9, 8, v8
    v_add_u32 v123, s21, v8
    v_bfe_u32 v8, v1, 2, 2
    v_lshl_add_u32 v8, v4, 2, v8
    v_bfe_u32 v9, v1, 1, 1
    v_xor_b32 v9, v9, v8
    v_lshlrev_b32 v9, 4, v9
    v_lshl_add_u32 v9, v8, 8, v9
    v_and_b32 v10, 1, v1
    v_lshl_add_u32 v9, v10, 3, v9
    v_add_u32 v108, s21, v9
    v_lshlrev_b32 v97, 11, v2
    v_lshl_add_u32 v97, v1, 4, v97
    v_add_u32 v97, 16512, v97
    v_lshrrev_b32 v8, 5, v0
    v_bfe_u32 v9, v0, 4, 1
    v_bfe_u32 v10, v0, 2, 2
    v_and_b32 v11, 3, v0
    v_lshl_add_u32 v10, v10, 4, v8
    v_lshlrev_b32 v10, 4, v10
    v_lshl_add_u32 v10, v9, 10, v10
    v_lshl_add_u32 v10, v11, 2, v10
    v_add_u32 v98, 16512, v10
    s_lshl_b32 s60, s25, 11
    v_lshl_add_u32 v99, v0, 3, s60
    s_lshl_b32 s60, s23, 11
    v_lshl_add_u32 v96, v0, 3, s60
    v_lshrrev_b32 v8, 5, v0
    v_lshlrev_b32 v8, 9, v8
    v_bfe_u32 v9, v0, 1, 4
    v_add_u32 v8, v8, v9
    s_lshl_b32 s60, s24, 12
    s_lshl_b32 s61, s23, 4
    s_add_u32 s60, s60, s61
    v_add_u32 v8, s60, v8
    v_lshlrev_b32 v95, 3, v8
    s_mov_b32 s62, 0
    s_mul_i32 s3, s62, 786432
    s_lshl_b32 s60, s22, 8
    s_add_u32 s3, s3, s60
    s_add_u32 s60, s21, 4096
    s_mov_b32 m0, s60
    s_add_u32 s61, s3, 8192
    buffer_load_dwordx4 v106, s[12:15], s61 offen lds
    s_add_u32 s60, s21, 5120
    s_mov_b32 m0, s60
    s_add_u32 s61, s3, 106496
    buffer_load_dwordx4 v107, s[12:15], s61 offen lds
    s_add_u32 s60, s21, 6144
    s_mov_b32 m0, s60
    s_add_u32 s61, s3, 204800
    buffer_load_dwordx4 v104, s[12:15], s61 offen lds
    s_add_u32 s60, s21, 7168
    s_mov_b32 m0, s60
    s_add_u32 s61, s3, 303104
    buffer_load_dwordx4 v105, s[12:15], s61 offen lds
    s_add_u32 s60, s21, 8192
    s_mov_b32 m0, s60
    s_add_u32 s61, s3, 401408
    buffer_load_dwordx4 v106, s[12:15], s61 offen lds
    s_add_u32 s60, s21, 9216
    s_mov_b32 m0, s60
    s_add_u32 s61, s3, 499712
    buffer_load_dwordx4 v107, s[12:15], s61 offen lds
    s_add_u32 s60, s21, 10240
    s_mov_b32 m0, s60
    s_add_u32 s61, s3, 598016
    buffer_load_dwordx4 v104, s[12:15], s61 offen lds
    s_add_u32 s60, s21, 11264
    s_mov_b32 m0, s60
    s_add_u32 s61, s3, 696320
    buffer_load_dwordx4 v105, s[12:15], s61 offen lds
    s_add_u32 s60, s21, 16384
    s_mov_b32 m0, s60
    s_add_u32 s61, s3, 16384
    buffer_load_dwordx4 v106, s[12:15], s61 offen lds
    s_add_u32 s60, s21, 17408
    s_mov_b32 m0, s60
    s_add_u32 s61, s3, 114688
    buffer_load_dwordx4 v107, s[12:15], s61 offen lds
    s_add_u32 s60, s21, 18432
    s_mov_b32 m0, s60
    s_add_u32 s61, s3, 212992
    buffer_load_dwordx4 v104, s[12:15], s61 offen lds
    s_add_u32 s60, s21, 19456
    s_mov_b32 m0, s60
    s_add_u32 s61, s3, 311296
    buffer_load_dwordx4 v105, s[12:15], s61 offen lds
    s_add_u32 s60, s21, 20480
    s_mov_b32 m0, s60
    s_add_u32 s61, s3, 409600
    buffer_load_dwordx4 v106, s[12:15], s61 offen lds
    s_add_u32 s60, s21, 21504
    s_mov_b32 m0, s60
    s_add_u32 s61, s3, 507904
    buffer_load_dwordx4 v107, s[12:15], s61 offen lds
    s_add_u32 s60, s21, 22528
    s_mov_b32 m0, s60
    s_add_u32 s61, s3, 606208
    buffer_load_dwordx4 v104, s[12:15], s61 offen lds
    s_add_u32 s60, s21, 23552
    s_mov_b32 m0, s60
    s_add_u32 s61, s3, 704512
    buffer_load_dwordx4 v105, s[12:15], s61 offen lds
    s_mov_b32 s70, 0
    s_mov_b32 s71, 0
    s_mov_b32 s72, 0
    s_mov_b32 s73, 0
    s_mov_b32 s74, 0
    s_mov_b32 s75, 0
    s_mov_b32 s76, 0
    s_mov_b32 s77, 0
    s_mov_b32 s78, 0
    s_mov_b32 s79, 0
    s_mov_b32 s80, 0
    s_mov_b32 s81, 0
    s_waitcnt vmcnt(0) lgkmcnt(0)
    s_barrier
.chain1_kernel_step:
    s_add_u32 s63, s62, 65
    v_mov_b32 v125, s63
    s_and_b32 s64, s62, 1
    s_mul_i32 s65, s64, 393216
    s_mul_i32 s66, s64, 524288
    s_add_u32 s66, s66, 786432
    s_mul_i32 s67, s64, 262144
    s_add_u32 s67, s67, 1835008
    ds_read_b128 v[16:19], v111 offset:0
    ds_read_b128 v[20:23], v111 offset:64
    ds_read_b128 v[24:27], v111 offset:128
    ds_read_b128 v[28:31], v111 offset:192
    ds_read_b128 v[32:35], v111 offset:256
    ds_read_b128 v[36:39], v111 offset:320
    ds_read_b128 v[40:43], v111 offset:384
    ds_read_b128 v[44:47], v111 offset:448
    v_mov_b32 v48, 0
    v_mov_b32 v49, 0
    v_mov_b32 v50, 0
    v_mov_b32 v51, 0
    v_mov_b32 v52, 0
    v_mov_b32 v53, 0
    v_mov_b32 v54, 0
    v_mov_b32 v55, 0
    v_mov_b32 v56, 0
    v_mov_b32 v57, 0
    v_mov_b32 v58, 0
    v_mov_b32 v59, 0
    s_waitcnt lgkmcnt(7)
    v_mfma_f32_16x16x32_bf16 v[48:51], v[128:131], v[16:19], v[48:51]
    v_mfma_f32_16x16x32_bf16 v[52:55], v[160:163], v[16:19], v[52:55]
    v_mfma_f32_16x16x32_bf16 v[56:59], v[192:195], v[16:19], v[56:59]
    s_waitcnt lgkmcnt(6)
    v_mfma_f32_16x16x32_bf16 v[48:51], v[132:135], v[20:23], v[48:51]
    v_mfma_f32_16x16x32_bf16 v[52:55], v[164:167], v[20:23], v[52:55]
    v_mfma_f32_16x16x32_bf16 v[56:59], v[196:199], v[20:23], v[56:59]
    s_waitcnt lgkmcnt(5)
    v_mfma_f32_16x16x32_bf16 v[48:51], v[136:139], v[24:27], v[48:51]
    v_mfma_f32_16x16x32_bf16 v[52:55], v[168:171], v[24:27], v[52:55]
    v_mfma_f32_16x16x32_bf16 v[56:59], v[200:203], v[24:27], v[56:59]
    s_waitcnt lgkmcnt(4)
    v_mfma_f32_16x16x32_bf16 v[48:51], v[140:143], v[28:31], v[48:51]
    v_mfma_f32_16x16x32_bf16 v[52:55], v[172:175], v[28:31], v[52:55]
    v_mfma_f32_16x16x32_bf16 v[56:59], v[204:207], v[28:31], v[56:59]
    s_waitcnt lgkmcnt(3)
    v_mfma_f32_16x16x32_bf16 v[48:51], v[144:147], v[32:35], v[48:51]
    v_mfma_f32_16x16x32_bf16 v[52:55], v[176:179], v[32:35], v[52:55]
    v_mfma_f32_16x16x32_bf16 v[56:59], v[208:211], v[32:35], v[56:59]
    s_waitcnt lgkmcnt(2)
    v_mfma_f32_16x16x32_bf16 v[48:51], v[148:151], v[36:39], v[48:51]
    v_mfma_f32_16x16x32_bf16 v[52:55], v[180:183], v[36:39], v[52:55]
    v_mfma_f32_16x16x32_bf16 v[56:59], v[212:215], v[36:39], v[56:59]
    s_waitcnt lgkmcnt(1)
    v_mfma_f32_16x16x32_bf16 v[48:51], v[152:155], v[40:43], v[48:51]
    v_mfma_f32_16x16x32_bf16 v[52:55], v[184:187], v[40:43], v[52:55]
    v_mfma_f32_16x16x32_bf16 v[56:59], v[216:219], v[40:43], v[56:59]
    s_waitcnt lgkmcnt(0)
    v_mfma_f32_16x16x32_bf16 v[48:51], v[156:159], v[44:47], v[48:51]
    v_mfma_f32_16x16x32_bf16 v[52:55], v[188:191], v[44:47], v[52:55]
    v_mfma_f32_16x16x32_bf16 v[56:59], v[220:223], v[44:47], v[56:59]
    s_nop 7
    s_nop 1
    ds_write_b128 v112, v[48:51] offset:0
    ds_write_b128 v112, v[52:55] offset:1024
    ds_write_b128 v112, v[56:59] offset:2048
    s_waitcnt lgkmcnt(0)
    s_barrier
    v_cmp_gt_u32 vcc, 192, v0
    s_and_saveexec_b64 s[42:43], vcc
    s_cbranch_execz .sk_20
    ds_read_b64 v[16:17], v113 offset:0
    ds_read_b64 v[18:19], v113 offset:3072
    ds_read_b64 v[20:21], v113 offset:6144
    ds_read_b64 v[22:23], v113 offset:9216
    s_waitcnt lgkmcnt(0)
    v_add_f32 v16, v16, v18
    v_add_f32 v17, v17, v19
    v_add_f32 v20, v20, v22
    v_add_f32 v21, v21, v23
    v_add_f32 v16, v16, v20
    v_add_f32 v17, v17, v21
    v_cvt_pk_bf16_f32 v16, v16, v17
    v_mov_b32 v17, v125
    s_cmp_eq_u32 s68, 1
    s_cbranch_scc0 .ls_21
    buffer_store_dwordx2 v[16:17], v114, s[8:11], s65 offen
    s_branch .le_22
.ls_21:
    buffer_store_dwordx2 v[16:17], v114, s[8:11], s65 offen sc1
.le_22:
    v_cmp_le_u32 vcc, 64, v0
    s_and_b64 exec, exec, vcc
    s_mul_i32 s3, s62, 131072
    buffer_store_dword v16, v115, s[16:19], s3 offen
.sk_20:
    s_mov_b64 exec, s[42:43]
    s_mul_i32 s31, s22, 12288
    s_add_u32 s31, s31, s65
    s_add_u32 s32, s31, 4096
    s_add_u32 s33, s31, 8192
    s_mov_b32 s30, 0
.poll_23:
    buffer_load_dwordx4 v[16:19], v109, s[8:11], s31 offen offset:0 sc1
    buffer_load_dwordx4 v[20:23], v109, s[8:11], s31 offen offset:1024 sc1
    buffer_load_dwordx4 v[24:27], v109, s[8:11], s31 offen offset:2048 sc1
    buffer_load_dwordx4 v[28:31], v109, s[8:11], s31 offen offset:3072 sc1
    buffer_load_dwordx4 v[32:35], v109, s[8:11], s32 offen offset:0 sc1
    buffer_load_dwordx4 v[36:39], v109, s[8:11], s32 offen offset:1024 sc1
    buffer_load_dwordx4 v[40:43], v109, s[8:11], s32 offen offset:2048 sc1
    buffer_load_dwordx4 v[44:47], v109, s[8:11], s32 offen offset:3072 sc1
    buffer_load_dwordx4 v[48:51], v109, s[8:11], s33 offen offset:0 sc1
    buffer_load_dwordx4 v[52:55], v109, s[8:11], s33 offen offset:1024 sc1
    buffer_load_dwordx4 v[56:59], v109, s[8:11], s33 offen offset:2048 sc1
    buffer_load_dwordx4 v[60:63], v109, s[8:11], s33 offen offset:3072 sc1
    s_waitcnt vmcnt(0)
    v_cmp_eq_u32 vcc, v17, v125
    v_cmp_eq_u32 s[40:41], v19, v125
    s_and_b64 vcc, vcc, s[40:41]
    v_cmp_eq_u32 s[40:41], v21, v125
    s_and_b64 vcc, vcc, s[40:41]
    v_cmp_eq_u32 s[40:41], v23, v125
    s_and_b64 vcc, vcc, s[40:41]
    v_cmp_eq_u32 s[40:41], v25, v125
    s_and_b64 vcc, vcc, s[40:41]
    v_cmp_eq_u32 s[40:41], v27, v125
    s_and_b64 vcc, vcc, s[40:41]
    v_cmp_eq_u32 s[40:41], v29, v125
    s_and_b64 vcc, vcc, s[40:41]
    v_cmp_eq_u32 s[40:41], v31, v125
    s_and_b64 vcc, vcc, s[40:41]
    v_cmp_eq_u32 s[40:41], v33, v125
    s_and_b64 vcc, vcc, s[40:41]
    v_cmp_eq_u32 s[40:41], v35, v125
    s_and_b64 vcc, vcc, s[40:41]
    v_cmp_eq_u32 s[40:41], v37, v125
    s_and_b64 vcc, vcc, s[40:41]
    v_cmp_eq_u32 s[40:41], v39, v125
    s_and_b64 vcc, vcc, s[40:41]
    v_cmp_eq_u32 s[40:41], v41, v125
    s_and_b64 vcc, vcc, s[40:41]
    v_cmp_eq_u32 s[40:41], v43, v125
    s_and_b64 vcc, vcc, s[40:41]
    v_cmp_eq_u32 s[40:41], v45, v125
    s_and_b64 vcc, vcc, s[40:41]
    v_cmp_eq_u32 s[40:41], v47, v125
    s_and_b64 vcc, vcc, s[40:41]
    v_cmp_eq_u32 s[40:41], v49, v125
    s_and_b64 vcc, vcc, s[40:41]
    v_cmp_eq_u32 s[40:41], v51, v125
    s_and_b64 vcc, vcc, s[40:41]
    v_cmp_eq_u32 s[40:41], v53, v125
    s_and_b64 vcc, vcc, s[40:41]
    v_cmp_eq_u32 s[40:41], v55, v125
    s_and_b64 vcc, vcc, s[40:41]
    v_cmp_eq_u32 s[40:41], v57, v125
    s_and_b64 vcc, vcc, s[40:41]
    v_cmp_eq_u32 s[40:41], v59, v125
    s_and_b64 vcc, vcc, s[40:41]
    v_cmp_eq_u32 s[40:41], v61, v125
    s_and_b64 vcc, vcc, s[40:41]
    v_cmp_eq_u32 s[40:41], v63, v125
    s_and_b64 vcc, vcc, s[40:41]
    s_cmp_eq_u64 vcc, exec
    s_cbranch_scc1 .pok_24
    s_add_u32 s30, s30, 1
    s_cmp_lt_u32 s30, 0x40000
    s_cbranch_scc1 .poll_23
.pok_24:
    v_mov_b32 v17, v18
    ds_write_b64 v100, v[16:17] offset:0
    v_mov_b32 v21, v22
    ds_write_b64 v101, v[20:21] offset:0
    v_mov_b32 v25, v26
    ds_write_b64 v102, v[24:25] offset:0
    v_mov_b32 v29, v30
    ds_write_b64 v103, v[28:29] offset:0
    v_mov_b32 v33, v34
    ds_write_b64 v100, v[32:33] offset:2048
    v_mov_b32 v37, v38
    ds_write_b64 v101, v[36:37] offset:2048
    v_mov_b32 v41, v42
    ds_write_b64 v102, v[40:41] offset:2048
    v_mov_b32 v45, v46
    ds_write_b64 v103, v[44:45] offset:2048
    v_mov_b32 v49, v50
    ds_write_b64 v100, v[48:49] offset:14336
    v_mov_b32 v53, v54
    ds_write_b64 v101, v[52:53] offset:14336
    v_mov_b32 v57, v58
    ds_write_b64 v102, v[56:57] offset:14336
    v_mov_b32 v61, v62
    ds_write_b64 v103, v[60:61] offset:14336
    s_waitcnt lgkmcnt(0)
    ds_read_b128 v[16:19], v120 offset:0
    ds_read_b128 v[20:23], v121 offset:0
    ds_read_b128 v[24:27], v122 offset:0
    ds_read_b128 v[28:31], v123 offset:0
    ds_read_b128 v[44:47], v116 offset:2048
    ds_read_b128 v[48:51], v117 offset:2048
    ds_read_b128 v[52:55], v118 offset:2048
    ds_read_b128 v[56:59], v119 offset:2048
    ds_read_b128 v[60:63], v116 offset:6144
    ds_read_b128 v[64:67], v117 offset:6144
    ds_read_b128 v[68:71], v118 offset:6144
    ds_read_b128 v[72:75], v119 offset:6144
    ds_read_b128 v[76:79], v116 offset:10240
    ds_read_b128 v[80:83], v117 offset:10240
    ds_read_b128 v[84:87], v118 offset:10240
    ds_read_b128 v[88:91], v119 offset:10240
    v_mov_b32 v32, 0
    v_mov_b32 v33, 0
    v_mov_b32 v34, 0
    v_mov_b32 v35, 0
    v_mov_b32 v36, 0
    v_mov_b32 v37, 0
    v_mov_b32 v38, 0
    v_mov_b32 v39, 0
    v_mov_b32 v40, 0
    v_mov_b32 v41, 0
    v_mov_b32 v42, 0
    v_mov_b32 v43, 0
    s_waitcnt lgkmcnt(0)
    v_mfma_f32_16x16x32_bf16 v[32:35], v[44:47], v[16:19], v[32:35]
    v_mfma_f32_16x16x32_bf16 v[36:39], v[60:63], v[16:19], v[36:39]
    v_mfma_f32_16x16x32_bf16 v[40:43], v[76:79], v[16:19], v[40:43]
    v_mfma_f32_16x16x32_bf16 v[32:35], v[48:51], v[20:23], v[32:35]
    v_mfma_f32_16x16x32_bf16 v[36:39], v[64:67], v[20:23], v[36:39]
    v_mfma_f32_16x16x32_bf16 v[40:43], v[80:83], v[20:23], v[40:43]
    v_mfma_f32_16x16x32_bf16 v[32:35], v[52:55], v[24:27], v[32:35]
    v_mfma_f32_16x16x32_bf16 v[36:39], v[68:71], v[24:27], v[36:39]
    v_mfma_f32_16x16x32_bf16 v[40:43], v[84:87], v[24:27], v[40:43]
    v_mfma_f32_16x16x32_bf16 v[32:35], v[56:59], v[28:31], v[32:35]
    v_mfma_f32_16x16x32_bf16 v[36:39], v[72:75], v[28:31], v[36:39]
    v_mfma_f32_16x16x32_bf16 v[40:43], v[88:91], v[28:31], v[40:43]
    s_nop 7
    s_nop 1
    v_xor_b32 v24, 0, v108
    ds_read_b64_tr_b16 v[44:45], v24 offset:14336
    ds_read_b64_tr_b16 v[46:47], v24 offset:18432
    ds_read_b64_tr_b16 v[48:49], v24 offset:22528
    v_xor_b32 v24, 32, v108
    ds_read_b64_tr_b16 v[50:51], v24 offset:14336
    ds_read_b64_tr_b16 v[52:53], v24 offset:18432
    ds_read_b64_tr_b16 v[54:55], v24 offset:22528
    v_xor_b32 v24, 64, v108
    ds_read_b64_tr_b16 v[56:57], v24 offset:14336
    ds_read_b64_tr_b16 v[58:59], v24 offset:18432
    ds_read_b64_tr_b16 v[60:61], v24 offset:22528
    v_xor_b32 v24, 96, v108
    ds_read_b64_tr_b16 v[62:63], v24 offset:14336
    ds_read_b64_tr_b16 v[64:65], v24 offset:18432
    ds_read_b64_tr_b16 v[66:67], v24 offset:22528
    v_xor_b32 v24, 128, v108
    ds_read_b64_tr_b16 v[68:69], v24 offset:14336
    ds_read_b64_tr_b16 v[70:71], v24 offset:18432
    ds_read_b64_tr_b16 v[72:73], v24 offset:22528
    v_xor_b32 v24, 160, v108
    ds_read_b64_tr_b16 v[74:75], v24 offset:14336
    ds_read_b64_tr_b16 v[76:77], v24 offset:18432
    ds_read_b64_tr_b16 v[78:79], v24 offset:22528
    v_xor_b32 v24, 192, v108
    ds_read_b64_tr_b16 v[80:81], v24 offset:14336
    ds_read_b64_tr_b16 v[82:83], v24 offset:18432
    ds_read_b64_tr_b16 v[84:85], v24 offset:22528
    v_xor_b32 v24, 224, v108
    ds_read_b64_tr_b16 v[86:87], v24 offset:14336
    ds_read_b64_tr_b16 v[88:89], v24 offset:18432
    ds_read_b64_tr_b16 v[90:91], v24 offset:22528
    v_cmp_le_u32 vcc, 2, v4
    v_mov_b32 v30, 0xff800000
    s_nop 0
    v_cndmask_b32 v40, v40, v30, vcc
    v_cndmask_b32 v41, v41, v30, vcc
    v_cndmask_b32 v42, v42, v30, vcc
    v_cndmask_b32 v43, v43, v30, vcc
    v_max_f32 v30, v32, v33
    v_max_f32 v30, v30, v34
    v_max_f32 v30, v30, v35
    v_max_f32 v30, v30, v36
    v_max_f32 v30, v30, v37
    v_max_f32 v30, v30, v38
    v_max_f32 v30, v30, v39
    v_max_f32 v30, v30, v40
    v_max_f32 v30, v30, v41
    v_max_f32 v30, v30, v42
    v_max_f32 v30, v30, v43
    ds_swizzle_b32 v31, v30 offset:0x401f
    s_waitcnt lgkmcnt(0)
    v_max_f32 v30, v30, v31
    v_mov_b32 v31, v30
    s_nop 1
    v_permlane32_swap_b32 v30, v31
    s_nop 1
    v_max_f32 v30, v30, v31
    v_mul_f32 v31, 0xbe0293ee, v30
    s_mov_b32 s3, 0x3e0293ee
    v_fma_f32 v32, v32, s3, v31
    v_exp_f32 v32, v32
    v_fma_f32 v33, v33, s3, v31
    v_exp_f32 v33, v33
    v_fma_f32 v34, v34, s3, v31
    v_exp_f32 v34, v34
    v_fma_f32 v35, v35, s3, v31
    v_exp_f32 v35, v35
    v_fma_f32 v36, v36, s3, v31
    v_exp_f32 v36, v36
    v_fma_f32 v37, v37, s3, v31
    v_exp_f32 v37, v37
    v_fma_f32 v38, v38, s3, v31
    v_exp_f32 v38, v38
    v_fma_f32 v39, v39, s3, v31
    v_exp_f32 v39, v39
    v_fma_f32 v40, v40, s3, v31
    v_exp_f32 v40, v40
    v_fma_f32 v41, v41, s3, v31
    v_exp_f32 v41, v41
    v_fma_f32 v42, v42, s3, v31
    v_exp_f32 v42, v42
    v_fma_f32 v43, v43, s3, v31
    v_exp_f32 v43, v43
    s_nop 0
    v_add_f32 v30, v32, v33
    v_add_f32 v30, v30, v34
    v_add_f32 v30, v30, v35
    v_add_f32 v30, v30, v36
    v_add_f32 v30, v30, v37
    v_add_f32 v30, v30, v38
    v_add_f32 v30, v30, v39
    v_add_f32 v30, v30, v40
    v_add_f32 v30, v30, v41
    v_add_f32 v30, v30, v42
    v_add_f32 v30, v30, v43
    ds_swizzle_b32 v31, v30 offset:0x401f
    s_waitcnt lgkmcnt(0)
    v_add_f32 v30, v30, v31
    v_mov_b32 v31, v30
    s_nop 1
    v_permlane32_swap_b32 v30, v31
    s_nop 1
    v_add_f32 v30, v30, v31
    v_rcp_f32 v30, v30
    s_nop 0
    v_mul_f32 v32, v32, v30
    v_mul_f32 v33, v33, v30
    v_mul_f32 v34, v34, v30
    v_mul_f32 v35, v35, v30
    v_mul_f32 v36, v36, v30
    v_mul_f32 v37, v37, v30
    v_mul_f32 v38, v38, v30
    v_mul_f32 v39, v39, v30
    v_mul_f32 v40, v40, v30
    v_mul_f32 v41, v41, v30
    v_mul_f32 v42, v42, v30
    v_mul_f32 v43, v43, v30
    v_cvt_pk_bf16_f32 v16, v32, v33
    v_cvt_pk_bf16_f32 v17, v34, v35
    v_cvt_pk_bf16_f32 v18, v36, v37
    v_cvt_pk_bf16_f32 v19, v38, v39
    v_cvt_pk_bf16_f32 v20, v40, v41
    v_cvt_pk_bf16_f32 v21, v42, v43
    s_waitcnt lgkmcnt(0)
    v_mfma_f32_16x16x32_bf16 v[24:27], v[44:47], v[16:19], 0
    v_mfma_f32_16x16x32_bf16 v[28:31], v[50:53], v[16:19], 0
    v_mfma_f32_16x16x32_bf16 v[32:35], v[56:59], v[16:19], 0
    v_mfma_f32_16x16x32_bf16 v[36:39], v[62:65], v[16:19], 0
    v_mfma_f32_16x16x16_bf16 v[24:27], v[48:49], v[20:21], v[24:27]
    v_mfma_f32_16x16x16_bf16 v[28:31], v[54:55], v[20:21], v[28:31]
    v_mfma_f32_16x16x16_bf16 v[32:35], v[60:61], v[20:21], v[32:35]
    v_mfma_f32_16x16x16_bf16 v[36:39], v[66:67], v[20:21], v[36:39]
    s_nop 7
    s_nop 1
    v_cvt_pk_bf16_f32 v44, v24, v25
    v_cvt_pk_bf16_f32 v45, v26, v27
    v_cvt_pk_bf16_f32 v50, v28, v29
    v_cvt_pk_bf16_f32 v51, v30, v31
    v_cvt_pk_bf16_f32 v56, v32, v33
    v_cvt_pk_bf16_f32 v57, v34, v35
    v_cvt_pk_bf16_f32 v62, v36, v37
    v_cvt_pk_bf16_f32 v63, v38, v39
    v_mfma_f32_16x16x32_bf16 v[24:27], v[68:71], v[16:19], 0
    v_mfma_f32_16x16x32_bf16 v[28:31], v[74:77], v[16:19], 0
    v_mfma_f32_16x16x32_bf16 v[32:35], v[80:83], v[16:19], 0
    v_mfma_f32_16x16x32_bf16 v[36:39], v[86:89], v[16:19], 0
    v_mfma_f32_16x16x16_bf16 v[24:27], v[72:73], v[20:21], v[24:27]
    v_mfma_f32_16x16x16_bf16 v[28:31], v[78:79], v[20:21], v[28:31]
    v_mfma_f32_16x16x16_bf16 v[32:35], v[84:85], v[20:21], v[32:35]
    v_mfma_f32_16x16x16_bf16 v[36:39], v[90:91], v[20:21], v[36:39]
    s_nop 7
    s_nop 1
    v_cvt_pk_bf16_f32 v68, v24, v25
    v_cvt_pk_bf16_f32 v69, v26, v27
    v_cvt_pk_bf16_f32 v74, v28, v29
    v_cvt_pk_bf16_f32 v75, v30, v31
    v_cvt_pk_bf16_f32 v80, v32, v33
    v_cvt_pk_bf16_f32 v81, v34, v35
    v_cvt_pk_bf16_f32 v86, v36, v37
    v_cvt_pk_bf16_f32 v87, v38, v39
    v_mov_b32 v24, v44
    v_mov_b32 v25, v45
    v_mov_b32 v26, v50
    v_mov_b32 v27, v51
    v_mov_b32 v28, v56
    v_mov_b32 v29, v57
    v_mov_b32 v30, v62
    v_mov_b32 v31, v63
    v_mov_b32 v32, v68
    v_mov_b32 v33, v69
    v_mov_b32 v34, v74
    v_mov_b32 v35, v75
    v_mov_b32 v36, v80
    v_mov_b32 v37, v81
    v_mov_b32 v38, v86
    v_mov_b32 v39, v87
    s_nop 1
    v_mfma_f32_16x16x32_bf16 v[16:19], v[224:227], v[24:27], 0
    v_mfma_f32_16x16x32_bf16 v[20:23], v[240:243], v[24:27], 0
    v_mfma_f32_16x16x32_bf16 v[16:19], v[228:231], v[28:31], v[16:19]
    v_mfma_f32_16x16x32_bf16 v[20:23], v[244:247], v[28:31], v[20:23]
    v_mfma_f32_16x16x32_bf16 v[16:19], v[232:235], v[32:35], v[16:19]
    v_mfma_f32_16x16x32_bf16 v[20:23], v[248:251], v[32:35], v[20:23]
    v_mfma_f32_16x16x32_bf16 v[16:19], v[236:239], v[36:39], v[16:19]
    v_mfma_f32_16x16x32_bf16 v[20:23], v[252:255], v[36:39], v[20:23]
    s_nop 7
    s_nop 1
    ds_write_b128 v97, v[16:19] offset:0
    ds_write_b128 v97, v[20:23] offset:1024
    s_waitcnt lgkmcnt(0)
    s_barrier
    ds_read_b32 v16, v98 offset:0
    ds_read_b32 v17, v98 offset:2048
    ds_read_b32 v18, v98 offset:4096
    ds_read_b32 v19, v98 offset:6144
    s_waitcnt lgkmcnt(0)
    v_add_f32 v16, v16, v17
    v_add_f32 v18, v18, v19
    v_add_f32 v16, v16, v18
    v_mov_b32 v17, v125
    buffer_store_dwordx2 v[16:17], v99, s[8:11], s66 offen sc1
    s_cmp_eq_u32 s62, 63
    s_cbranch_scc1 .np_25
    s_add_u32 s62, s62, 1
    s_mul_i32 s3, s62, 786432
    s_lshl_b32 s60, s22, 8
    s_add_u32 s3, s3, s60
    s_add_u32 s60, s21, 4096
    s_mov_b32 m0, s60
    s_add_u32 s61, s3, 8192
    buffer_load_dwordx4 v106, s[12:15], s61 offen lds
    s_add_u32 s60, s21, 5120
    s_mov_b32 m0, s60
    s_add_u32 s61, s3, 106496
    buffer_load_dwordx4 v107, s[12:15], s61 offen lds
    s_add_u32 s60, s21, 6144
    s_mov_b32 m0, s60
    s_add_u32 s61, s3, 204800
    buffer_load_dwordx4 v104, s[12:15], s61 offen lds
    s_add_u32 s60, s21, 7168
    s_mov_b32 m0, s60
    s_add_u32 s61, s3, 303104
    buffer_load_dwordx4 v105, s[12:15], s61 offen lds
    s_add_u32 s60, s21, 8192
    s_mov_b32 m0, s60
    s_add_u32 s61, s3, 401408
    buffer_load_dwordx4 v106, s[12:15], s61 offen lds
    s_add_u32 s60, s21, 9216
    s_mov_b32 m0, s60
    s_add_u32 s61, s3, 499712
    buffer_load_dwordx4 v107, s[12:15], s61 offen lds
    s_add_u32 s60, s21, 10240
    s_mov_b32 m0, s60
    s_add_u32 s61, s3, 598016
    buffer_load_dwordx4 v104, s[12:15], s61 offen lds
    s_add_u32 s60, s21, 11264
    s_mov_b32 m0, s60
    s_add_u32 s61, s3, 696320
    buffer_load_dwordx4 v105, s[12:15], s61 offen lds
    s_add_u32 s60, s21, 16384
    s_mov_b32 m0, s60
    s_add_u32 s61, s3, 16384
    buffer_load_dwordx4 v106, s[12:15], s61 offen lds
    s_add_u32 s60, s21, 17408
    s_mov_b32 m0, s60
    s_add_u32 s61, s3, 114688
    buffer_load_dwordx4 v107, s[12:15], s61 offen lds
    s_add_u32 s60, s21, 18432
    s_mov_b32 m0, s60
    s_add_u32 s61, s3, 212992
    buffer_load_dwordx4 v104, s[12:15], s61 offen lds
    s_add_u32 s60, s21, 19456
    s_mov_b32 m0, s60
    s_add_u32 s61, s3, 311296
    buffer_load_dwordx4 v105, s[12:15], s61 offen lds
    s_add_u32 s60, s21, 20480
    s_mov_b32 m0, s60
    s_add_u32 s61, s3, 409600
    buffer_load_dwordx4 v106, s[12:15], s61 offen lds
    s_add_u32 s60, s21, 21504
    s_mov_b32 m0, s60
    s_add_u32 s61, s3, 507904
    buffer_load_dwordx4 v107, s[12:15], s61 offen lds
    s_add_u32 s60, s21, 22528
    s_mov_b32 m0, s60
    s_add_u32 s61, s3, 606208
    buffer_load_dwordx4 v104, s[12:15], s61 offen lds
    s_add_u32 s60, s21, 23552
    s_mov_b32 m0, s60
    s_add_u32 s61, s3, 704512
    buffer_load_dwordx4 v105, s[12:15], s61 offen lds
    s_sub_u32 s62, s62, 1
.np_25:
    s_add_u32 s31, s66, 0
    s_add_u32 s32, s66, 65536
    s_add_u32 s33, s66, 131072
    s_add_u32 s34, s66, 196608
    s_add_u32 s35, s66, 262144
    s_add_u32 s36, s66, 327680
    s_add_u32 s37, s66, 393216
    s_add_u32 s38, s66, 458752
    s_mov_b32 s30, 0
.poll_26:
    buffer_load_dwordx2 v[16:17], v96, s[8:11], s31 offen sc1
    buffer_load_dwordx2 v[18:19], v96, s[8:11], s32 offen sc1
    buffer_load_dwordx2 v[20:21], v96, s[8:11], s33 offen sc1
    buffer_load_dwordx2 v[22:23], v96, s[8:11], s34 offen sc1
    buffer_load_dwordx2 v[24:25], v96, s[8:11], s35 offen sc1
    buffer_load_dwordx2 v[26:27], v96, s[8:11], s36 offen sc1
    buffer_load_dwordx2 v[28:29], v96, s[8:11], s37 offen sc1
    buffer_load_dwordx2 v[30:31], v96, s[8:11], s38 offen sc1
    s_waitcnt vmcnt(0)
    v_cmp_eq_u32 vcc, v17, v125
    v_cmp_eq_u32 s[40:41], v19, v125
    s_and_b64 vcc, vcc, s[40:41]
    v_cmp_eq_u32 s[40:41], v21, v125
    s_and_b64 vcc, vcc, s[40:41]
    v_cmp_eq_u32 s[40:41], v23, v125
    s_and_b64 vcc, vcc, s[40:41]
    v_cmp_eq_u32 s[40:41], v25, v125
    s_and_b64 vcc, vcc, s[40:41]
    v_cmp_eq_u32 s[40:41], v27, v125
    s_and_b64 vcc, vcc, s[40:41]
    v_cmp_eq_u32 s[40:41], v29, v125
    s_and_b64 vcc, vcc, s[40:41]
    v_cmp_eq_u32 s[40:41], v31, v125
    s_and_b64 vcc, vcc, s[40:41]
    s_cmp_eq_u64 vcc, exec
    s_cbranch_scc1 .pok_27
    s_add_u32 s30, s30, 1
    s_cmp_lt_u32 s30, 0x40000
    s_cbranch_scc1 .poll_26
.pok_27:
    v_add_f32 v16, v16, v18
    v_add_f32 v20, v20, v22
    v_add_f32 v24, v24, v26
    v_add_f32 v28, v28, v30
    v_add_f32 v16, v16, v20
    v_add_f32 v24, v24, v28
    v_add_f32 v16, v16, v24
    ds_swizzle_b32 v17, v16 offset:0x041f
    s_waitcnt lgkmcnt(0)
    v_cvt_pk_bf16_f32 v16, v16, v17
    v_mov_b32 v17, v125
    v_and_b32 v18, 1, v0
    v_cmp_eq_u32 vcc, 0, v18
    s_and_saveexec_b64 s[42:43], vcc
    s_cmp_eq_u32 s68, 1
    s_cbranch_scc0 .ls_28
    buffer_store_dwordx2 v[16:17], v95, s[8:11], s67 offen
    s_branch .le_29
.ls_28:
    buffer_store_dwordx2 v[16:17], v95, s[8:11], s67 offen sc1
.le_29:
    s_mov_b64 exec, s[42:43]
    s_cmp_eq_u32 s62, 63
    s_cbranch_scc1 .chain1_kernel_fin
    s_lshl_b32 s60, s24, 15
    s_add_u32 s60, s60, s67
    s_add_u32 s31, s60, 0
    s_add_u32 s32, s60, 4096
    s_add_u32 s33, s60, 8192
    s_add_u32 s34, s60, 12288
    s_add_u32 s35, s60, 16384
    s_add_u32 s36, s60, 20480
    s_add_u32 s37, s60, 24576
    s_add_u32 s38, s60, 28672
    s_mov_b32 s30, 0
.poll_30:
    buffer_load_dwordx4 v[16:19], v110, s[8:11], s31 offen sc1
    buffer_load_dwordx4 v[20:23], v110, s[8:11], s32 offen sc1
    buffer_load_dwordx4 v[24:27], v110, s[8:11], s33 offen sc1
    buffer_load_dwordx4 v[28:31], v110, s[8:11], s34 offen sc1
    buffer_load_dwordx4 v[32:35], v110, s[8:11], s35 offen sc1
    buffer_load_dwordx4 v[36:39], v110, s[8:11], s36 offen sc1
    buffer_load_dwordx4 v[40:43], v110, s[8:11], s37 offen sc1
    buffer_load_dwordx4 v[44:47], v110, s[8:11], s38 offen sc1
    s_waitcnt vmcnt(0)
    v_cmp_eq_u32 vcc, v17, v125
    v_cmp_eq_u32 s[40:41], v19, v125
    s_and_b64 vcc, vcc, s[40:41]
    v_cmp_eq_u32 s[40:41], v21, v125
    s_and_b64 vcc, vcc, s[40:41]
    v_cmp_eq_u32 s[40:41], v23, v125
    s_and_b64 vcc, vcc, s[40:41]
    v_cmp_eq_u32 s[40:41], v25, v125
    s_and_b64 vcc, vcc, s[40:41]
    v_cmp_eq_u32 s[40:41], v27, v125
    s_and_b64 vcc, vcc, s[40:41]
    v_cmp_eq_u32 s[40:41], v29, v125
    s_and_b64 vcc, vcc, s[40:41]
    v_cmp_eq_u32 s[40:41], v31, v125
    s_and_b64 vcc, vcc, s[40:41]
    v_cmp_eq_u32 s[40:41], v33, v125
    s_and_b64 vcc, vcc, s[40:41]
    v_cmp_eq_u32 s[40:41], v35, v125
    s_and_b64 vcc, vcc, s[40:41]
    v_cmp_eq_u32 s[40:41], v37, v125
    s_and_b64 vcc, vcc, s[40:41]
    v_cmp_eq_u32 s[40:41], v39, v125
    s_and_b64 vcc, vcc, s[40:41]
    v_cmp_eq_u32 s[40:41], v41, v125
    s_and_b64 vcc, vcc, s[40:41]
    v_cmp_eq_u32 s[40:41], v43, v125
    s_and_b64 vcc, vcc, s[40:41]
    v_cmp_eq_u32 s[40:41], v45, v125
    s_and_b64 vcc, vcc, s[40:41]
    v_cmp_eq_u32 s[40:41], v47, v125
    s_and_b64 vcc, vcc, s[40:41]
    s_cmp_eq_u64 vcc, exec
    s_cbranch_scc1 .pok_31
    s_add_u32 s30, s30, 1
    s_cmp_lt_u32 s30, 0x40000
    s_cbranch_scc1 .poll_30
.pok_31:
    v_mov_b32 v17, v18
    ds_write_b64 v124, v[16:17] offset:0
    v_mov_b32 v21, v22
    ds_write_b64 v124, v[20:21] offset:2064
    v_mov_b32 v25, v26
    ds_write_b64 v124, v[24:25] offset:4128
    v_mov_b32 v29, v30
    ds_write_b64 v124, v[28:29] offset:6192
    v_mov_b32 v33, v34
    ds_write_b64 v124, v[32:33] offset:8256
    v_mov_b32 v37, v38
    ds_write_b64 v124, v[36:37] offset:10320
    v_mov_b32 v41, v42
    ds_write_b64 v124, v[40:41] offset:12384
    v_mov_b32 v45, v46
    ds_write_b64 v124, v[44:45] offset:14448
    s_waitcnt lgkmcnt(0)
    s_barrier
    s_add_u32 s62, s62, 1
    s_branch .chain1_kernel_step
.chain1_kernel_fin:
.chain1_kernel_done:
    s_endpgm
.section .rodata,"a"
.p2align 6
.amdhsa_kernel chain1_kernel
  .amdhsa_next_free_vgpr 256
  .amdhsa_next_free_sgpr 96
  .amdhsa_accum_offset 256
  .amdhsa_group_segment_fixed_size 0
  .amdhsa_kernarg_size 120
  .amdhsa_user_sgpr_count 2
  .amdhsa_user_sgpr_kernarg_segment_ptr 1
  .amdhsa_system_sgpr_workgroup_id_x 1
.end_amdhsa_kernel
.text
.globl attn_kernel
.p2align 8
.type attn_kernel,@function
attn_kernel:
    s_cmp_ge_u32 s2, 512
    s_cbranch_scc1 .attn_kernel_done
    s_load_dwordx2 s[4:5], s[0:1], 112
    v_and_b32 v1, 63, v0
    v_lshrrev_b32 v2, 6, v0
    v_and_b32 v3, 15, v1
    v_lshrrev_b32 v4, 4, v1
    s_nop 0
    v_readfirstlane_b32 s58, v2
    s_lshr_b32 s59, s2, 3
    s_and_b32 s60, s2, 7
    s_lshl_b32 s60, s60, 2
    s_add_u32 s60, s60, s58
    s_waitcnt lgkmcnt(0)
    s_add_u32 s6, s4, 0x1000000
    s_addc_u32 s7, s5, 0
    s_mov_b32 s12, s6
    s_and_b32 s13, s7, 0xffff
    s_mov_b32 s14, 0x3000000
    s_mov_b32 s15, 0x00020000
    s_add_u32 s6, s4, 0x6000000
    s_addc_u32 s7, s5, 0
    s_mov_b32 s16, s6
    s_and_b32 s17, s7, 0xffff
    s_mov_b32 s18, 0x800000
    s_mov_b32 s19, 0x00020000
    s_add_u32 s6, s4, 0x4000000
    s_addc_u32 s7, s5, 0
    s_mov_b32 s20, s6
    s_and_b32 s21, s7, 0xffff
    s_mov_b32 s22, 0x1000000
    s_mov_b32 s23, 0x00020000
    s_mul_i32 s61, s58, 26112
    v_lshlrev_b32 v5, 13, v4
    v_lshl_add_u32 v5, v3, 4, v5
    s_mov_b32 s3, 24576
    v_mul_lo_u32 v6, v4, s3
    v_lshl_add_u32 v6, v3, 4, v6
    v_mul_u32_u24 v7, 272, v4
    v_lshl_add_u32 v7, v3, 4, v7
    v_add_u32 v7, s61, v7
    s_lshl_b32 s62, s59, 17
    s_lshl_b32 s63, s60, 8
    s_add_u32 s62, s62, s63
    s_mul_i32 s64, s59, 786432
    s_add_u32 s64, s64, s63
    s_add_u32 s3, s62, 0
    buffer_load_dwordx4 v[64:67], v5, s[16:19], s3 offen
    s_add_u32 s3, s62, 32768
    buffer_load_dwordx4 v[68:71], v5, s[16:19], s3 offen
    s_add_u32 s3, s64, 8192
    buffer_load_dwordx4 v[72:75], v6, s[12:15], s3 offen
    s_add_u32 s3, s64, 106496
    buffer_load_dwordx4 v[76:79], v6, s[12:15], s3 offen
    s_add_u32 s3, s64, 204800
    buffer_load_dwordx4 v[80:83], v6, s[12:15], s3 offen
    s_add_u32 s3, s64, 303104
    buffer_load_dwordx4 v[84:87], v6, s[12:15], s3 offen
    s_add_u32 s3, s64, 401408
    buffer_load_dwordx4 v[88:91], v6, s[12:15], s3 offen
    s_add_u32 s3, s64, 499712
    buffer_load_dwordx4 v[92:95], v6, s[12:15], s3 offen
    s_add_u32 s3, s64, 598016
    buffer_load_dwordx4 v[96:99], v6, s[12:15], s3 offen
    s_add_u32 s3, s64, 696320
    buffer_load_dwordx4 v[100:103], v6, s[12:15], s3 offen
    s_add_u32 s3, s62, 65536
    buffer_load_dwordx4 v[104:107], v5, s[16:19], s3 offen
    s_add_u32 s3, s62, 98304
    buffer_load_dwordx4 v[108:111], v5, s[16:19], s3 offen
    s_add_u32 s3, s64, 16384
    buffer_load_dwordx4 v[112:115], v6, s[12:15], s3 offen
    s_add_u32 s3, s64, 114688
    buffer_load_dwordx4 v[116:119], v6, s[12:15], s3 offen
    s_add_u32 s3, s64, 212992
    buffer_load_dwordx4 v[120:123], v6, s[12:15], s3 offen
    s_add_u32 s3, s64, 311296
    buffer_load_dwordx4 v[124:127], v6, s[12:15], s3 offen
    s_add_u32 s3, s64, 409600
    buffer_load_dwordx4 v[128:131], v6, s[12:15], s3 offen
    s_add_u32 s3, s64, 507904
    buffer_load_dwordx4 v[132:135], v6, s[12:15], s3 offen
    s_add_u32 s3, s64, 606208
    buffer_load_dwordx4 v[136:139], v6, s[12:15], s3 offen
    s_add_u32 s3, s64, 704512
    buffer_load_dwordx4 v[140:143], v6, s[12:15], s3 offen
    s_mov_b32 s3, 24576
    v_mul_lo_u32 v8, v3, s3
    v_lshl_add_u32 v8, v4, 4, v8
    s_add_u32 s3, s64, 0
    buffer_load_dwordx4 v[160:163], v8, s[12:15], s3 offen
    s_add_u32 s3, s64, 64
    buffer_load_dwordx4 v[164:167], v8, s[12:15], s3 offen
    s_add_u32 s3, s64, 128
    buffer_load_dwordx4 v[168:171], v8, s[12:15], s3 offen
    s_add_u32 s3, s64, 192
    buffer_load_dwordx4 v[172:175], v8, s[12:15], s3 offen
    s_add_u32 s3, s64, 393216
    buffer_load_dwordx4 v[176:179], v8, s[12:15], s3 offen
    s_add_u32 s3, s64, 393280
    buffer_load_dwordx4 v[180:183], v8, s[12:15], s3 offen
    s_add_u32 s3, s64, 393344
    buffer_load_dwordx4 v[184:187], v8, s[12:15], s3 offen
    s_add_u32 s3, s64, 393408
    buffer_load_dwordx4 v[188:191], v8, s[12:15], s3 offen
    v_mov_b32 v12, 0
    v_mov_b32 v13, 0
    v_mov_b32 v14, 0
    v_mov_b32 v15, 0
    s_waitcnt vmcnt(0)
    ds_write_b128 v7, v[64:67] offset:0
    ds_write_b128 v7, v[68:71] offset:1088
    ds_write_b128 v7, v[72:75] offset:2176
    ds_write_b128 v7, v[76:79] offset:3264
    ds_write_b128 v7, v[80:83] offset:4352
    ds_write_b128 v7, v[84:87] offset:5440
    ds_write_b128 v7, v[88:91] offset:6528
    ds_write_b128 v7, v[92:95] offset:7616
    ds_write_b128 v7, v[96:99] offset:8704
    ds_write_b128 v7, v[100:103] offset:9792
    ds_write_b128 v7, v[12:15] offset:10880
    ds_write_b128 v7, v[12:15] offset:11968
    ds_write_b128 v7, v[104:107] offset:13056
    ds_write_b128 v7, v[108:111] offset:14144
    ds_write_b128 v7, v[112:115] offset:15232
    ds_write_b128 v7, v[116:119] offset:16320
    ds_write_b128 v7, v[120:123] offset:17408
    ds_write_b128 v7, v[124:127] offset:18496
    ds_write_b128 v7, v[128:131] offset:19584
    ds_write_b128 v7, v[132:135] offset:20672
    ds_write_b128 v7, v[136:139] offset:21760
    ds_write_b128 v7, v[140:143] offset:22848
    ds_write_b128 v7, v[12:15] offset:23936
    ds_write_b128 v7, v[12:15] offset:25024
    v_mul_u32_u24 v9, 272, v3
    v_lshl_add_u32 v9, v4, 4, v9
    v_add_u32 v9, s61, v9
    v_bfe_u32 v10, v1, 2, 2
    v_lshl_add_u32 v10, v4, 2, v10
    v_mul_u32_u24 v10, 272, v10
    v_and_b32 v11, 3, v1
    v_lshl_add_u32 v10, v11, 3, v10
    v_add_u32 v10, s61, v10
    s_waitcnt lgkmcnt(0)
    ds_read_b128 v[64:67], v9 offset:0
    ds_read_b128 v[68:71], v9 offset:64
    ds_read_b128 v[72:75], v9 offset:128
    ds_read_b128 v[76:79], v9 offset:192
    ds_read_b128 v[80:83], v9 offset:4352
    ds_read_b128 v[84:87], v9 offset:4416
    ds_read_b128 v[88:91], v9 offset:4480
    ds_read_b128 v[92:95], v9 offset:4544
    ds_read_b128 v[96:99], v9 offset:8704
    ds_read_b128 v[100:103], v9 offset:8768
    ds_read_b128 v[104:107], v9 offset:8832
    ds_read_b128 v[108:111], v9 offset:8896
    ds_read_b64_tr_b16 v[112:113], v10 offset:13056
    ds_read_b64_tr_b16 v[114:115], v10 offset:17408
    ds_read_b64_tr_b16 v[116:117], v10 offset:21760
    ds_read_b64_tr_b16 v[118:119], v10 offset:13088
    ds_read_b64_tr_b16 v[120:121], v10 offset:17440
    ds_read_b64_tr_b16 v[122:123], v10 offset:21792
    ds_read_b64_tr_b16 v[124:125], v10 offset:13120
    ds_read_b64_tr_b16 v[126:127], v10 offset:17472
    ds_read_b64_tr_b16 v[128:129], v10 offset:21824
    ds_read_b64_tr_b16 v[130:131], v10 offset:13152
    ds_read_b64_tr_b16 v[132:133], v10 offset:17504
    ds_read_b64_tr_b16 v[134:135], v10 offset:21856
    ds_read_b64_tr_b16 v[136:137], v10 offset:13184
    ds_read_b64_tr_b16 v[138:139], v10 offset:17536
    ds_read_b64_tr_b16 v[140:141], v10 offset:21888
    ds_read_b64_tr_b16 v[142:143], v10 offset:13216
    ds_read_b64_tr_b16 v[144:145], v10 offset:17568
    ds_read_b64_tr_b16 v[146:147], v10 offset:21920
    ds_read_b64_tr_b16 v[148:149], v10 offset:13248
    ds_read_b64_tr_b16 v[150:151], v10 offset:17600
    ds_read_b64_tr_b16 v[152:153], v10 offset:21952
    ds_read_b64_tr_b16 v[154:155], v10 offset:13280
    ds_read_b64_tr_b16 v[156:157], v10 offset:17632
    ds_read_b64_tr_b16 v[158:159], v10 offset:21984
    v_lshlrev_b32 v11, 13, v3
    v_lshl_add_u32 v11, v4, 3, v11
    s_mul_i32 s65, s59, 262144
    s_add_u32 s65, s65, s63
    s_waitcnt lgkmcnt(0)
    v_mov_b32 v48, 0
    v_mov_b32 v49, 0
    v_mov_b32 v50, 0
    v_mov_b32 v51, 0
    v_mov_b32 v52, 0
    v_mov_b32 v53, 0
    v_mov_b32 v54, 0
    v_mov_b32 v55, 0
    v_mov_b32 v56, 0
    v_mov_b32 v57, 0
    v_mov_b32 v58, 0
    v_mov_b32 v59, 0
    s_nop 1
    v_mfma_f32_16x16x32_bf16 v[48:51], v[64:67], v[160:163], v[48:51]
    v_mfma_f32_16x16x32_bf16 v[52:55], v[80:83], v[160:163], v[52:55]
    v_mfma_f32_16x16x32_bf16 v[56:59], v[96:99], v[160:163], v[56:59]
    v_mfma_f32_16x16x32_bf16 v[48:51], v[68:71], v[164:167], v[48:51]
    v_mfma_f32_16x16x32_bf16 v[52:55], v[84:87], v[164:167], v[52:55]
    v_mfma_f32_16x16x32_bf16 v[56:59], v[100:103], v[164:167], v[56:59]
    v_mfma_f32_16x16x32_bf16 v[48:51], v[72:75], v[168:171], v[48:51]
    v_mfma_f32_16x16x32_bf16 v[52:55], v[88:91], v[168:171], v[52:55]
    v_mfma_f32_16x16x32_bf16 v[56:59], v[104:107], v[168:171], v[56:59]
    v_mfma_f32_16x16x32_bf16 v[48:51], v[76:79], v[172:175], v[48:51]
    v_mfma_f32_16x16x32_bf16 v[52:55], v[92:95], v[172:175], v[52:55]
    v_mfma_f32_16x16x32_bf16 v[56:59], v[108:111], v[172:175], v[56:59]
    s_nop 7
    s_nop 1
    v_lshlrev_b32 v33, 2, v4
    v_sub_u32 v33, v33, v3
    v_mov_b32 v32, 0xff800000
    v_cmp_ge_i32 vcc, 8, v33
    s_nop 1
    v_cndmask_b32 v48, v32, v48, vcc
    v_cmp_ge_i32 vcc, 7, v33
    s_nop 1
    v_cndmask_b32 v49, v32, v49, vcc
    v_cmp_ge_i32 vcc, 6, v33
    s_nop 1
    v_cndmask_b32 v50, v32, v50, vcc
    v_cmp_ge_i32 vcc, 5, v33
    s_nop 1
    v_cndmask_b32 v51, v32, v51, vcc
    v_cmp_ge_i32 vcc, -8, v33
    s_nop 1
    v_cndmask_b32 v52, v32, v52, vcc
    v_cmp_ge_i32 vcc, -9, v33
    s_nop 1
    v_cndmask_b32 v53, v32, v53, vcc
    v_cmp_ge_i32 vcc, -10, v33
    s_nop 1
    v_cndmask_b32 v54, v32, v54, vcc
    v_cmp_ge_i32 vcc, -11, v33
    s_nop 1
    v_cndmask_b32 v55, v32, v55, vcc
    v_cmp_ge_i32 vcc, -24, v33
    s_nop 1
    v_cndmask_b32 v56, v32, v56, vcc
    v_cmp_ge_i32 vcc, -25, v33
    s_nop 1
    v_cndmask_b32 v57, v32, v57, vcc
    v_cmp_ge_i32 vcc, -26, v33
    s_nop 1
    v_cndmask_b32 v58, v32, v58, vcc
    v_cmp_ge_i32 vcc, -27, v33
    s_nop 1
    v_cndmask_b32 v59, v32, v59, vcc
    v_max_f32 v32, v48, v49
    v_max_f32 v32, v32, v50
    v_max_f32 v32, v32, v51
    v_max_f32 v32, v32, v52
    v_max_f32 v32, v32, v53
    v_max_f32 v32, v32, v54
    v_max_f32 v32, v32, v55
    v_max_f32 v32, v32, v56
    v_max_f32 v32, v32, v57
    v_max_f32 v32, v32, v58
    v_max_f32 v32, v32, v59
    ds_swizzle_b32 v33, v32 offset:0x401f
    s_waitcnt lgkmcnt(0)
    v_max_f32 v32, v32, v33
    v_mov_b32 v33, v32
    s_nop 1
    v_permlane32_swap_b32 v32, v33
    s_nop 1
    v_max_f32 v32, v32, v33
    v_mul_f32 v33, 0xbe0293ee, v32
    s_mov_b32 s3, 0x3e0293ee
    v_fma_f32 v48, v48, s3, v33
    v_exp_f32 v48, v48
    v_fma_f32 v49, v49, s3, v33
    v_exp_f32 v49, v49
    v_fma_f32 v50, v50, s3, v33
    v_exp_f32 v50, v50
    v_fma_f32 v51, v51, s3, v33
    v_exp_f32 v51, v51
    v_fma_f32 v52, v52, s3, v33
    v_exp_f32 v52, v52
    v_fma_f32 v53, v53, s3, v33
    v_exp_f32 v53, v53
    v_fma_f32 v54, v54, s3, v33
    v_exp_f32 v54, v54
    v_fma_f32 v55, v55, s3, v33
    v_exp_f32 v55, v55
    v_fma_f32 v56, v56, s3, v33
    v_exp_f32 v56, v56
    v_fma_f32 v57, v57, s3, v33
    v_exp_f32 v57, v57
    v_fma_f32 v58, v58, s3, v33
    v_exp_f32 v58, v58
    v_fma_f32 v59, v59, s3, v33
    v_exp_f32 v59, v59
    s_nop 0
    v_add_f32 v32, v48, v49
    v_add_f32 v32, v32, v50
    v_add_f32 v32, v32, v51
    v_add_f32 v32, v32, v52
    v_add_f32 v32, v32, v53
    v_add_f32 v32, v32, v54
    v_add_f32 v32, v32, v55
    v_add_f32 v32, v32, v56
    v_add_f32 v32, v32, v57
    v_add_f32 v32, v32, v58
    v_add_f32 v32, v32, v59
    ds_swizzle_b32 v33, v32 offset:0x401f
    s_waitcnt lgkmcnt(0)
    v_add_f32 v32, v32, v33
    v_mov_b32 v33, v32
    s_nop 1
    v_permlane32_swap_b32 v32, v33
    s_nop 1
    v_add_f32 v32, v32, v33
    v_rcp_f32 v32, v32
    s_nop 0
    v_mul_f32 v48, v48, v32
    v_mul_f32 v49, v49, v32
    v_mul_f32 v50, v50, v32
    v_mul_f32 v51, v51, v32
    v_mul_f32 v52, v52, v32
    v_mul_f32 v53, v53, v32
    v_mul_f32 v54, v54, v32
    v_mul_f32 v55, v55, v32
    v_mul_f32 v56, v56, v32
    v_mul_f32 v57, v57, v32
    v_mul_f32 v58, v58, v32
    v_mul_f32 v59, v59, v32
    v_cvt_pk_bf16_f32 v16, v48, v49
    v_cvt_pk_bf16_f32 v17, v50, v51
    v_cvt_pk_bf16_f32 v18, v52, v53
    v_cvt_pk_bf16_f32 v19, v54, v55
    v_cvt_pk_bf16_f32 v20, v56, v57
    v_cvt_pk_bf16_f32 v21, v58, v59
    s_nop 1
    v_mfma_f32_16x16x32_bf16 v[192:195], v[112:115], v[16:19], 0
    v_mfma_f32_16x16x32_bf16 v[196:199], v[118:121], v[16:19], 0
    v_mfma_f32_16x16x32_bf16 v[200:203], v[124:127], v[16:19], 0
    v_mfma_f32_16x16x32_bf16 v[204:207], v[130:133], v[16:19], 0
    v_mfma_f32_16x16x32_bf16 v[208:211], v[136:139], v[16:19], 0
    v_mfma_f32_16x16x32_bf16 v[212:215], v[142:145], v[16:19], 0
    v_mfma_f32_16x16x32_bf16 v[216:219], v[148:151], v[16:19], 0
    v_mfma_f32_16x16x32_bf16 v[220:223], v[154:157], v[16:19], 0
    v_mfma_f32_16x16x16_bf16 v[192:195], v[116:117], v[20:21], v[192:195]
    v_mfma_f32_16x16x16_bf16 v[196:199], v[122:123], v[20:21], v[196:199]
    v_mfma_f32_16x16x16_bf16 v[200:203], v[128:129], v[20:21], v[200:203]
    v_mfma_f32_16x16x16_bf16 v[204:207], v[134:135], v[20:21], v[204:207]
    v_mfma_f32_16x16x16_bf16 v[208:211], v[140:141], v[20:21], v[208:211]
    v_mfma_f32_16x16x16_bf16 v[212:215], v[146:147], v[20:21], v[212:215]
    v_mfma_f32_16x16x16_bf16 v[216:219], v[152:153], v[20:21], v[216:219]
    v_mfma_f32_16x16x16_bf16 v[220:223], v[158:159], v[20:21], v[220:223]
    s_nop 7
    s_nop 1
    s_add_u32 s3, s65, 0
    v_cvt_pk_bf16_f32 v24, v192, v193
    v_cvt_pk_bf16_f32 v25, v194, v195
    buffer_store_dwordx2 v[24:25], v11, s[20:23], s3 offen offset:0
    s_nop 1
    v_cvt_pk_bf16_f32 v24, v196, v197
    v_cvt_pk_bf16_f32 v25, v198, v199
    buffer_store_dwordx2 v[24:25], v11, s[20:23], s3 offen offset:32
    s_nop 1
    v_cvt_pk_bf16_f32 v24, v200, v201
    v_cvt_pk_bf16_f32 v25, v202, v203
    buffer_store_dwordx2 v[24:25], v11, s[20:23], s3 offen offset:64
    s_nop 1
    v_cvt_pk_bf16_f32 v24, v204, v205
    v_cvt_pk_bf16_f32 v25, v206, v207
    buffer_store_dwordx2 v[24:25], v11, s[20:23], s3 offen offset:96
    s_nop 1
    v_cvt_pk_bf16_f32 v24, v208, v209
    v_cvt_pk_bf16_f32 v25, v210, v211
    buffer_store_dwordx2 v[24:25], v11, s[20:23], s3 offen offset:128
    s_nop 1
    v_cvt_pk_bf16_f32 v24, v212, v213
    v_cvt_pk_bf16_f32 v25, v214, v215
    buffer_store_dwordx2 v[24:25], v11, s[20:23], s3 offen offset:160
    s_nop 1
    v_cvt_pk_bf16_f32 v24, v216, v217
    v_cvt_pk_bf16_f32 v25, v218, v219
    buffer_store_dwordx2 v[24:25], v11, s[20:23], s3 offen offset:192
    s_nop 1
    v_cvt_pk_bf16_f32 v24, v220, v221
    v_cvt_pk_bf16_f32 v25, v222, v223
    buffer_store_dwordx2 v[24:25], v11, s[20:23], s3 offen offset:224
    s_nop 1
    v_mov_b32 v48, 0
    v_mov_b32 v49, 0
    v_mov_b32 v50, 0
    v_mov_b32 v51, 0
    v_mov_b32 v52, 0
    v_mov_b32 v53, 0
    v_mov_b32 v54, 0
    v_mov_b32 v55, 0
    v_mov_b32 v56, 0
    v_mov_b32 v57, 0
    v_mov_b32 v58, 0
    v_mov_b32 v59, 0
    s_nop 1
    v_mfma_f32_16x16x32_bf16 v[48:51], v[64:67], v[176:179], v[48:51]
    v_mfma_f32_16x16x32_bf16 v[52:55], v[80:83], v[176:179], v[52:55]
    v_mfma_f32_16x16x32_bf16 v[56:59], v[96:99], v[176:179], v[56:59]
    v_mfma_f32_16x16x32_bf16 v[48:51], v[68:71], v[180:183], v[48:51]
    v_mfma_f32_16x16x32_bf16 v[52:55], v[84:87], v[180:183], v[52:55]
    v_mfma_f32_16x16x32_bf16 v[56:59], v[100:103], v[180:183], v[56:59]
    v_mfma_f32_16x16x32_bf16 v[48:51], v[72:75], v[184:187], v[48:51]
    v_mfma_f32_16x16x32_bf16 v[52:55], v[88:91], v[184:187], v[52:55]
    v_mfma_f32_16x16x32_bf16 v[56:59], v[104:107], v[184:187], v[56:59]
    v_mfma_f32_16x16x32_bf16 v[48:51], v[76:79], v[188:191], v[48:51]
    v_mfma_f32_16x16x32_bf16 v[52:55], v[92:95], v[188:191], v[52:55]
    v_mfma_f32_16x16x32_bf16 v[56:59], v[108:111], v[188:191], v[56:59]
    s_nop 7
    s_nop 1
    v_lshlrev_b32 v33, 2, v4
    v_sub_u32 v33, v33, v3
    v_mov_b32 v32, 0xff800000
    v_cmp_ge_i32 vcc, 24, v33
    s_nop 1
    v_cndmask_b32 v48, v32, v48, vcc
    v_cmp_ge_i32 vcc, 23, v33
    s_nop 1
    v_cndmask_b32 v49, v32, v49, vcc
    v_cmp_ge_i32 vcc, 22, v33
    s_nop 1
    v_cndmask_b32 v50, v32, v50, vcc
    v_cmp_ge_i32 vcc, 21, v33
    s_nop 1
    v_cndmask_b32 v51, v32, v51, vcc
    v_cmp_ge_i32 vcc, 8, v33
    s_nop 1
    v_cndmask_b32 v52, v32, v52, vcc
    v_cmp_ge_i32 vcc, 7, v33
    s_nop 1
    v_cndmask_b32 v53, v32, v53, vcc
    v_cmp_ge_i32 vcc, 6, v33
    s_nop 1
    v_cndmask_b32 v54, v32, v54, vcc
    v_cmp_ge_i32 vcc, 5, v33
    s_nop 1
    v_cndmask_b32 v55, v32, v55, vcc
    v_cmp_ge_i32 vcc, -8, v33
    s_nop 1
    v_cndmask_b32 v56, v32, v56, vcc
    v_cmp_ge_i32 vcc, -9, v33
    s_nop 1
    v_cndmask_b32 v57, v32, v57, vcc
    v_cmp_ge_i32 vcc, -10, v33
    s_nop 1
    v_cndmask_b32 v58, v32, v58, vcc
    v_cmp_ge_i32 vcc, -11, v33
    s_nop 1
    v_cndmask_b32 v59, v32, v59, vcc
    v_max_f32 v32, v48, v49
    v_max_f32 v32, v32, v50
    v_max_f32 v32, v32, v51
    v_max_f32 v32, v32, v52
    v_max_f32 v32, v32, v53
    v_max_f32 v32, v32, v54
    v_max_f32 v32, v32, v55
    v_max_f32 v32, v32, v56
    v_max_f32 v32, v32, v57
    v_max_f32 v32, v32, v58
    v_max_f32 v32, v32, v59
    ds_swizzle_b32 v33, v32 offset:0x401f
    s_waitcnt lgkmcnt(0)
    v_max_f32 v32, v32, v33
    v_mov_b32 v33, v32
    s_nop 1
    v_permlane32_swap_b32 v32, v33
    s_nop 1
    v_max_f32 v32, v32, v33
    v_mul_f32 v33, 0xbe0293ee, v32
    s_mov_b32 s3, 0x3e0293ee
    v_fma_f32 v48, v48, s3, v33
    v_exp_f32 v48, v48
    v_fma_f32 v49, v49, s3, v33
    v_exp_f32 v49, v49
    v_fma_f32 v50, v50, s3, v33
    v_exp_f32 v50, v50
    v_fma_f32 v51, v51, s3, v33
    v_exp_f32 v51, v51
    v_fma_f32 v52, v52, s3, v33
    v_exp_f32 v52, v52
    v_fma_f32 v53, v53, s3, v33
    v_exp_f32 v53, v53
    v_fma_f32 v54, v54, s3, v33
    v_exp_f32 v54, v54
    v_fma_f32 v55, v55, s3, v33
    v_exp_f32 v55, v55
    v_fma_f32 v56, v56, s3, v33
    v_exp_f32 v56, v56
    v_fma_f32 v57, v57, s3, v33
    v_exp_f32 v57, v57
    v_fma_f32 v58, v58, s3, v33
    v_exp_f32 v58, v58
    v_fma_f32 v59, v59, s3, v33
    v_exp_f32 v59, v59
    s_nop 0
    v_add_f32 v32, v48, v49
    v_add_f32 v32, v32, v50
    v_add_f32 v32, v32, v51
    v_add_f32 v32, v32, v52
    v_add_f32 v32, v32, v53
    v_add_f32 v32, v32, v54
    v_add_f32 v32, v32, v55
    v_add_f32 v32, v32, v56
    v_add_f32 v32, v32, v57
    v_add_f32 v32, v32, v58
    v_add_f32 v32, v32, v59
    ds_swizzle_b32 v33, v32 offset:0x401f
    s_waitcnt lgkmcnt(0)
    v_add_f32 v32, v32, v33
    v_mov_b32 v33, v32
    s_nop 1
    v_permlane32_swap_b32 v32, v33
    s_nop 1
    v_add_f32 v32, v32, v33
    v_rcp_f32 v32, v32
    s_nop 0
    v_mul_f32 v48, v48, v32
    v_mul_f32 v49, v49, v32
    v_mul_f32 v50, v50, v32
    v_mul_f32 v51, v51, v32
    v_mul_f32 v52, v52, v32
    v_mul_f32 v53, v53, v32
    v_mul_f32 v54, v54, v32
    v_mul_f32 v55, v55, v32
    v_mul_f32 v56, v56, v32
    v_mul_f32 v57, v57, v32
    v_mul_f32 v58, v58, v32
    v_mul_f32 v59, v59, v32
    v_cvt_pk_bf16_f32 v16, v48, v49
    v_cvt_pk_bf16_f32 v17, v50, v51
    v_cvt_pk_bf16_f32 v18, v52, v53
    v_cvt_pk_bf16_f32 v19, v54, v55
    v_cvt_pk_bf16_f32 v20, v56, v57
    v_cvt_pk_bf16_f32 v21, v58, v59
    s_nop 1
    v_mfma_f32_16x16x32_bf16 v[192:195], v[112:115], v[16:19], 0
    v_mfma_f32_16x16x32_bf16 v[196:199], v[118:121], v[16:19], 0
    v_mfma_f32_16x16x32_bf16 v[200:203], v[124:127], v[16:19], 0
    v_mfma_f32_16x16x32_bf16 v[204:207], v[130:133], v[16:19], 0
    v_mfma_f32_16x16x32_bf16 v[208:211], v[136:139], v[16:19], 0
    v_mfma_f32_16x16x32_bf16 v[212:215], v[142:145], v[16:19], 0
    v_mfma_f32_16x16x32_bf16 v[216:219], v[148:151], v[16:19], 0
    v_mfma_f32_16x16x32_bf16 v[220:223], v[154:157], v[16:19], 0
    v_mfma_f32_16x16x16_bf16 v[192:195], v[116:117], v[20:21], v[192:195]
    v_mfma_f32_16x16x16_bf16 v[196:199], v[122:123], v[20:21], v[196:199]
    v_mfma_f32_16x16x16_bf16 v[200:203], v[128:129], v[20:21], v[200:203]
    v_mfma_f32_16x16x16_bf16 v[204:207], v[134:135], v[20:21], v[204:207]
    v_mfma_f32_16x16x16_bf16 v[208:211], v[140:141], v[20:21], v[208:211]
    v_mfma_f32_16x16x16_bf16 v[212:215], v[146:147], v[20:21], v[212:215]
    v_mfma_f32_16x16x16_bf16 v[216:219], v[152:153], v[20:21], v[216:219]
    v_mfma_f32_16x16x16_bf16 v[220:223], v[158:159], v[20:21], v[220:223]
    s_nop 7
    s_nop 1
    s_add_u32 s3, s65, 131072
    v_cvt_pk_bf16_f32 v24, v192, v193
    v_cvt_pk_bf16_f32 v25, v194, v195
    buffer_store_dwordx2 v[24:25], v11, s[20:23], s3 offen offset:0
    s_nop 1
    v_cvt_pk_bf16_f32 v24, v196, v197
    v_cvt_pk_bf16_f32 v25, v198, v199
    buffer_store_dwordx2 v[24:25], v11, s[20:23], s3 offen offset:32
    s_nop 1
    v_cvt_pk_bf16_f32 v24, v200, v201
    v_cvt_pk_bf16_f32 v25, v202, v203
    buffer_store_dwordx2 v[24:25], v11, s[20:23], s3 offen offset:64
    s_nop 1
    v_cvt_pk_bf16_f32 v24, v204, v205
    v_cvt_pk_bf16_f32 v25, v206, v207
    buffer_store_dwordx2 v[24:25], v11, s[20:23], s3 offen offset:96
    s_nop 1
    v_cvt_pk_bf16_f32 v24, v208, v209
    v_cvt_pk_bf16_f32 v25, v210, v211
    buffer_store_dwordx2 v[24:25], v11, s[20:23], s3 offen offset:128
    s_nop 1
    v_cvt_pk_bf16_f32 v24, v212, v213
    v_cvt_pk_bf16_f32 v25, v214, v215
    buffer_store_dwordx2 v[24:25], v11, s[20:23], s3 offen offset:160
    s_nop 1
    v_cvt_pk_bf16_f32 v24, v216, v217
    v_cvt_pk_bf16_f32 v25, v218, v219
    buffer_store_dwordx2 v[24:25], v11, s[20:23], s3 offen offset:192
    s_nop 1
    v_cvt_pk_bf16_f32 v24, v220, v221
    v_cvt_pk_bf16_f32 v25, v222, v223
    buffer_store_dwordx2 v[24:25], v11, s[20:23], s3 offen offset:224
    s_nop 1
.attn_kernel_done:
    s_endpgm
.section .rodata,"a"
.p2align 6
.amdhsa_kernel attn_kernel
  .amdhsa_next_free_vgpr 224
  .amdhsa_next_free_sgpr 80
  .amdhsa_accum_offset 224
  .amdhsa_group_segment_fixed_size 0
  .amdhsa_kernarg_size 120
  .amdhsa_user_sgpr_count 2
  .amdhsa_user_sgpr_kernarg_segment_ptr 1
  .amdhsa_system_sgpr_workgroup_id_x 1
.end_amdhsa_kernel
```
